```python
import torch

def _softmax(x, axis=-1):
    return torch.softmax(x, dim=axis)
def _gelu(x):
    return torch.nn.functional.gelu(x, approximate="tanh")
def _silu(x):
    return torch.nn.functional.silu(x)
def _sigmoid(x):
    return torch.sigmoid(x)
def _layernorm(x, axis=-1, eps=1e-5):
    m = x.mean(dim=axis, keepdim=True)
    v = x.var(dim=axis, keepdim=True, unbiased=False)
    return (x - m) / torch.sqrt(v + eps)
def _scatter_add(tgt, idx, src, axis=0):
    return tgt.clone().index_add_(axis, idx, src)
def _segment_sum(src, seg, n):
    out = torch.zeros((n,) + src.shape[1:], dtype=src.dtype)
    return out.index_add_(0, seg, src)
def _pad(x, pw):
    flat = tuple(v for pair in reversed(pw) for v in pair)
    return torch.nn.functional.pad(x, flat)

kernel_name = 'concat_heads__ssm_conv_s4d__spectral_gfnet__prompt'

def setup_inputs():

    _w = (lambda a: (lambda t: t.to(torch.bfloat16) if t.is_floating_point() else t)(torch.as_tensor(a)))
    def _A_setup():
        Bsz, L, D, N = 1, 2048, 640, 128
        return {
            "u": _w((lambda *s: torch.randn(*s, dtype=torch.bfloat16) * 0.05)(Bsz, L, D)),
            "log_A_real": _w((lambda *s: torch.randn(*s, dtype=torch.bfloat16) * 6.4)(D, N) * 0.5),
            "A_imag": _w((lambda *s: torch.randn(*s, dtype=torch.bfloat16) * 0.05)(D, N) * 3.14),
            "C_real": _w((lambda *s: torch.randn(*s, dtype=torch.bfloat16) * 0.05)(D, N) / N ** 0.5),
            "C_imag": _w((lambda *s: torch.randn(*s, dtype=torch.bfloat16) * 0.05)(D, N) / N ** 0.5),
            "log_dt": _w((lambda *s: torch.randn(*s, dtype=torch.bfloat16) * 0.05)(D) * 0.5 - 4.0),
            "D_skip": _w((lambda *s: torch.randn(*s, dtype=torch.bfloat16) * 0.05)(D)),
        }
    _A_in = _A_setup()

    def _B_setup():
        B, S, D = 1, 2048, 640
        Df = D // 2 + 1
        return {
            "x": _w((lambda *s: torch.randn(*s, dtype=torch.bfloat16) * 0.05)(B, S, D)),
            "w_r": _w((lambda *s: torch.randn(*s, dtype=torch.bfloat16) * 0.8)(S, Df) * 0.02),
            "w_i": _w((lambda *s: torch.randn(*s, dtype=torch.bfloat16) * 0.8)(S, Df) * 0.02),
        }
    _B_in = _B_setup()

    return {
        "A_u": _A_in["u"],
        "A_log_A_real": _A_in["log_A_real"],
        "A_A_imag": _A_in["A_imag"],
        "A_C_real": _A_in["C_real"],
        "A_C_imag": _A_in["C_imag"],
        "A_log_dt": _A_in["log_dt"],
        "A_D_skip": _A_in["D_skip"],
        "B_x": _B_in["x"],
        "B_w_r": _B_in["w_r"],
        "B_w_i": _B_in["w_i"],
    }

def reference(A_u, A_log_A_real, A_A_imag, A_C_real, A_C_imag, A_log_dt, A_D_skip, B_x, B_w_r, B_w_i):
    def _A_ref(u, log_A_real, A_imag, C_real, C_imag, log_dt, D_skip):
        L = u.shape[1]
        dt = torch.exp(log_dt)
        A = -torch.exp(log_A_real) + 1j * A_imag
        C = (C_real + 1j * C_imag) * dt[:, None]
        pos = (lambda x, dt: x.to(dt))(torch.arange(L), log_dt.dtype)
        P = torch.exp((A * dt[:, None])[:, :, None] * pos[None, None, :])
        K = 2.0 * torch.einsum("dn,dnl->dl", C, P).real
        L2 = 2 * L
        u_t = (lambda x, *d: x.permute(*d))(u, 0, 2, 1)
        Kf = (lambda x, *a, **k: torch.fft.rfft(x.float(), *a, **k))(K, L2)
        Uf = (lambda x, *a, **k: torch.fft.rfft(x.float(), *a, **k))(u_t, L2)
        y = (lambda x, *a, **k: torch.fft.irfft(x, *a, **k).to(torch.bfloat16))(Uf * Kf[None, :, :], L2)[:, :, :L]
        y = (lambda x, *d: x.permute(*d))(y, 0, 2, 1)
        return y + u * D_skip[None, None, :]

    def _B_ref(x, w_r, w_i):
        B, S, D = x.shape
        X = (lambda x, axes=(-2,-1): torch.fft.rfft2(x.float(), dim=axes))(x, axes=(-2, -1))
        W = w_r + 1j * w_i
        X = X * W
        y = (lambda x, s, axes=(-2,-1): torch.fft.irfft2(x, s=s, dim=axes).to(torch.bfloat16))(X, (S, D), axes=(-2, -1))
        return y

    a = _A_ref(A_u, A_log_A_real, A_A_imag, A_C_real, A_C_imag, A_log_dt, A_D_skip)
    b = _B_ref(B_x, B_w_r, B_w_i)
    return torch.concatenate([a, b], axis=-1)
```

```asm
; @launch kernel=k1_kernel grid=(752,1,1) block=(256,1,1) lds=36864
; @launch kernel=k2_kernel grid=(241,1,1) block=(512,1,1) lds=83968
; @launch kernel=k3_kernel grid=(416,1,1) block=(256,1,1) lds=38400
.amdgcn_target "amdgcn-amd-amdhsa--gfx950"
.text
.globl k1_kernel
.type k1_kernel,@function
.set STAMP_BASE, 0
.p2align 8
k1_kernel:
  s_cmp_ge_u32 s2, 752
  s_cbranch_scc1 L_k1_end
  s_load_dwordx2 s[60:61], s[0:1], 96
  s_mov_b32 s62, 20971520
  s_mov_b32 s63, 0x20000
  s_getpc_b64 s[72:73]
L_spf_k1_kernel:
  s_sub_u32 s72, s72, L_spf_k1_kernel - k1_kernel
  s_subb_u32 s73, s73, 0
  s_mov_b32 s74, L_k1_end - k1_kernel
  s_mov_b32 s75, 0x20000
  s_lshr_b32 s76, s2, 3
  s_and_b32 s76, s76, 1
  s_lshl_b32 s76, s76, 12
  v_lshlrev_b32 v120, 4, v0
  buffer_load_dwordx4 v[120:123], v120, s[72:75], s76 offen
  v_lshrrev_b32 v1, 6, v0
  v_and_b32 v0, 63, v0
  v_readfirstlane_b32 s3, v1
  s_nop 3
  s_sub_u32 s4, s2, 576
  s_cmp_lt_u32 s4, 176
  s_cbranch_scc1 L_k1_tstub
  s_sub_u32 s4, s2, 256
  s_cmp_lt_u32 s4, 320
  s_cbranch_scc1 L_k1_kstub
  s_sub_u32 s40, s2, 0
  s_load_dwordx2 s[64:65], s[0:1], 56
  s_mov_b32 s66, 2621440
  s_mov_b32 s67, 0x20000
  s_getpc_b64 s[68:69]
L_br_pc:
  s_add_u32 s68, s68, T_P1 - L_br_pc
  s_addc_u32 s69, s69, 0
  s_mov_b32 s70, 13312
  s_mov_b32 s71, 0x20000
  s_lshr_b32 s41, s40, 2
  s_and_b32 s42, s40, 3
  s_lshr_b32 s43, s42, 1
  s_lshl_b32 s43, s43, 4
  s_and_b32 s44, s42, 1
  s_lshl_b32 s44, s44, 2
  s_add_u32 s43, s43, s44
  s_lshr_b32 s44, s3, 1
  s_lshl_b32 s44, s44, 3
  s_add_u32 s43, s43, s44
  s_and_b32 s44, s3, 1
  s_lshl_b32 s44, s44, 1
  s_add_u32 s43, s43, s44
  s_lshl_b32 s43, s43, 6
  s_add_u32 s43, s43, s41
  s_mul_i32 s44, s43, 1280
  v_lshlrev_b32 v2, 4, v0
  v_lshrrev_b32 v5, 4, v0
  v_min_u32 v5, 1, v5
  v_mul_u32_u24 v5, 80640, v5
  v_add_u32 v4, v2, v5
  s_mul_i32 s45, s3, 2560
  s_add_u32 s47, s44, 1024
  s_add_u32 s48, s44, 82688
  s_lshl_b32 s46, s3, 10
  s_waitcnt lgkmcnt(0)
  s_mov_b32 m0, s45
  s_nop 0
  buffer_load_dwordx4 v2, s[64:67], s44 offen lds
  s_add_u32 m0, s45, 1024
  s_nop 0
  buffer_load_dwordx4 v4, s[64:67], s47 offen lds
  s_add_u32 m0, s45, 2048
  s_mov_b32 exec_hi, 0
  buffer_load_dwordx4 v2, s[64:67], s48 offen lds
  s_mov_b32 exec_hi, -1
  s_add_u32 m0, s46, 10240
  s_add_u32 s47, s46, 0
  buffer_load_dwordx4 v2, s[68:71], s47 offen lds
  s_add_u32 m0, s46, 14336
  s_add_u32 s47, s46, 4096
  buffer_load_dwordx4 v2, s[68:71], s47 offen lds
  s_add_u32 m0, s46, 18432
  s_add_u32 s47, s46, 8192
  buffer_load_dwordx4 v2, s[68:71], s47 offen lds
  s_cmp_lg_u32 s3, 0
  s_cbranch_scc1 L_k1_brow
  s_mov_b32 m0, 22528
  s_movk_i32 s47, 12288
  buffer_load_dwordx4 v2, s[68:71], s47 offen lds
  s_branch L_k1_brow
L_k1_tstub:
  s_sub_u32 s41, s2, 576
  s_lshl_b32 s41, s41, 2
  s_add_u32 s41, s41, s3
  v_and_b32 v2, 7, v0
  v_lshrrev_b32 v3, 3, v0
  s_cmp_ge_u32 s41, 320
  s_cbranch_scc1 L_ts_w
  s_load_dwordx2 s[64:65], s[0:1], 0
  s_mov_b32 s66, 2621440
  s_mov_b32 s67, 0x20000
  s_mul_i32 s42, s41, 6554
  s_lshr_b32 s42, s42, 16
  s_mul_i32 s43, s42, 10
  s_sub_u32 s43, s41, s43
  s_mul_i32 s44, s42, 81920
  s_lshl_b32 s45, s43, 7
  s_add_u32 s44, s44, s45
  s_add_u32 s45, s44, 5120
  v_mul_u32_u24 v4, 10240, v3
  v_lshl_add_u32 v4, v2, 4, v4
  s_waitcnt lgkmcnt(0)
  buffer_load_dwordx4 v[16:19], v4, s[64:67], s44 offen offset:0
  buffer_load_dwordx4 v[20:23], v4, s[64:67], s44 offen offset:1280
  buffer_load_dwordx4 v[24:27], v4, s[64:67], s44 offen offset:2560
  buffer_load_dwordx4 v[28:31], v4, s[64:67], s44 offen offset:3840
  buffer_load_dwordx4 v[32:35], v4, s[64:67], s45 offen offset:0
  buffer_load_dwordx4 v[36:39], v4, s[64:67], s45 offen offset:1280
  buffer_load_dwordx4 v[40:43], v4, s[64:67], s45 offen offset:2560
  buffer_load_dwordx4 v[44:47], v4, s[64:67], s45 offen offset:3840
  s_branch L_tt_u
L_ts_w:
  s_load_dwordx2 s[64:65], s[0:1], 64
  s_mov_b32 s66, 1314816
  s_mov_b32 s67, 0x20000
  s_load_dwordx2 s[68:69], s[0:1], 72
  s_mov_b32 s70, 1314816
  s_mov_b32 s71, 0x20000
  s_sub_u32 s41, s41, 320
  s_mul_i32 s42, s41, 10923
  s_lshr_b32 s42, s42, 16
  s_mul_i32 s43, s42, 6
  s_sub_u32 s43, s41, s43
  s_mul_i32 s44, s42, 20544
  s_lshl_b32 s45, s43, 7
  s_add_u32 s44, s44, s45
  v_mul_u32_u24 v4, 2568, v3
  s_cmp_eq_u32 s43, 5
  s_cbranch_scc1 L_ts_w5
  v_lshl_add_u32 v4, v2, 4, v4
  s_waitcnt lgkmcnt(0)
  buffer_load_dwordx4 v[16:19], v4, s[64:67], s44 offen offset:0
  buffer_load_dwordx4 v[32:35], v4, s[68:71], s44 offen offset:0
  buffer_load_dwordx4 v[20:23], v4, s[64:67], s44 offen offset:642
  buffer_load_dwordx4 v[36:39], v4, s[68:71], s44 offen offset:642
  buffer_load_dwordx4 v[24:27], v4, s[64:67], s44 offen offset:1284
  buffer_load_dwordx4 v[40:43], v4, s[68:71], s44 offen offset:1284
  buffer_load_dwordx4 v[28:31], v4, s[64:67], s44 offen offset:1926
  buffer_load_dwordx4 v[44:47], v4, s[68:71], s44 offen offset:1926
  s_branch L_tt_w
L_ts_w5:
  s_waitcnt lgkmcnt(0)
  buffer_load_ushort v16, v4, s[64:67], s44 offen offset:0
  buffer_load_ushort v32, v4, s[68:71], s44 offen offset:0
  buffer_load_ushort v20, v4, s[64:67], s44 offen offset:642
  buffer_load_ushort v36, v4, s[68:71], s44 offen offset:642
  buffer_load_ushort v24, v4, s[64:67], s44 offen offset:1284
  buffer_load_ushort v40, v4, s[68:71], s44 offen offset:1284
  buffer_load_ushort v28, v4, s[64:67], s44 offen offset:1926
  buffer_load_ushort v44, v4, s[68:71], s44 offen offset:1926
  s_branch L_tt_w5
L_k1_kstub:
  s_sub_u32 s40, s2, 256
  s_load_dwordx2 s[64:65], s[0:1], 8
  s_mov_b32 s66, 163840
  s_mov_b32 s67, 0x20000
  s_load_dwordx2 s[68:69], s[0:1], 16
  s_mov_b32 s70, 163840
  s_mov_b32 s71, 0x20000
  s_load_dwordx2 s[72:73], s[0:1], 24
  s_mov_b32 s74, 163840
  s_mov_b32 s75, 0x20000
  s_load_dwordx2 s[76:77], s[0:1], 32
  s_mov_b32 s78, 163840
  s_mov_b32 s79, 0x20000
  s_load_dwordx2 s[80:81], s[0:1], 40
  s_mov_b32 s82, 1280
  s_mov_b32 s83, 0x20000
  s_load_dwordx2 s[56:57], s[0:1], 48
  s_mov_b32 s58, 1280
  s_mov_b32 s59, 0x20000
  s_lshr_b32 s41, s3, 1
  s_lshl_b32 s42, s40, 1
  s_add_u32 s42, s42, s41
  s_and_b32 s43, s3, 1
  s_lshl_b32 s44, s42, 8
  s_lshl_b32 s45, s43, 7
  s_add_u32 s44, s44, s45
  v_lshlrev_b32 v2, 1, v0
  s_lshl_b32 s45, s42, 1
  v_mov_b32 v3, 0
  s_getpc_b64 s[30:31]
L_pf_pc:
  s_add_u32 s30, s30, k2_kernel - L_pf_pc
  s_addc_u32 s31, s31, 0
  s_waitcnt lgkmcnt(0)
  buffer_load_ushort v4, v2, s[64:67], s44 offen
  buffer_load_ushort v5, v2, s[68:71], s44 offen
  buffer_load_ushort v8, v3, s[80:83], s45 offen
  buffer_load_ushort v6, v2, s[72:75], s44 offen
  buffer_load_ushort v7, v2, s[76:79], s44 offen
  buffer_load_ushort v108, v3, s[56:59], s45 offen
  s_mov_b64 s[64:65], s[30:31]
  s_mov_b32 s66, PF_END - k2_kernel
  s_lshl_b32 s46, s40, 2
  s_add_u32 s46, s46, s3
  s_mul_i32 s47, s46, 1111
  s_lshr_b32 s47, s47, 16
  s_mul_i32 s47, s47, 59
  s_sub_u32 s46, s46, s47
  s_lshl_b32 s46, s46, 10
  v_lshlrev_b32 v9, 4, v0
  buffer_load_dwordx4 v[112:115], v9, s[64:67], s46 offen
L_k1_kgen:
  s_lshl_b32 s46, s3, 13
  v_lshlrev_b32 v9, 2, v0
  v_add_u32 v9, s46, v9
  v_mov_b32 v48, v9
  v_xor_b32 v49, 16, v9
  v_xor_b32 v50, 32, v9
  v_xor_b32 v51, 48, v9
  v_xor_b32 v52, 64, v9
  v_xor_b32 v53, 80, v9
  v_xor_b32 v54, 96, v9
  v_xor_b32 v55, 112, v9
  v_and_b32 v10, 15, v0
  v_lshrrev_b32 v11, 4, v0
  v_lshrrev_b32 v12, 1, v10
  v_xor_b32 v11, v11, v12
  v_lshlrev_b32 v11, 4, v11
  v_lshl_add_u32 v11, v10, 8, v11
  v_add_u32 v11, s46, v11
  v_xor_b32 v44, 0, v11
  v_xor_b32 v45, 64, v11
  v_xor_b32 v46, 128, v11
  v_xor_b32 v47, 192, v11
  s_waitcnt vmcnt(4)
  v_lshlrev_b32 v4, 16, v4
  v_lshlrev_b32 v5, 16, v5
  v_lshlrev_b32 v8, 16, v8
  v_mul_f32 v10, 0x3fb8aa00, v8
  v_mul_f32 v11, 0x36a407db, v8
  v_exp_f32 v10, v10
  s_nop 0
  v_fma_f32 v10, v10, v11, v10
  v_cvt_pk_bf16_f32 v10, v10, v10
  v_lshlrev_b32 v12, 16, v10
  v_mul_f32 v14, 0x3fb8aa00, v4
  v_mul_f32 v15, 0x36a407db, v4
  v_exp_f32 v14, v14
  s_nop 0
  v_fma_f32 v14, v14, v15, v14
  v_cvt_pk_bf16_f32 v14, v14, v14
  v_lshlrev_b32 v13, 16, v14
  v_mul_f32 v13, v13, v12
  v_mul_f32 v5, v5, v12
  v_mul_f32 v13, 0xbfb8aa3b, v13
  v_mul_f32 v5, 0x3e22f983, v5
  v_mul_f32 v56, 0x3f800000, v13
  v_mul_f32 v57, 0x3f800000, v5
  v_mul_f32 v58, 0x41000000, v13
  v_mul_f32 v59, 0x41000000, v5
  v_mul_f32 v60, 0x43000000, v13
  v_mul_f32 v61, 0x43000000, v5
  v_exp_f32 v56, v56
  v_fract_f32 v57, v57
  v_exp_f32 v58, v58
  v_fract_f32 v59, v59
  v_exp_f32 v60, v60
  v_fract_f32 v61, v61
  v_cos_f32 v16, v57
  v_sin_f32 v17, v57
  v_cos_f32 v30, v59
  v_sin_f32 v31, v59
  v_cos_f32 v32, v61
  v_sin_f32 v33, v61
  v_mul_f32 v16, v16, v56
  v_mul_f32 v17, v17, v56
  v_mul_f32 v30, v30, v58
  v_mul_f32 v31, v31, v58
  v_mul_f32 v32, v32, v60
  v_mul_f32 v33, v33, v60
  s_waitcnt vmcnt(2)
  v_add_f32 v12, v12, v12
  v_lshlrev_b32 v6, 16, v6
  v_lshlrev_b32 v7, 16, v7
  v_mul_f32 v34, v6, v12
  v_mul_f32 v35, v7, v12
  v_mov_b32 v63, 0x80003f80
  v_cvt_pk_bf16_f32 v42, v30, -v31
  ds_write2st64_b32 v48, v63, v42 offset0:0 offset1:1
  v_pk_mul_f32 v[38:39], v[30:31], v[30:31] op_sel:[0,0] op_sel_hi:[0,1]
  v_pk_fma_f32 v[38:39], v[30:31], v[30:31], v[38:39] op_sel:[1,1,0] op_sel_hi:[1,0,1] neg_lo:[1,0,0]
  v_pk_mul_f32 v[18:19], v[16:17], v[16:17] op_sel:[0,0] op_sel_hi:[0,1]
  v_pk_fma_f32 v[18:19], v[16:17], v[16:17], v[18:19] op_sel:[1,1,0] op_sel_hi:[1,0,1] neg_lo:[1,0,0]
  v_cvt_pk_bf16_f32 v43, v38, -v39
  v_pk_mul_f32 v[40:41], v[38:39], v[30:31] op_sel:[0,0] op_sel_hi:[0,1]
  v_pk_fma_f32 v[40:41], v[38:39], v[30:31], v[40:41] op_sel:[1,1,0] op_sel_hi:[1,0,1] neg_lo:[1,0,0]
  v_pk_mul_f32 v[20:21], v[18:19], v[16:17] op_sel:[0,0] op_sel_hi:[0,1]
  v_pk_fma_f32 v[20:21], v[18:19], v[16:17], v[20:21] op_sel:[1,1,0] op_sel_hi:[1,0,1] neg_lo:[1,0,0]
  v_cvt_pk_bf16_f32 v62, v40, -v41
  ds_write2st64_b32 v49, v43, v62 offset0:2 offset1:3
  v_pk_mul_f32 v[38:39], v[40:41], v[30:31] op_sel:[0,0] op_sel_hi:[0,1]
  v_pk_fma_f32 v[38:39], v[40:41], v[30:31], v[38:39] op_sel:[1,1,0] op_sel_hi:[1,0,1] neg_lo:[1,0,0]
  v_pk_mul_f32 v[22:23], v[20:21], v[16:17] op_sel:[0,0] op_sel_hi:[0,1]
  v_pk_fma_f32 v[22:23], v[20:21], v[16:17], v[22:23] op_sel:[1,1,0] op_sel_hi:[1,0,1] neg_lo:[1,0,0]
  v_cvt_pk_bf16_f32 v63, v38, -v39
  v_pk_mul_f32 v[40:41], v[38:39], v[30:31] op_sel:[0,0] op_sel_hi:[0,1]
  v_pk_fma_f32 v[40:41], v[38:39], v[30:31], v[40:41] op_sel:[1,1,0] op_sel_hi:[1,0,1] neg_lo:[1,0,0]
  v_pk_mul_f32 v[24:25], v[22:23], v[16:17] op_sel:[0,0] op_sel_hi:[0,1]
  v_pk_fma_f32 v[24:25], v[22:23], v[16:17], v[24:25] op_sel:[1,1,0] op_sel_hi:[1,0,1] neg_lo:[1,0,0]
  v_cvt_pk_bf16_f32 v42, v40, -v41
  ds_write2st64_b32 v50, v63, v42 offset0:4 offset1:5
  v_pk_mul_f32 v[38:39], v[40:41], v[30:31] op_sel:[0,0] op_sel_hi:[0,1]
  v_pk_fma_f32 v[38:39], v[40:41], v[30:31], v[38:39] op_sel:[1,1,0] op_sel_hi:[1,0,1] neg_lo:[1,0,0]
  v_pk_mul_f32 v[26:27], v[24:25], v[16:17] op_sel:[0,0] op_sel_hi:[0,1]
  v_pk_fma_f32 v[26:27], v[24:25], v[16:17], v[26:27] op_sel:[1,1,0] op_sel_hi:[1,0,1] neg_lo:[1,0,0]
  v_cvt_pk_bf16_f32 v43, v38, -v39
  v_pk_mul_f32 v[40:41], v[38:39], v[30:31] op_sel:[0,0] op_sel_hi:[0,1]
  v_pk_fma_f32 v[40:41], v[38:39], v[30:31], v[40:41] op_sel:[1,1,0] op_sel_hi:[1,0,1] neg_lo:[1,0,0]
  v_pk_mul_f32 v[28:29], v[26:27], v[16:17] op_sel:[0,0] op_sel_hi:[0,1]
  v_pk_fma_f32 v[28:29], v[26:27], v[16:17], v[28:29] op_sel:[1,1,0] op_sel_hi:[1,0,1] neg_lo:[1,0,0]
  v_cvt_pk_bf16_f32 v62, v40, -v41
  ds_write2st64_b32 v51, v43, v62 offset0:6 offset1:7
  v_pk_mul_f32 v[38:39], v[40:41], v[30:31] op_sel:[0,0] op_sel_hi:[0,1]
  v_pk_fma_f32 v[38:39], v[40:41], v[30:31], v[38:39] op_sel:[1,1,0] op_sel_hi:[1,0,1] neg_lo:[1,0,0]
  v_cvt_pk_bf16_f32 v63, v38, -v39
  v_pk_mul_f32 v[40:41], v[38:39], v[30:31] op_sel:[0,0] op_sel_hi:[0,1]
  v_pk_fma_f32 v[40:41], v[38:39], v[30:31], v[40:41] op_sel:[1,1,0] op_sel_hi:[1,0,1] neg_lo:[1,0,0]
  v_cvt_pk_bf16_f32 v42, v40, -v41
  ds_write2st64_b32 v52, v63, v42 offset0:8 offset1:9
  v_pk_mul_f32 v[38:39], v[40:41], v[30:31] op_sel:[0,0] op_sel_hi:[0,1]
  v_pk_fma_f32 v[38:39], v[40:41], v[30:31], v[38:39] op_sel:[1,1,0] op_sel_hi:[1,0,1] neg_lo:[1,0,0]
  v_cvt_pk_bf16_f32 v43, v38, -v39
  v_pk_mul_f32 v[40:41], v[38:39], v[30:31] op_sel:[0,0] op_sel_hi:[0,1]
  v_pk_fma_f32 v[40:41], v[38:39], v[30:31], v[40:41] op_sel:[1,1,0] op_sel_hi:[1,0,1] neg_lo:[1,0,0]
  v_cvt_pk_bf16_f32 v62, v40, -v41
  ds_write2st64_b32 v53, v43, v62 offset0:10 offset1:11
  v_pk_mul_f32 v[38:39], v[40:41], v[30:31] op_sel:[0,0] op_sel_hi:[0,1]
  v_pk_fma_f32 v[38:39], v[40:41], v[30:31], v[38:39] op_sel:[1,1,0] op_sel_hi:[1,0,1] neg_lo:[1,0,0]
  v_cvt_pk_bf16_f32 v63, v38, -v39
  v_pk_mul_f32 v[40:41], v[38:39], v[30:31] op_sel:[0,0] op_sel_hi:[0,1]
  v_pk_fma_f32 v[40:41], v[38:39], v[30:31], v[40:41] op_sel:[1,1,0] op_sel_hi:[1,0,1] neg_lo:[1,0,0]
  v_cvt_pk_bf16_f32 v42, v40, -v41
  ds_write2st64_b32 v54, v63, v42 offset0:12 offset1:13
  v_pk_mul_f32 v[38:39], v[40:41], v[30:31] op_sel:[0,0] op_sel_hi:[0,1]
  v_pk_fma_f32 v[38:39], v[40:41], v[30:31], v[38:39] op_sel:[1,1,0] op_sel_hi:[1,0,1] neg_lo:[1,0,0]
  v_cvt_pk_bf16_f32 v43, v38, -v39
  v_pk_mul_f32 v[40:41], v[38:39], v[30:31] op_sel:[0,0] op_sel_hi:[0,1]
  v_pk_fma_f32 v[40:41], v[38:39], v[30:31], v[40:41] op_sel:[1,1,0] op_sel_hi:[1,0,1] neg_lo:[1,0,0]
  v_cvt_pk_bf16_f32 v62, v40, -v41
  ds_write2st64_b32 v55, v43, v62 offset0:14 offset1:15
  ds_read_b128 v[64:67], v44 offset:0
  ds_read_b128 v[68:71], v45 offset:0
  ds_read_b128 v[72:75], v46 offset:0
  ds_read_b128 v[76:79], v47 offset:0
  v_pk_mul_f32 v[36:37], v[34:35], v[32:33] op_sel:[0,0] op_sel_hi:[0,1]
  v_pk_fma_f32 v[36:37], v[34:35], v[32:33], v[36:37] op_sel:[1,1,0] op_sel_hi:[1,0,1] neg_lo:[1,0,0]
  v_cvt_pk_bf16_f32 v63, v34, v35
  v_pk_mul_f32 v[38:39], v[34:35], v[16:17] op_sel:[0,0] op_sel_hi:[0,1]
  v_pk_fma_f32 v[38:39], v[34:35], v[16:17], v[38:39] op_sel:[1,1,0] op_sel_hi:[1,0,1] neg_lo:[1,0,0]
  v_cvt_pk_bf16_f32 v42, v38, v39
  ds_write2st64_b32 v48, v63, v42 offset0:16 offset1:17
  v_pk_mul_f32 v[40:41], v[34:35], v[18:19] op_sel:[0,0] op_sel_hi:[0,1]
  v_pk_fma_f32 v[40:41], v[34:35], v[18:19], v[40:41] op_sel:[1,1,0] op_sel_hi:[1,0,1] neg_lo:[1,0,0]
  v_cvt_pk_bf16_f32 v43, v40, v41
  v_pk_mul_f32 v[38:39], v[34:35], v[20:21] op_sel:[0,0] op_sel_hi:[0,1]
  v_pk_fma_f32 v[38:39], v[34:35], v[20:21], v[38:39] op_sel:[1,1,0] op_sel_hi:[1,0,1] neg_lo:[1,0,0]
  v_cvt_pk_bf16_f32 v62, v38, v39
  ds_write2st64_b32 v49, v43, v62 offset0:18 offset1:19
  v_pk_mul_f32 v[40:41], v[34:35], v[22:23] op_sel:[0,0] op_sel_hi:[0,1]
  v_pk_fma_f32 v[40:41], v[34:35], v[22:23], v[40:41] op_sel:[1,1,0] op_sel_hi:[1,0,1] neg_lo:[1,0,0]
  v_cvt_pk_bf16_f32 v63, v40, v41
  v_pk_mul_f32 v[38:39], v[34:35], v[24:25] op_sel:[0,0] op_sel_hi:[0,1]
  v_pk_fma_f32 v[38:39], v[34:35], v[24:25], v[38:39] op_sel:[1,1,0] op_sel_hi:[1,0,1] neg_lo:[1,0,0]
  v_cvt_pk_bf16_f32 v42, v38, v39
  ds_write2st64_b32 v50, v63, v42 offset0:20 offset1:21
  v_pk_mul_f32 v[40:41], v[34:35], v[26:27] op_sel:[0,0] op_sel_hi:[0,1]
  v_pk_fma_f32 v[40:41], v[34:35], v[26:27], v[40:41] op_sel:[1,1,0] op_sel_hi:[1,0,1] neg_lo:[1,0,0]
  v_cvt_pk_bf16_f32 v43, v40, v41
  v_pk_mul_f32 v[38:39], v[34:35], v[28:29] op_sel:[0,0] op_sel_hi:[0,1]
  v_pk_fma_f32 v[38:39], v[34:35], v[28:29], v[38:39] op_sel:[1,1,0] op_sel_hi:[1,0,1] neg_lo:[1,0,0]
  v_cvt_pk_bf16_f32 v62, v38, v39
  ds_write2st64_b32 v51, v43, v62 offset0:22 offset1:23
  v_cvt_pk_bf16_f32 v63, v36, v37
  v_pk_mul_f32 v[40:41], v[36:37], v[16:17] op_sel:[0,0] op_sel_hi:[0,1]
  v_pk_fma_f32 v[40:41], v[36:37], v[16:17], v[40:41] op_sel:[1,1,0] op_sel_hi:[1,0,1] neg_lo:[1,0,0]
  v_cvt_pk_bf16_f32 v42, v40, v41
  ds_write2st64_b32 v52, v63, v42 offset0:24 offset1:25
  v_pk_mul_f32 v[38:39], v[36:37], v[18:19] op_sel:[0,0] op_sel_hi:[0,1]
  v_pk_fma_f32 v[38:39], v[36:37], v[18:19], v[38:39] op_sel:[1,1,0] op_sel_hi:[1,0,1] neg_lo:[1,0,0]
  v_cvt_pk_bf16_f32 v43, v38, v39
  v_pk_mul_f32 v[40:41], v[36:37], v[20:21] op_sel:[0,0] op_sel_hi:[0,1]
  v_pk_fma_f32 v[40:41], v[36:37], v[20:21], v[40:41] op_sel:[1,1,0] op_sel_hi:[1,0,1] neg_lo:[1,0,0]
  v_cvt_pk_bf16_f32 v62, v40, v41
  ds_write2st64_b32 v53, v43, v62 offset0:26 offset1:27
  v_pk_mul_f32 v[38:39], v[36:37], v[22:23] op_sel:[0,0] op_sel_hi:[0,1]
  v_pk_fma_f32 v[38:39], v[36:37], v[22:23], v[38:39] op_sel:[1,1,0] op_sel_hi:[1,0,1] neg_lo:[1,0,0]
  v_cvt_pk_bf16_f32 v63, v38, v39
  v_pk_mul_f32 v[40:41], v[36:37], v[24:25] op_sel:[0,0] op_sel_hi:[0,1]
  v_pk_fma_f32 v[40:41], v[36:37], v[24:25], v[40:41] op_sel:[1,1,0] op_sel_hi:[1,0,1] neg_lo:[1,0,0]
  v_cvt_pk_bf16_f32 v42, v40, v41
  ds_write2st64_b32 v54, v63, v42 offset0:28 offset1:29
  v_pk_mul_f32 v[38:39], v[36:37], v[26:27] op_sel:[0,0] op_sel_hi:[0,1]
  v_pk_fma_f32 v[38:39], v[36:37], v[26:27], v[38:39] op_sel:[1,1,0] op_sel_hi:[1,0,1] neg_lo:[1,0,0]
  v_cvt_pk_bf16_f32 v43, v38, v39
  v_pk_mul_f32 v[40:41], v[36:37], v[28:29] op_sel:[0,0] op_sel_hi:[0,1]
  v_pk_fma_f32 v[40:41], v[36:37], v[28:29], v[40:41] op_sel:[1,1,0] op_sel_hi:[1,0,1] neg_lo:[1,0,0]
  v_cvt_pk_bf16_f32 v62, v40, v41
  ds_write2st64_b32 v55, v43, v62 offset0:30 offset1:31
  ds_read_b128 v[80:83], v44 offset:4096
  ds_read_b128 v[84:87], v45 offset:4096
  ds_read_b128 v[88:91], v46 offset:4096
  ds_read_b128 v[92:95], v47 offset:4096
  v_pk_mul_f32 v[34:35], v[36:37], v[32:33] op_sel:[0,0] op_sel_hi:[0,1]
  v_pk_fma_f32 v[34:35], v[36:37], v[32:33], v[34:35] op_sel:[1,1,0] op_sel_hi:[1,0,1] neg_lo:[1,0,0]
  s_waitcnt lgkmcnt(0)
  v_mfma_f32_16x16x32_bf16 v[96:99], v[80:83], v[64:67], 0
  v_mfma_f32_16x16x32_bf16 v[96:99], v[84:87], v[68:71], v[96:99]
  v_mfma_f32_16x16x32_bf16 v[96:99], v[88:91], v[72:75], v[96:99]
  v_mfma_f32_16x16x32_bf16 v[96:99], v[92:95], v[76:79], v[96:99]
  v_pk_mul_f32 v[36:37], v[34:35], v[32:33] op_sel:[0,0] op_sel_hi:[0,1]
  v_pk_fma_f32 v[36:37], v[34:35], v[32:33], v[36:37] op_sel:[1,1,0] op_sel_hi:[1,0,1] neg_lo:[1,0,0]
  v_cvt_pk_bf16_f32 v63, v34, v35
  v_pk_mul_f32 v[38:39], v[34:35], v[18:19] op_sel:[0,0] op_sel_hi:[0,1]
  v_pk_fma_f32 v[38:39], v[34:35], v[18:19], v[38:39] op_sel:[1,1,0] op_sel_hi:[1,0,1] neg_lo:[1,0,0]
  v_cvt_pk_bf16_f32 v42, v38, v39
  ds_write2st64_b32 v48, v63, v42 offset0:16 offset1:17
  v_pk_mul_f32 v[40:41], v[34:35], v[22:23] op_sel:[0,0] op_sel_hi:[0,1]
  v_pk_fma_f32 v[40:41], v[34:35], v[22:23], v[40:41] op_sel:[1,1,0] op_sel_hi:[1,0,1] neg_lo:[1,0,0]
  v_cvt_pk_bf16_f32 v43, v40, v41
  v_pk_mul_f32 v[38:39], v[34:35], v[26:27] op_sel:[0,0] op_sel_hi:[0,1]
  v_pk_fma_f32 v[38:39], v[34:35], v[26:27], v[38:39] op_sel:[1,1,0] op_sel_hi:[1,0,1] neg_lo:[1,0,0]
  v_cvt_pk_bf16_f32 v62, v38, v39
  ds_write2st64_b32 v49, v43, v62 offset0:18 offset1:19
  v_cvt_pk_bf16_f32 v63, v36, v37
  v_pk_mul_f32 v[40:41], v[36:37], v[18:19] op_sel:[0,0] op_sel_hi:[0,1]
  v_pk_fma_f32 v[40:41], v[36:37], v[18:19], v[40:41] op_sel:[1,1,0] op_sel_hi:[1,0,1] neg_lo:[1,0,0]
  v_cvt_pk_bf16_f32 v42, v40, v41
  ds_write2st64_b32 v50, v63, v42 offset0:20 offset1:21
  v_pk_mul_f32 v[38:39], v[36:37], v[22:23] op_sel:[0,0] op_sel_hi:[0,1]
  v_pk_fma_f32 v[38:39], v[36:37], v[22:23], v[38:39] op_sel:[1,1,0] op_sel_hi:[1,0,1] neg_lo:[1,0,0]
  v_cvt_pk_bf16_f32 v43, v38, v39
  v_pk_mul_f32 v[40:41], v[36:37], v[26:27] op_sel:[0,0] op_sel_hi:[0,1]
  v_pk_fma_f32 v[40:41], v[36:37], v[26:27], v[40:41] op_sel:[1,1,0] op_sel_hi:[1,0,1] neg_lo:[1,0,0]
  v_cvt_pk_bf16_f32 v62, v40, v41
  ds_write2st64_b32 v51, v43, v62 offset0:22 offset1:23
  v_pk_mul_f32 v[34:35], v[36:37], v[32:33] op_sel:[0,0] op_sel_hi:[0,1]
  v_pk_fma_f32 v[34:35], v[36:37], v[32:33], v[34:35] op_sel:[1,1,0] op_sel_hi:[1,0,1] neg_lo:[1,0,0]
  v_cvt_pk_bf16_f32 v63, v34, v35
  v_pk_mul_f32 v[38:39], v[34:35], v[22:23] op_sel:[0,0] op_sel_hi:[0,1]
  v_pk_fma_f32 v[38:39], v[34:35], v[22:23], v[38:39] op_sel:[1,1,0] op_sel_hi:[1,0,1] neg_lo:[1,0,0]
  v_cvt_pk_bf16_f32 v42, v38, v39
  ds_write2st64_b32 v52, v63, v42 offset0:24 offset1:25
  v_pk_mul_f32 v[36:37], v[34:35], v[32:33] op_sel:[0,0] op_sel_hi:[0,1]
  v_pk_fma_f32 v[36:37], v[34:35], v[32:33], v[36:37] op_sel:[1,1,0] op_sel_hi:[1,0,1] neg_lo:[1,0,0]
  v_cvt_pk_bf16_f32 v43, v36, v37
  v_pk_mul_f32 v[40:41], v[36:37], v[22:23] op_sel:[0,0] op_sel_hi:[0,1]
  v_pk_fma_f32 v[40:41], v[36:37], v[22:23], v[40:41] op_sel:[1,1,0] op_sel_hi:[1,0,1] neg_lo:[1,0,0]
  v_cvt_pk_bf16_f32 v62, v40, v41
  ds_write2st64_b32 v53, v43, v62 offset0:26 offset1:27
  v_pk_mul_f32 v[34:35], v[36:37], v[32:33] op_sel:[0,0] op_sel_hi:[0,1]
  v_pk_fma_f32 v[34:35], v[36:37], v[32:33], v[34:35] op_sel:[1,1,0] op_sel_hi:[1,0,1] neg_lo:[1,0,0]
  v_cvt_pk_bf16_f32 v63, v34, v35
  v_pk_mul_f32 v[38:39], v[34:35], v[22:23] op_sel:[0,0] op_sel_hi:[0,1]
  v_pk_fma_f32 v[38:39], v[34:35], v[22:23], v[38:39] op_sel:[1,1,0] op_sel_hi:[1,0,1] neg_lo:[1,0,0]
  v_cvt_pk_bf16_f32 v42, v38, v39
  ds_write2st64_b32 v54, v63, v42 offset0:28 offset1:29
  v_pk_mul_f32 v[36:37], v[34:35], v[32:33] op_sel:[0,0] op_sel_hi:[0,1]
  v_pk_fma_f32 v[36:37], v[34:35], v[32:33], v[36:37] op_sel:[1,1,0] op_sel_hi:[1,0,1] neg_lo:[1,0,0]
  v_cvt_pk_bf16_f32 v43, v36, v37
  v_pk_mul_f32 v[40:41], v[36:37], v[22:23] op_sel:[0,0] op_sel_hi:[0,1]
  v_pk_fma_f32 v[40:41], v[36:37], v[22:23], v[40:41] op_sel:[1,1,0] op_sel_hi:[1,0,1] neg_lo:[1,0,0]
  v_cvt_pk_bf16_f32 v62, v40, v41
  ds_write2st64_b32 v55, v43, v62 offset0:30 offset1:31
  ds_read_b128 v[80:83], v44 offset:4096
  ds_read_b128 v[84:87], v45 offset:4096
  ds_read_b128 v[88:91], v46 offset:4096
  ds_read_b128 v[92:95], v47 offset:4096
  v_pk_mul_f32 v[34:35], v[36:37], v[32:33] op_sel:[0,0] op_sel_hi:[0,1]
  v_pk_fma_f32 v[34:35], v[36:37], v[32:33], v[34:35] op_sel:[1,1,0] op_sel_hi:[1,0,1] neg_lo:[1,0,0]
  s_waitcnt lgkmcnt(0)
  v_mfma_f32_16x16x32_bf16 v[100:103], v[80:83], v[64:67], 0
  v_mfma_f32_16x16x32_bf16 v[100:103], v[84:87], v[68:71], v[100:103]
  v_mfma_f32_16x16x32_bf16 v[100:103], v[88:91], v[72:75], v[100:103]
  v_mfma_f32_16x16x32_bf16 v[100:103], v[92:95], v[76:79], v[100:103]
  v_cvt_pk_bf16_f32 v63, v34, v35
  v_pk_mul_f32 v[36:37], v[34:35], v[32:33] op_sel:[0,0] op_sel_hi:[0,1]
  v_pk_fma_f32 v[36:37], v[34:35], v[32:33], v[36:37] op_sel:[1,1,0] op_sel_hi:[1,0,1] neg_lo:[1,0,0]
  v_cvt_pk_bf16_f32 v42, v36, v37
  ds_write2st64_b32 v48, v63, v42 offset0:16 offset1:17
  v_pk_mul_f32 v[34:35], v[36:37], v[32:33] op_sel:[0,0] op_sel_hi:[0,1]
  v_pk_fma_f32 v[34:35], v[36:37], v[32:33], v[34:35] op_sel:[1,1,0] op_sel_hi:[1,0,1] neg_lo:[1,0,0]
  v_cvt_pk_bf16_f32 v43, v34, v35
  v_pk_mul_f32 v[36:37], v[34:35], v[32:33] op_sel:[0,0] op_sel_hi:[0,1]
  v_pk_fma_f32 v[36:37], v[34:35], v[32:33], v[36:37] op_sel:[1,1,0] op_sel_hi:[1,0,1] neg_lo:[1,0,0]
  v_cvt_pk_bf16_f32 v62, v36, v37
  ds_write2st64_b32 v49, v43, v62 offset0:18 offset1:19
  v_pk_mul_f32 v[34:35], v[36:37], v[32:33] op_sel:[0,0] op_sel_hi:[0,1]
  v_pk_fma_f32 v[34:35], v[36:37], v[32:33], v[34:35] op_sel:[1,1,0] op_sel_hi:[1,0,1] neg_lo:[1,0,0]
  v_cvt_pk_bf16_f32 v63, v34, v35
  v_pk_mul_f32 v[36:37], v[34:35], v[32:33] op_sel:[0,0] op_sel_hi:[0,1]
  v_pk_fma_f32 v[36:37], v[34:35], v[32:33], v[36:37] op_sel:[1,1,0] op_sel_hi:[1,0,1] neg_lo:[1,0,0]
  v_cvt_pk_bf16_f32 v42, v36, v37
  ds_write2st64_b32 v50, v63, v42 offset0:20 offset1:21
  v_pk_mul_f32 v[34:35], v[36:37], v[32:33] op_sel:[0,0] op_sel_hi:[0,1]
  v_pk_fma_f32 v[34:35], v[36:37], v[32:33], v[34:35] op_sel:[1,1,0] op_sel_hi:[1,0,1] neg_lo:[1,0,0]
  v_cvt_pk_bf16_f32 v43, v34, v35
  v_pk_mul_f32 v[36:37], v[34:35], v[32:33] op_sel:[0,0] op_sel_hi:[0,1]
  v_pk_fma_f32 v[36:37], v[34:35], v[32:33], v[36:37] op_sel:[1,1,0] op_sel_hi:[1,0,1] neg_lo:[1,0,0]
  v_cvt_pk_bf16_f32 v62, v36, v37
  ds_write2st64_b32 v51, v43, v62 offset0:22 offset1:23
  v_pk_mul_f32 v[34:35], v[36:37], v[32:33] op_sel:[0,0] op_sel_hi:[0,1]
  v_pk_fma_f32 v[34:35], v[36:37], v[32:33], v[34:35] op_sel:[1,1,0] op_sel_hi:[1,0,1] neg_lo:[1,0,0]
  v_cvt_pk_bf16_f32 v63, v34, v35
  ds_write_b32 v52, v63 offset:6144
  ds_read_b128 v[80:83], v44 offset:4096
  ds_read_b128 v[84:87], v45 offset:4096
  ds_read_b128 v[88:91], v46 offset:4096
  ds_read_b128 v[92:95], v47 offset:4096
  s_waitcnt lgkmcnt(0)
  v_mfma_f32_16x16x32_bf16 v[104:107], v[80:83], v[64:67], 0
  v_mfma_f32_16x16x32_bf16 v[104:107], v[84:87], v[68:71], v[104:107]
  v_mfma_f32_16x16x32_bf16 v[104:107], v[88:91], v[72:75], v[104:107]
  v_mfma_f32_16x16x32_bf16 v[104:107], v[92:95], v[76:79], v[104:107]
  v_and_b32 v10, 15, v0
  v_lshrrev_b32 v11, 4, v0
  v_lshrrev_b32 v2, 1, v11
  v_lshlrev_b32 v2, 9, v2
  v_lshl_add_u32 v2, v10, 5, v2
  v_and_b32 v3, 1, v11
  v_lshl_add_u32 v2, v3, 4, v2
  v_add_u32 v2, s46, v2
  ds_write_b128 v2, v[96:99]
  v_lshlrev_b32 v2, 8, v11
  v_add_u32 v2, 1024, v2
  v_add_u32 v2, s46, v2
  v_lshrrev_b32 v3, 1, v11
  v_sub_u32 v4, 4, v3
  v_lshlrev_b32 v4, v4, v10
  v_add_u32 v2, v2, v4
  v_mul_u32_u24 v3, 120, v3
  v_add3_u32 v3, v2, v3, 8
  ds_write_b64 v2, v[100:101]
  ds_write_b64 v3, v[102:103]
  v_lshlrev_b32 v2, 8, v11
  v_lshl_add_u32 v2, v10, 2, v2
  v_add_u32 v2, s46, v2
  ds_write_b32 v2, v104 offset:2048
  ds_write_b32 v2, v105 offset:2112
  ds_write_b32 v2, v106 offset:2176
  ds_write_b32 v2, v107 offset:2240
  s_waitcnt lgkmcnt(0)
  s_barrier
  s_lshr_b32 s47, s3, 1
  s_lshl_b32 s47, s47, 14
  s_mul_i32 s50, s42, 1536
  s_add_u32 s50, s50, 9437184
  s_lshl_b32 s48, s43, 11
  s_add_u32 s47, s47, s48
  v_lshlrev_b32 v2, 5, v0
  v_add_u32 v2, s47, v2
  ds_read_b128 v[16:19], v2
  ds_read_b128 v[20:23], v2 offset:16
  ds_read_b128 v[24:27], v2 offset:8192
  ds_read_b128 v[28:31], v2 offset:8208
  s_lshl_b32 s48, s43, 10
  s_add_u32 s50, s50, s48
  v_lshlrev_b32 v4, 4, v0
  s_waitcnt vmcnt(0)
  v_lshlrev_b32 v108, 16, v108
  s_lshl_b32 s48, s43, 6
  v_add_u32 v5, s48, v0
  v_cmp_eq_u32 vcc, 0, v5
  s_nop 1
  v_cndmask_b32 v108, 0, v108, vcc
  v_cmp_gt_u32 vcc, 82, v5
  s_waitcnt lgkmcnt(0)
  v_add_f32 v16, v16, v24
  v_add_f32 v17, v17, v25
  v_add_f32 v18, v18, v26
  v_add_f32 v19, v19, v27
  v_add_f32 v20, v20, v28
  v_add_f32 v21, v21, v29
  v_add_f32 v22, v22, v30
  v_add_f32 v23, v23, v31
  v_add_f32 v16, v16, v108
  v_cvt_pk_bf16_f32 v40, v16, v17
  v_cvt_pk_bf16_f32 v41, v18, v19
  v_cvt_pk_bf16_f32 v42, v20, v21
  v_cvt_pk_bf16_f32 v43, v22, v23
  s_and_b64 exec, exec, vcc
  buffer_store_dwordx4 v[40:43], v4, s[60:63], s50 offen sc1
  s_endpgm
L_tt_u:
  s_lshl_b32 s46, s3, 13
  s_mov_b32 s54, 84148480
  s_mov_b32 s55, 117834498
  s_mov_b32 s50, 6291456
  s_mul_i32 s44, s43, 262144
  s_lshl_b32 s45, s42, 7
  s_add_u32 s44, s44, s45
  v_mov_b32 v5, s44
  s_waitcnt vmcnt(6)
  v_perm_b32 v64, v20, v16, s54
  v_perm_b32 v68, v20, v16, s55
  v_perm_b32 v72, v21, v17, s54
  v_perm_b32 v76, v21, v17, s55
  v_perm_b32 v80, v22, v18, s54
  v_perm_b32 v84, v22, v18, s55
  v_perm_b32 v88, v23, v19, s54
  v_perm_b32 v92, v23, v19, s55
  s_waitcnt vmcnt(4)
  v_perm_b32 v65, v28, v24, s54
  v_perm_b32 v69, v28, v24, s55
  v_perm_b32 v73, v29, v25, s54
  v_perm_b32 v77, v29, v25, s55
  v_perm_b32 v81, v30, v26, s54
  v_perm_b32 v85, v30, v26, s55
  v_perm_b32 v89, v31, v27, s54
  v_perm_b32 v93, v31, v27, s55
  s_waitcnt vmcnt(2)
  v_perm_b32 v66, v36, v32, s54
  v_perm_b32 v70, v36, v32, s55
  v_perm_b32 v74, v37, v33, s54
  v_perm_b32 v78, v37, v33, s55
  v_perm_b32 v82, v38, v34, s54
  v_perm_b32 v86, v38, v34, s55
  v_perm_b32 v90, v39, v35, s54
  v_perm_b32 v94, v39, v35, s55
  s_waitcnt vmcnt(0)
  v_perm_b32 v67, v44, v40, s54
  v_perm_b32 v71, v44, v40, s55
  v_perm_b32 v75, v45, v41, s54
  v_perm_b32 v79, v45, v41, s55
  v_perm_b32 v83, v46, v42, s54
  v_perm_b32 v87, v46, v42, s55
  v_perm_b32 v91, v47, v43, s54
  v_perm_b32 v95, v47, v43, s55
  v_and_b32 v2, 7, v0
  v_lshrrev_b32 v3, 3, v0
  v_xor_b32 v4, v2, v3
  v_lshlrev_b32 v4, 4, v4
  v_lshl_add_u32 v4, v2, 10, v4
  v_add_u32 v4, s46, v4
  ds_write_b128 v4, v[64:67] offset:0
  ds_write_b128 v4, v[68:71] offset:128
  ds_write_b128 v4, v[72:75] offset:256
  ds_write_b128 v4, v[76:79] offset:384
  ds_write_b128 v4, v[80:83] offset:512
  ds_write_b128 v4, v[84:87] offset:640
  ds_write_b128 v4, v[88:91] offset:768
  ds_write_b128 v4, v[92:95] offset:896
  v_lshlrev_b32 v6, 7, v3
  v_lshl_add_u32 v6, v2, 4, v6
  v_add_u32 v6, s46, v6
  v_mul_u32_u24 v7, 4096, v3
  v_lshl_add_u32 v7, v2, 4, v7
  v_add_u32 v7, v5, v7
  v_mov_b32 v8, v6
  ds_read_b128 v[16:19], v8 offset:0
  v_xor_b32 v8, 16, v6
  ds_read_b128 v[20:23], v8 offset:1024
  v_xor_b32 v8, 32, v6
  ds_read_b128 v[24:27], v8 offset:2048
  v_xor_b32 v8, 48, v6
  ds_read_b128 v[28:31], v8 offset:3072
  v_xor_b32 v8, 64, v6
  ds_read_b128 v[32:35], v8 offset:4096
  v_xor_b32 v8, 80, v6
  ds_read_b128 v[36:39], v8 offset:5120
  v_xor_b32 v8, 96, v6
  ds_read_b128 v[40:43], v8 offset:6144
  v_xor_b32 v8, 112, v6
  ds_read_b128 v[44:47], v8 offset:7168
  s_waitcnt lgkmcnt(7)
  buffer_store_dwordx4 v[16:19], v7, s[60:63], s50 offen sc1
  v_add_u32 v7, 32768, v7
  s_waitcnt lgkmcnt(6)
  buffer_store_dwordx4 v[20:23], v7, s[60:63], s50 offen sc1
  v_add_u32 v7, 32768, v7
  s_waitcnt lgkmcnt(5)
  buffer_store_dwordx4 v[24:27], v7, s[60:63], s50 offen sc1
  v_add_u32 v7, 32768, v7
  s_waitcnt lgkmcnt(4)
  buffer_store_dwordx4 v[28:31], v7, s[60:63], s50 offen sc1
  v_add_u32 v7, 32768, v7
  s_waitcnt lgkmcnt(3)
  buffer_store_dwordx4 v[32:35], v7, s[60:63], s50 offen sc1
  v_add_u32 v7, 32768, v7
  s_waitcnt lgkmcnt(2)
  buffer_store_dwordx4 v[36:39], v7, s[60:63], s50 offen sc1
  v_add_u32 v7, 32768, v7
  s_waitcnt lgkmcnt(1)
  buffer_store_dwordx4 v[40:43], v7, s[60:63], s50 offen sc1
  v_add_u32 v7, 32768, v7
  s_waitcnt lgkmcnt(0)
  buffer_store_dwordx4 v[44:47], v7, s[60:63], s50 offen sc1
  s_endpgm
L_tt_w:
  s_lshl_b32 s46, s3, 13
  s_mov_b32 s54, 84148480
  s_mov_b32 s55, 117834498
  s_mov_b32 s50, 3145728
  s_mul_i32 s44, s43, 524288
  s_lshl_b32 s45, s42, 7
  s_add_u32 s44, s44, s45
  v_mov_b32 v5, s44
  s_waitcnt vmcnt(6)
  v_perm_b32 v64, v32, v16, s54
  v_perm_b32 v68, v32, v16, s55
  v_perm_b32 v72, v33, v17, s54
  v_perm_b32 v76, v33, v17, s55
  v_perm_b32 v80, v34, v18, s54
  v_perm_b32 v84, v34, v18, s55
  v_perm_b32 v88, v35, v19, s54
  v_perm_b32 v92, v35, v19, s55
  s_waitcnt vmcnt(4)
  v_perm_b32 v65, v36, v20, s54
  v_perm_b32 v69, v36, v20, s55
  v_perm_b32 v73, v37, v21, s54
  v_perm_b32 v77, v37, v21, s55
  v_perm_b32 v81, v38, v22, s54
  v_perm_b32 v85, v38, v22, s55
  v_perm_b32 v89, v39, v23, s54
  v_perm_b32 v93, v39, v23, s55
  s_waitcnt vmcnt(2)
  v_perm_b32 v66, v40, v24, s54
  v_perm_b32 v70, v40, v24, s55
  v_perm_b32 v74, v41, v25, s54
  v_perm_b32 v78, v41, v25, s55
  v_perm_b32 v82, v42, v26, s54
  v_perm_b32 v86, v42, v26, s55
  v_perm_b32 v90, v43, v27, s54
  v_perm_b32 v94, v43, v27, s55
  s_waitcnt vmcnt(0)
  v_perm_b32 v67, v44, v28, s54
  v_perm_b32 v71, v44, v28, s55
  v_perm_b32 v75, v45, v29, s54
  v_perm_b32 v79, v45, v29, s55
  v_perm_b32 v83, v46, v30, s54
  v_perm_b32 v87, v46, v30, s55
  v_perm_b32 v91, v47, v31, s54
  v_perm_b32 v95, v47, v31, s55
  v_and_b32 v2, 7, v0
  v_lshrrev_b32 v3, 3, v0
  v_xor_b32 v4, v2, v3
  v_lshlrev_b32 v4, 4, v4
  v_lshl_add_u32 v4, v2, 10, v4
  v_add_u32 v4, s46, v4
  ds_write_b128 v4, v[64:67] offset:0
  ds_write_b128 v4, v[68:71] offset:128
  ds_write_b128 v4, v[72:75] offset:256
  ds_write_b128 v4, v[76:79] offset:384
  ds_write_b128 v4, v[80:83] offset:512
  ds_write_b128 v4, v[84:87] offset:640
  ds_write_b128 v4, v[88:91] offset:768
  ds_write_b128 v4, v[92:95] offset:896
  v_lshlrev_b32 v6, 7, v3
  v_lshl_add_u32 v6, v2, 4, v6
  v_add_u32 v6, s46, v6
  v_mul_u32_u24 v7, 8192, v3
  v_lshl_add_u32 v7, v2, 4, v7
  v_add_u32 v7, v5, v7
  v_mov_b32 v8, v6
  ds_read_b128 v[16:19], v8 offset:0
  v_xor_b32 v8, 16, v6
  ds_read_b128 v[20:23], v8 offset:1024
  v_xor_b32 v8, 32, v6
  ds_read_b128 v[24:27], v8 offset:2048
  v_xor_b32 v8, 48, v6
  ds_read_b128 v[28:31], v8 offset:3072
  v_xor_b32 v8, 64, v6
  ds_read_b128 v[32:35], v8 offset:4096
  v_xor_b32 v8, 80, v6
  ds_read_b128 v[36:39], v8 offset:5120
  v_xor_b32 v8, 96, v6
  ds_read_b128 v[40:43], v8 offset:6144
  v_xor_b32 v8, 112, v6
  ds_read_b128 v[44:47], v8 offset:7168
  s_waitcnt lgkmcnt(7)
  buffer_store_dwordx4 v[16:19], v7, s[60:63], s50 offen sc1
  v_add_u32 v7, 65536, v7
  s_waitcnt lgkmcnt(6)
  buffer_store_dwordx4 v[20:23], v7, s[60:63], s50 offen sc1
  v_add_u32 v7, 65536, v7
  s_waitcnt lgkmcnt(5)
  buffer_store_dwordx4 v[24:27], v7, s[60:63], s50 offen sc1
  v_add_u32 v7, 65536, v7
  s_waitcnt lgkmcnt(4)
  buffer_store_dwordx4 v[28:31], v7, s[60:63], s50 offen sc1
  v_add_u32 v7, 65536, v7
  s_waitcnt lgkmcnt(3)
  buffer_store_dwordx4 v[32:35], v7, s[60:63], s50 offen sc1
  v_add_u32 v7, 65536, v7
  s_waitcnt lgkmcnt(2)
  buffer_store_dwordx4 v[36:39], v7, s[60:63], s50 offen sc1
  v_add_u32 v7, 65536, v7
  s_waitcnt lgkmcnt(1)
  buffer_store_dwordx4 v[40:43], v7, s[60:63], s50 offen sc1
  v_add_u32 v7, 65536, v7
  s_waitcnt lgkmcnt(0)
  buffer_store_dwordx4 v[44:47], v7, s[60:63], s50 offen sc1
  s_endpgm
L_tt_w5:
  s_lshl_b32 s46, s3, 13
  s_mov_b32 s54, 84148480
  s_mov_b32 s55, 117834498
  s_mov_b32 s50, 3145728
  s_mul_i32 s44, s43, 524288
  s_lshl_b32 s45, s42, 7
  s_add_u32 s44, s44, s45
  v_mov_b32 v5, s44
  s_waitcnt vmcnt(0)
  v_perm_b32 v64, v32, v16, s54
  v_perm_b32 v65, v36, v20, s54
  v_perm_b32 v66, v40, v24, s54
  v_perm_b32 v67, v44, v28, s54
  v_mov_b32 v68, 0
  v_mov_b32 v69, 0
  v_mov_b32 v70, 0
  v_mov_b32 v71, 0
  v_mov_b32 v72, 0
  v_mov_b32 v73, 0
  v_mov_b32 v74, 0
  v_mov_b32 v75, 0
  v_mov_b32 v76, 0
  v_mov_b32 v77, 0
  v_mov_b32 v78, 0
  v_mov_b32 v79, 0
  v_mov_b32 v80, 0
  v_mov_b32 v81, 0
  v_mov_b32 v82, 0
  v_mov_b32 v83, 0
  v_mov_b32 v84, 0
  v_mov_b32 v85, 0
  v_mov_b32 v86, 0
  v_mov_b32 v87, 0
  v_mov_b32 v88, 0
  v_mov_b32 v89, 0
  v_mov_b32 v90, 0
  v_mov_b32 v91, 0
  v_mov_b32 v92, 0
  v_mov_b32 v93, 0
  v_mov_b32 v94, 0
  v_mov_b32 v95, 0
  v_and_b32 v2, 7, v0
  v_lshrrev_b32 v3, 3, v0
  v_xor_b32 v4, v2, v3
  v_lshlrev_b32 v4, 4, v4
  v_lshl_add_u32 v4, v2, 10, v4
  v_add_u32 v4, s46, v4
  ds_write_b128 v4, v[64:67] offset:0
  ds_write_b128 v4, v[68:71] offset:128
  ds_write_b128 v4, v[72:75] offset:256
  ds_write_b128 v4, v[76:79] offset:384
  ds_write_b128 v4, v[80:83] offset:512
  ds_write_b128 v4, v[84:87] offset:640
  ds_write_b128 v4, v[88:91] offset:768
  ds_write_b128 v4, v[92:95] offset:896
  v_lshlrev_b32 v6, 7, v3
  v_lshl_add_u32 v6, v2, 4, v6
  v_add_u32 v6, s46, v6
  v_mul_u32_u24 v7, 8192, v3
  v_lshl_add_u32 v7, v2, 4, v7
  v_add_u32 v7, v5, v7
  v_mov_b32 v8, v6
  ds_read_b128 v[16:19], v8 offset:0
  s_waitcnt lgkmcnt(0)
  buffer_store_dwordx4 v[16:19], v7, s[60:63], s50 offen sc1
  s_endpgm
L_k1_brow:
  v_and_b32 v8, 3, v0
  v_bfe_u32 v9, v0, 4, 1
  v_lshl_add_u32 v8, v9, 2, v8
  v_cmp_le_u32 vcc, 5, v8
  v_subrev_u32 v9, 5, v8
  s_nop 0
  v_cndmask_b32 v8, v8, v9, vcc
  v_bfe_u32 v9, v0, 2, 2
  v_lshrrev_b32 v10, 5, v0
  v_lshl_add_u32 v9, v10, 3, v9
  v_mul_u32_u24 v9, 40, v9
  v_lshl_add_u32 v8, v8, 3, v9
  v_add_u32 v8, s45, v8
  v_add_u32 v9, 10240, v2
  s_waitcnt vmcnt(0)
  s_barrier
  ds_read_b64_tr_b16 v[68:69], v8 offset:0
  ds_read_b64_tr_b16 v[70:71], v8 offset:160
  ds_read_b64_tr_b16 v[72:73], v8 offset:640
  ds_read_b64_tr_b16 v[74:75], v8 offset:800
  ds_read_b64_tr_b16 v[76:77], v8 offset:1280
  ds_read_b64_tr_b16 v[78:79], v8 offset:1440
  ds_read_b64_tr_b16 v[80:81], v8 offset:1920
  ds_read_b64_tr_b16 v[82:83], v8 offset:2080
  ds_read_b128 v[16:19], v9 offset:0
  ds_read_b128 v[20:23], v9 offset:1024
  ds_read_b128 v[24:27], v9 offset:2048
  ds_read_b128 v[28:31], v9 offset:3072
  ds_read_b128 v[32:35], v9 offset:4096
  ds_read_b128 v[36:39], v9 offset:5120
  ds_read_b128 v[40:43], v9 offset:6144
  ds_read_b128 v[44:47], v9 offset:7168
  ds_read_b128 v[48:51], v9 offset:8192
  ds_read_b128 v[52:55], v9 offset:9216
  ds_read_b128 v[56:59], v9 offset:10240
  ds_read_b128 v[60:63], v9 offset:11264
  ds_read_b128 v[64:67], v9 offset:12288
  s_waitcnt lgkmcnt(9)
  v_mfma_f32_32x32x16_bf16 v[84:99], v[68:71], v[16:19], 0
  v_mfma_f32_32x32x16_bf16 v[84:99], v[72:75], v[20:23], v[84:99]
  v_mfma_f32_32x32x16_bf16 v[100:115], v[68:71], v[24:27], 0
  v_mfma_f32_32x32x16_bf16 v[100:115], v[72:75], v[28:31], v[100:115]
  v_mfma_f32_32x32x16_bf16 v[116:131], v[76:79], v[16:19], 0
  v_mfma_f32_32x32x16_bf16 v[116:131], v[80:83], v[20:23], v[116:131]
  v_mfma_f32_32x32x16_bf16 v[132:147], v[76:79], v[24:27], 0
  v_mfma_f32_32x32x16_bf16 v[132:147], v[80:83], v[28:31], v[132:147]
  s_waitcnt lgkmcnt(0)
  s_nop 4
  v_mul_f32 v2, v84, v32
  s_nop 0
  v_mul_f32 v3, v100, v32
  v_fmac_f32 v2, v100, v44
  v_fma_f32 v3, -v84, v44, v3
  v_cvt_pk_bf16_f32 v68, v2, v3
  v_mul_f32 v2, v85, v33
  v_mul_f32 v3, v101, v33
  v_fmac_f32 v2, v101, v45
  v_fma_f32 v3, -v85, v45, v3
  v_cvt_pk_bf16_f32 v69, v2, v3
  v_mul_f32 v2, v86, v34
  v_mul_f32 v3, v102, v34
  v_fmac_f32 v2, v102, v46
  v_fma_f32 v3, -v86, v46, v3
  v_cvt_pk_bf16_f32 v70, v2, v3
  v_mul_f32 v2, v87, v35
  v_mul_f32 v3, v103, v35
  v_fmac_f32 v2, v103, v47
  v_fma_f32 v3, -v87, v47, v3
  v_cvt_pk_bf16_f32 v71, v2, v3
  v_mul_f32 v2, v88, v36
  v_mul_f32 v3, v104, v36
  v_fmac_f32 v2, v104, v48
  v_fma_f32 v3, -v88, v48, v3
  v_cvt_pk_bf16_f32 v72, v2, v3
  v_mul_f32 v2, v89, v37
  v_mul_f32 v3, v105, v37
  v_fmac_f32 v2, v105, v49
  v_fma_f32 v3, -v89, v49, v3
  v_cvt_pk_bf16_f32 v73, v2, v3
  v_mul_f32 v2, v90, v38
  v_mul_f32 v3, v106, v38
  v_fmac_f32 v2, v106, v50
  v_fma_f32 v3, -v90, v50, v3
  v_cvt_pk_bf16_f32 v74, v2, v3
  v_mul_f32 v2, v91, v39
  v_mul_f32 v3, v107, v39
  v_fmac_f32 v2, v107, v51
  v_fma_f32 v3, -v91, v51, v3
  v_cvt_pk_bf16_f32 v75, v2, v3
  v_mul_f32 v2, v92, v40
  v_mul_f32 v3, v108, v40
  v_fmac_f32 v2, v108, v52
  v_fma_f32 v3, -v92, v52, v3
  v_cvt_pk_bf16_f32 v76, v2, v3
  v_mul_f32 v2, v93, v41
  v_mul_f32 v3, v109, v41
  v_fmac_f32 v2, v109, v53
  v_fma_f32 v3, -v93, v53, v3
  v_cvt_pk_bf16_f32 v77, v2, v3
  v_mul_f32 v2, v94, v42
  v_mul_f32 v3, v110, v42
  v_fmac_f32 v2, v110, v54
  v_fma_f32 v3, -v94, v54, v3
  v_cvt_pk_bf16_f32 v78, v2, v3
  v_mul_f32 v2, v95, v43
  v_mul_f32 v3, v111, v43
  v_fmac_f32 v2, v111, v55
  v_fma_f32 v3, -v95, v55, v3
  v_cvt_pk_bf16_f32 v79, v2, v3
  v_mfma_f32_32x32x16_bf16 v[84:99], v[56:59], v[68:71], 0
  v_mfma_f32_32x32x16_bf16 v[84:99], v[60:63], v[72:75], v[84:99]
  v_mfma_f32_32x32x16_bf16 v[84:99], v[64:67], v[76:79], v[84:99]
  v_mul_f32 v2, v116, v32
  v_mul_f32 v3, v132, v32
  v_fmac_f32 v2, v132, v44
  v_fma_f32 v3, -v116, v44, v3
  v_cvt_pk_bf16_f32 v148, v2, v3
  v_mul_f32 v2, v117, v33
  v_mul_f32 v3, v133, v33
  v_fmac_f32 v2, v133, v45
  v_fma_f32 v3, -v117, v45, v3
  v_cvt_pk_bf16_f32 v149, v2, v3
  v_mul_f32 v2, v118, v34
  v_mul_f32 v3, v134, v34
  v_fmac_f32 v2, v134, v46
  v_fma_f32 v3, -v118, v46, v3
  v_cvt_pk_bf16_f32 v150, v2, v3
  v_mul_f32 v2, v119, v35
  v_mul_f32 v3, v135, v35
  v_fmac_f32 v2, v135, v47
  v_fma_f32 v3, -v119, v47, v3
  v_cvt_pk_bf16_f32 v151, v2, v3
  v_mul_f32 v2, v120, v36
  v_mul_f32 v3, v136, v36
  v_fmac_f32 v2, v136, v48
  v_fma_f32 v3, -v120, v48, v3
  v_cvt_pk_bf16_f32 v152, v2, v3
  v_mul_f32 v2, v121, v37
  v_mul_f32 v3, v137, v37
  v_fmac_f32 v2, v137, v49
  v_fma_f32 v3, -v121, v49, v3
  v_cvt_pk_bf16_f32 v153, v2, v3
  v_mul_f32 v2, v122, v38
  v_mul_f32 v3, v138, v38
  v_fmac_f32 v2, v138, v50
  v_fma_f32 v3, -v122, v50, v3
  v_cvt_pk_bf16_f32 v154, v2, v3
  v_mul_f32 v2, v123, v39
  v_mul_f32 v3, v139, v39
  v_fmac_f32 v2, v139, v51
  v_fma_f32 v3, -v123, v51, v3
  v_cvt_pk_bf16_f32 v155, v2, v3
  v_mul_f32 v2, v124, v40
  v_mul_f32 v3, v140, v40
  v_fmac_f32 v2, v140, v52
  v_fma_f32 v3, -v124, v52, v3
  v_cvt_pk_bf16_f32 v156, v2, v3
  v_mul_f32 v2, v125, v41
  v_mul_f32 v3, v141, v41
  v_fmac_f32 v2, v141, v53
  v_fma_f32 v3, -v125, v53, v3
  v_cvt_pk_bf16_f32 v157, v2, v3
  v_mul_f32 v2, v126, v42
  v_mul_f32 v3, v142, v42
  v_fmac_f32 v2, v142, v54
  v_fma_f32 v3, -v126, v54, v3
  v_cvt_pk_bf16_f32 v158, v2, v3
  v_mul_f32 v2, v127, v43
  v_mul_f32 v3, v143, v43
  v_fmac_f32 v2, v143, v55
  v_fma_f32 v3, -v127, v55, v3
  v_cvt_pk_bf16_f32 v159, v2, v3
  v_mfma_f32_32x32x16_bf16 v[116:131], v[56:59], v[148:151], 0
  v_mfma_f32_32x32x16_bf16 v[116:131], v[60:63], v[152:155], v[116:131]
  v_mfma_f32_32x32x16_bf16 v[116:131], v[64:67], v[156:159], v[116:131]
  v_and_b32 v4, 31, v0
  v_lshlrev_b32 v4, 3, v4
  v_lshrrev_b32 v5, 5, v0
  v_lshl_add_u32 v4, v5, 9, v4
  s_mul_i32 s46, s3, 3072
  s_add_u32 s46, s46, 23552
  v_add_u32 v4, s46, v4
  s_nop 4
  v_cvt_pk_bf16_f32 v16, v84, v116
  v_cvt_pk_bf16_f32 v17, v85, v117
  v_cvt_pk_bf16_f32 v18, v86, v118
  v_cvt_pk_bf16_f32 v19, v87, v119
  v_cvt_pk_bf16_f32 v20, v88, v120
  v_cvt_pk_bf16_f32 v21, v89, v121
  v_cvt_pk_bf16_f32 v22, v90, v122
  v_cvt_pk_bf16_f32 v23, v91, v123
  v_cvt_pk_bf16_f32 v24, v92, v124
  v_cvt_pk_bf16_f32 v25, v93, v125
  v_cvt_pk_bf16_f32 v26, v94, v126
  v_cvt_pk_bf16_f32 v27, v95, v127
  ds_write_b64 v4, v[16:17] offset:0
  ds_write_b64 v4, v[18:19] offset:256
  ds_write_b64 v4, v[20:21] offset:1024
  ds_write_b64 v4, v[22:23] offset:1280
  ds_write_b64 v4, v[24:25] offset:2048
  ds_write_b64 v4, v[26:27] offset:2304
  s_waitcnt lgkmcnt(0)
  s_barrier
  s_lshl_b32 s46, s3, 6
  v_add_u32 v2, s46, v0
  v_lshlrev_b32 v3, 2, v2
  v_add_u32 v3, 23552, v3
  s_lshr_b32 s47, s41, 1
  s_and_b32 s47, s47, 15
  s_lshl_b32 s48, s42, 3
  v_and_b32 v4, 7, v2
  v_add_u32 v4, s48, v4
  v_xor_b32 v4, s47, v4
  v_lshlrev_b32 v4, 4, v4
  v_lshrrev_b32 v5, 3, v2
  s_mov_b32 s48, 32768
  v_mad_u32_u24 v4, v5, s48, v4
  s_lshl_b32 s48, s41, 9
  v_add_u32 v4, s48, v4
  s_mov_b32 s50, 0
  ds_read2st64_b32 v[16:17], v3 offset0:0 offset1:12
  ds_read2st64_b32 v[18:19], v3 offset0:24 offset1:36
  ds_read2st64_b32 v[20:21], v3 offset0:4 offset1:16
  ds_read2st64_b32 v[22:23], v3 offset0:28 offset1:40
  ds_read2st64_b32 v[24:25], v3 offset0:8 offset1:20
  ds_read2st64_b32 v[26:27], v3 offset0:32 offset1:44
  s_waitcnt lgkmcnt(4)
  buffer_store_dwordx4 v[16:19], v4, s[60:63], s50 offen sc1
  v_add_u32 v4, 1048576, v4
  s_waitcnt lgkmcnt(2)
  buffer_store_dwordx4 v[20:23], v4, s[60:63], s50 offen sc1
  v_add_u32 v4, 1048576, v4
  s_waitcnt lgkmcnt(0)
  v_cmp_gt_u32 vcc, 136, v2
  s_nop 3
  s_and_saveexec_b64 s[52:53], vcc
  s_cbranch_execz L_br_end
  buffer_store_dwordx4 v[24:27], v4, s[60:63], s50 offen sc1
L_br_end:
  s_endpgm
L_k1_end:
  s_endpgm
.globl k2_kernel
.type k2_kernel,@function
.set STAMP_BASE, 0x30000
.p2align 8
k2_kernel:
  s_cmp_ge_u32 s2, 241
  s_cbranch_scc1 L_k2_end
  s_load_dwordx2 s[60:61], s[0:1], 96
  s_mov_b32 s62, 20971520
  s_mov_b32 s63, 0x20000
  v_lshrrev_b32 v1, 6, v0
  v_and_b32 v0, 63, v0
  v_readfirstlane_b32 s3, v1
  s_nop 3
  s_cmp_lt_u32 s2, 81
  s_cbranch_scc0 L_k2_cstub
  s_mov_b32 s40, s2
  s_lshl_b32 s41, s40, 2
  s_add_u32 s41, s41, s3
  s_getpc_b64 s[30:31]
L_col_pc:
  s_add_u32 s30, s30, T_P2 - L_col_pc
  s_addc_u32 s31, s31, 0
  s_mov_b64 s[68:69], s[30:31]
  s_mov_b32 s70, 24576
  s_mov_b32 s71, 0x20000
  v_lshlrev_b32 v2, 4, v0
  s_lshl_b32 s45, s3, 10
  s_add_u32 s48, s45, 8192
  s_cmp_lt_u32 s3, 4
  s_cselect_b32 s48, s45, s48
  s_add_u32 m0, s48, 32768
  s_nop 0
  buffer_load_dwordx4 v2, s[68:71], s48 offen lds
  s_mul_i32 s42, s40, 32768
  s_lshl_b32 s43, s3, 12
  s_add_u32 s44, s42, s43
  s_add_u32 s44, s44, 0
  s_waitcnt lgkmcnt(0)
  s_add_u32 m0, s43, 0
  s_nop 0
  buffer_load_dwordx4 v2, s[60:63], s44 offen lds
  s_add_u32 s44, s44, 1024
  s_add_u32 m0, s43, 1024
  s_nop 0
  buffer_load_dwordx4 v2, s[60:63], s44 offen lds
  s_add_u32 s44, s44, 1024
  s_add_u32 m0, s43, 2048
  s_nop 0
  buffer_load_dwordx4 v2, s[60:63], s44 offen lds
  s_add_u32 s44, s44, 1024
  s_add_u32 m0, s43, 3072
  s_nop 0
  buffer_load_dwordx4 v2, s[60:63], s44 offen lds
  s_add_u32 m0, s45, 36864
  s_add_u32 s49, s45, 4096
  buffer_load_dwordx4 v2, s[68:71], s49 offen lds
  s_add_u32 m0, s45, 49152
  s_add_u32 s49, s45, 16384
  buffer_load_dwordx4 v2, s[68:71], s49 offen lds
  s_cmp_lt_u32 s3, 4
  s_cbranch_scc1 L_k2_col
  s_waitcnt vmcnt(6)
  s_barrier
  s_waitcnt vmcnt(2)
  s_barrier
  s_waitcnt vmcnt(0)
  s_barrier
  v_lshrrev_b32 v2, 5, v0
  v_lshlrev_b32 v2, 10, v2
  v_and_b32 v3, 31, v0
  v_lshl_add_u32 v2, v3, 4, v2
  v_mov_b32 v3, v2
  s_sub_u32 s43, s3, 4
  s_lshl_b32 s50, s43, 13
  v_add_u32 v3, s50, v3
  s_add_u32 s44, s42, s50
  s_add_u32 s44, s44, 12582912
  s_add_u32 s49, s44, 4096
  s_barrier
  ds_read_b128 v[8:11], v3 offset:0
  ds_read_b128 v[12:15], v3 offset:2048
  ds_read_b128 v[16:19], v3 offset:4096
  ds_read_b128 v[20:23], v3 offset:6144
  s_waitcnt lgkmcnt(3)
  buffer_store_dwordx4 v[8:11], v2, s[60:63], s44 offen offset:0 sc1
  s_waitcnt lgkmcnt(2)
  buffer_store_dwordx4 v[12:15], v2, s[60:63], s44 offen offset:2048 sc1
  s_waitcnt lgkmcnt(1)
  buffer_store_dwordx4 v[16:19], v2, s[60:63], s49 offen offset:0 sc1
  s_waitcnt lgkmcnt(0)
  buffer_store_dwordx4 v[20:23], v2, s[60:63], s49 offen offset:2048 sc1
  s_barrier
  s_lshl_b32 s50, s3, 12
  v_add_u32 v4, s50, v2
  s_add_u32 s44, s42, s50
  s_add_u32 s44, s44, 12583424
  ds_read_b128 v[24:27], v4 offset:512
  ds_read_b128 v[28:31], v4 offset:2560
  s_waitcnt lgkmcnt(1)
  buffer_store_dwordx4 v[24:27], v2, s[60:63], s44 offen offset:0 sc1
  s_waitcnt lgkmcnt(0)
  buffer_store_dwordx4 v[28:31], v2, s[60:63], s44 offen offset:2048 sc1
  s_endpgm
L_k2_col:
  v_and_b32 v3, 31, v0
  v_lshrrev_b32 v4, 5, v0
  v_lshlrev_b32 v5, 2, v3
  v_lshl_add_u32 v5, v4, 9, v5
  s_mul_i32 s46, s41, 8192
  s_add_u32 s46, s46, 3145728
  s_add_u32 s47, s46, 4096
  buffer_load_dword v56, v5, s[60:63], s46 offen offset:0
  buffer_load_dword v57, v5, s[60:63], s46 offen offset:128
  buffer_load_dword v58, v5, s[60:63], s46 offen offset:256
  buffer_load_dword v59, v5, s[60:63], s46 offen offset:384
  buffer_load_dword v60, v5, s[60:63], s46 offen offset:1024
  buffer_load_dword v61, v5, s[60:63], s46 offen offset:1152
  buffer_load_dword v62, v5, s[60:63], s46 offen offset:1280
  buffer_load_dword v63, v5, s[60:63], s46 offen offset:1408
  buffer_load_dword v64, v5, s[60:63], s46 offen offset:2048
  buffer_load_dword v65, v5, s[60:63], s46 offen offset:2176
  buffer_load_dword v66, v5, s[60:63], s46 offen offset:2304
  buffer_load_dword v67, v5, s[60:63], s46 offen offset:2432
  buffer_load_dword v68, v5, s[60:63], s46 offen offset:3072
  buffer_load_dword v69, v5, s[60:63], s46 offen offset:3200
  buffer_load_dword v70, v5, s[60:63], s46 offen offset:3328
  buffer_load_dword v71, v5, s[60:63], s46 offen offset:3456
  buffer_load_dword v72, v5, s[60:63], s47 offen offset:0
  buffer_load_dword v73, v5, s[60:63], s47 offen offset:128
  buffer_load_dword v74, v5, s[60:63], s47 offen offset:256
  buffer_load_dword v75, v5, s[60:63], s47 offen offset:384
  buffer_load_dword v76, v5, s[60:63], s47 offen offset:1024
  buffer_load_dword v77, v5, s[60:63], s47 offen offset:1152
  buffer_load_dword v78, v5, s[60:63], s47 offen offset:1280
  buffer_load_dword v79, v5, s[60:63], s47 offen offset:1408
  buffer_load_dword v80, v5, s[60:63], s47 offen offset:2048
  buffer_load_dword v81, v5, s[60:63], s47 offen offset:2176
  buffer_load_dword v82, v5, s[60:63], s47 offen offset:2304
  buffer_load_dword v83, v5, s[60:63], s47 offen offset:2432
  buffer_load_dword v84, v5, s[60:63], s47 offen offset:3072
  buffer_load_dword v85, v5, s[60:63], s47 offen offset:3200
  buffer_load_dword v86, v5, s[60:63], s47 offen offset:3328
  buffer_load_dword v87, v5, s[60:63], s47 offen offset:3456
  v_lshlrev_b32 v6, 3, v4
  s_lshl_b32 s48, s3, 1
  v_add_u32 v6, s48, v6
  v_and_b32 v7, 15, v3
  v_xor_b32 v6, v6, v7
  v_lshlrev_b32 v6, 4, v6
  v_lshl_add_u32 v6, v3, 10, v6
  v_mov_b32 v248, v6
  v_xor_b32 v249, 16, v6
  v_xor_b32 v250, 256, v6
  v_xor_b32 v251, 272, v6
  v_xor_b32 v252, 512, v6
  v_xor_b32 v253, 528, v6
  v_xor_b32 v254, 768, v6
  v_xor_b32 v255, 784, v6
  v_add_u32 v7, 32768, v2
  s_waitcnt vmcnt(38)
  s_barrier
  ds_read_b128 v[8:11], v7 offset:0
  ds_read_b128 v[16:19], v7 offset:2048
  ds_read_b128 v[12:15], v7 offset:1024
  ds_read_b128 v[20:23], v7 offset:3072
  ds_read_b128 v[216:219], v7 offset:12288
  ds_read_b128 v[220:223], v7 offset:13312
  ds_read_b128 v[224:227], v7 offset:14336
  ds_read_b128 v[228:231], v7 offset:15360
  s_waitcnt lgkmcnt(4)
  v_xor_b32 v24, 0x80008000, v16
  v_xor_b32 v25, 0x80008000, v17
  v_xor_b32 v26, 0x80008000, v18
  v_xor_b32 v27, 0x80008000, v19
  v_xor_b32 v28, 0x80008000, v20
  v_xor_b32 v29, 0x80008000, v21
  v_xor_b32 v30, 0x80008000, v22
  v_xor_b32 v31, 0x80008000, v23
  s_waitcnt vmcnt(34)
  s_barrier
  ds_read_b128 v[88:91], v248
  ds_read_b128 v[92:95], v249
  ds_read_b128 v[96:99], v250
  ds_read_b128 v[100:103], v251
  ds_read_b128 v[104:107], v252
  ds_read_b128 v[108:111], v253
  ds_read_b128 v[112:115], v254
  ds_read_b128 v[116:119], v255
  s_waitcnt lgkmcnt(4)
  v_mfma_f32_32x32x16_bf16 v[120:135], v[88:91], v[8:11], 0
  v_mfma_f32_32x32x16_bf16 v[136:151], v[92:95], v[8:11], 0
  v_mfma_f32_32x32x16_bf16 v[120:135], v[92:95], v[16:19], v[120:135]
  v_mfma_f32_32x32x16_bf16 v[136:151], v[88:91], v[24:27], v[136:151]
  v_mfma_f32_32x32x16_bf16 v[120:135], v[96:99], v[12:15], v[120:135]
  v_mfma_f32_32x32x16_bf16 v[136:151], v[100:103], v[12:15], v[136:151]
  v_mfma_f32_32x32x16_bf16 v[120:135], v[100:103], v[20:23], v[120:135]
  v_mfma_f32_32x32x16_bf16 v[136:151], v[96:99], v[28:31], v[136:151]
  s_waitcnt vmcnt(32) lgkmcnt(0)
  s_barrier
  ds_read_b128 v[32:35], v7 offset:4096
  ds_read_b128 v[40:43], v7 offset:6144
  ds_read_b128 v[36:39], v7 offset:5120
  ds_read_b128 v[44:47], v7 offset:7168
  v_mfma_f32_32x32x16_bf16 v[152:167], v[104:107], v[8:11], 0
  s_nop 3
  v_fma_mix_f32 v232, v120, v216, 0 op_sel_hi:[0,1,0]
  v_fma_mix_f32 v234, v136, v216, 0 op_sel_hi:[0,1,0]
  v_fma_mix_f32 v233, v121, v217, 0 op_sel_hi:[0,1,0]
  v_fma_mix_f32 v235, v137, v217, 0 op_sel_hi:[0,1,0]
  v_fma_mix_f32 v232, v136, v216, v232 op_sel:[0,1,0] op_sel_hi:[0,1,0]
  v_fma_mix_f32 v234, -v120, v216, v234 op_sel:[0,1,0] op_sel_hi:[0,1,0]
  v_fma_mix_f32 v233, v137, v217, v233 op_sel:[0,1,0] op_sel_hi:[0,1,0]
  v_mfma_f32_32x32x16_bf16 v[168:183], v[108:111], v[8:11], 0
  v_fma_mix_f32 v235, -v121, v217, v235 op_sel:[0,1,0] op_sel_hi:[0,1,0]
  v_cvt_pk_bf16_f32 v88, v232, v233
  v_cvt_pk_bf16_f32 v92, v234, v235
  v_fma_mix_f32 v240, v122, v218, 0 op_sel_hi:[0,1,0]
  v_fma_mix_f32 v242, v138, v218, 0 op_sel_hi:[0,1,0]
  v_fma_mix_f32 v241, v123, v219, 0 op_sel_hi:[0,1,0]
  v_mfma_f32_32x32x16_bf16 v[152:167], v[108:111], v[16:19], v[152:167]
  v_fma_mix_f32 v243, v139, v219, 0 op_sel_hi:[0,1,0]
  v_fma_mix_f32 v240, v138, v218, v240 op_sel:[0,1,0] op_sel_hi:[0,1,0]
  v_fma_mix_f32 v242, -v122, v218, v242 op_sel:[0,1,0] op_sel_hi:[0,1,0]
  v_fma_mix_f32 v241, v139, v219, v241 op_sel:[0,1,0] op_sel_hi:[0,1,0]
  v_fma_mix_f32 v243, -v123, v219, v243 op_sel:[0,1,0] op_sel_hi:[0,1,0]
  v_cvt_pk_bf16_f32 v89, v240, v241
  v_cvt_pk_bf16_f32 v93, v242, v243
  v_mfma_f32_32x32x16_bf16 v[168:183], v[104:107], v[24:27], v[168:183]
  v_fma_mix_f32 v232, v124, v220, 0 op_sel_hi:[0,1,0]
  v_fma_mix_f32 v234, v140, v220, 0 op_sel_hi:[0,1,0]
  v_fma_mix_f32 v233, v125, v221, 0 op_sel_hi:[0,1,0]
  v_fma_mix_f32 v235, v141, v221, 0 op_sel_hi:[0,1,0]
  v_fma_mix_f32 v232, v140, v220, v232 op_sel:[0,1,0] op_sel_hi:[0,1,0]
  v_fma_mix_f32 v234, -v124, v220, v234 op_sel:[0,1,0] op_sel_hi:[0,1,0]
  v_mfma_f32_32x32x16_bf16 v[152:167], v[112:115], v[12:15], v[152:167]
  v_fma_mix_f32 v233, v141, v221, v233 op_sel:[0,1,0] op_sel_hi:[0,1,0]
  v_fma_mix_f32 v235, -v125, v221, v235 op_sel:[0,1,0] op_sel_hi:[0,1,0]
  v_cvt_pk_bf16_f32 v90, v232, v233
  v_cvt_pk_bf16_f32 v94, v234, v235
  v_fma_mix_f32 v240, v126, v222, 0 op_sel_hi:[0,1,0]
  v_fma_mix_f32 v242, v142, v222, 0 op_sel_hi:[0,1,0]
  v_fma_mix_f32 v241, v127, v223, 0 op_sel_hi:[0,1,0]
  v_mfma_f32_32x32x16_bf16 v[168:183], v[116:119], v[12:15], v[168:183]
  v_fma_mix_f32 v243, v143, v223, 0 op_sel_hi:[0,1,0]
  v_fma_mix_f32 v240, v142, v222, v240 op_sel:[0,1,0] op_sel_hi:[0,1,0]
  v_fma_mix_f32 v242, -v126, v222, v242 op_sel:[0,1,0] op_sel_hi:[0,1,0]
  v_fma_mix_f32 v241, v143, v223, v241 op_sel:[0,1,0] op_sel_hi:[0,1,0]
  v_fma_mix_f32 v243, -v127, v223, v243 op_sel:[0,1,0] op_sel_hi:[0,1,0]
  v_cvt_pk_bf16_f32 v91, v240, v241
  v_cvt_pk_bf16_f32 v95, v242, v243
  v_mfma_f32_32x32x16_bf16 v[152:167], v[116:119], v[20:23], v[152:167]
  s_waitcnt lgkmcnt(0)
  ds_read_b128 v[216:219], v7 offset:16384
  ds_read_b128 v[220:223], v7 offset:17408
  v_fma_mix_f32 v232, v128, v224, 0 op_sel_hi:[0,1,0]
  v_fma_mix_f32 v234, v144, v224, 0 op_sel_hi:[0,1,0]
  v_fma_mix_f32 v233, v129, v225, 0 op_sel_hi:[0,1,0]
  v_mfma_f32_32x32x16_bf16 v[168:183], v[112:115], v[28:31], v[168:183]
  v_fma_mix_f32 v235, v145, v225, 0 op_sel_hi:[0,1,0]
  v_fma_mix_f32 v232, v144, v224, v232 op_sel:[0,1,0] op_sel_hi:[0,1,0]
  v_fma_mix_f32 v234, -v128, v224, v234 op_sel:[0,1,0] op_sel_hi:[0,1,0]
  v_fma_mix_f32 v233, v145, v225, v233 op_sel:[0,1,0] op_sel_hi:[0,1,0]
  v_fma_mix_f32 v235, -v129, v225, v235 op_sel:[0,1,0] op_sel_hi:[0,1,0]
  v_cvt_pk_bf16_f32 v96, v232, v233
  v_cvt_pk_bf16_f32 v100, v234, v235
  v_fma_mix_f32 v240, v130, v226, 0 op_sel_hi:[0,1,0]
  v_fma_mix_f32 v242, v146, v226, 0 op_sel_hi:[0,1,0]
  v_fma_mix_f32 v241, v131, v227, 0 op_sel_hi:[0,1,0]
  v_fma_mix_f32 v243, v147, v227, 0 op_sel_hi:[0,1,0]
  v_fma_mix_f32 v240, v146, v226, v240 op_sel:[0,1,0] op_sel_hi:[0,1,0]
  v_fma_mix_f32 v242, -v130, v226, v242 op_sel:[0,1,0] op_sel_hi:[0,1,0]
  v_fma_mix_f32 v241, v147, v227, v241 op_sel:[0,1,0] op_sel_hi:[0,1,0]
  v_fma_mix_f32 v243, -v131, v227, v243 op_sel:[0,1,0] op_sel_hi:[0,1,0]
  v_cvt_pk_bf16_f32 v97, v240, v241
  v_cvt_pk_bf16_f32 v101, v242, v243
  v_fma_mix_f32 v232, v132, v228, 0 op_sel_hi:[0,1,0]
  v_fma_mix_f32 v234, v148, v228, 0 op_sel_hi:[0,1,0]
  v_fma_mix_f32 v233, v133, v229, 0 op_sel_hi:[0,1,0]
  v_fma_mix_f32 v235, v149, v229, 0 op_sel_hi:[0,1,0]
  v_fma_mix_f32 v232, v148, v228, v232 op_sel:[0,1,0] op_sel_hi:[0,1,0]
  v_fma_mix_f32 v234, -v132, v228, v234 op_sel:[0,1,0] op_sel_hi:[0,1,0]
  v_fma_mix_f32 v233, v149, v229, v233 op_sel:[0,1,0] op_sel_hi:[0,1,0]
  v_fma_mix_f32 v235, -v133, v229, v235 op_sel:[0,1,0] op_sel_hi:[0,1,0]
  v_cvt_pk_bf16_f32 v98, v232, v233
  v_cvt_pk_bf16_f32 v102, v234, v235
  v_fma_mix_f32 v240, v134, v230, 0 op_sel_hi:[0,1,0]
  v_fma_mix_f32 v242, v150, v230, 0 op_sel_hi:[0,1,0]
  v_fma_mix_f32 v241, v135, v231, 0 op_sel_hi:[0,1,0]
  v_fma_mix_f32 v243, v151, v231, 0 op_sel_hi:[0,1,0]
  v_fma_mix_f32 v240, v150, v230, v240 op_sel:[0,1,0] op_sel_hi:[0,1,0]
  v_fma_mix_f32 v242, -v134, v230, v242 op_sel:[0,1,0] op_sel_hi:[0,1,0]
  v_fma_mix_f32 v241, v151, v231, v241 op_sel:[0,1,0] op_sel_hi:[0,1,0]
  v_fma_mix_f32 v243, -v135, v231, v243 op_sel:[0,1,0] op_sel_hi:[0,1,0]
  v_cvt_pk_bf16_f32 v99, v240, v241
  v_cvt_pk_bf16_f32 v103, v242, v243
  ds_read_b128 v[224:227], v7 offset:18432
  ds_read_b128 v[228:231], v7 offset:19456
  v_mfma_f32_32x32x16_bf16 v[184:199], v[8:11], v[88:91], 0
  v_xor_b32 v48, 0x80008000, v40
  v_xor_b32 v49, 0x80008000, v41
  v_xor_b32 v50, 0x80008000, v42
  v_xor_b32 v51, 0x80008000, v43
  v_xor_b32 v52, 0x80008000, v44
  v_xor_b32 v53, 0x80008000, v45
  v_mfma_f32_32x32x16_bf16 v[200:215], v[8:11], v[92:95], 0
  v_xor_b32 v54, 0x80008000, v46
  v_xor_b32 v55, 0x80008000, v47
  s_waitcnt lgkmcnt(2)
  v_fma_mix_f32 v232, v152, v216, 0 op_sel_hi:[0,1,0]
  v_fma_mix_f32 v234, v168, v216, 0 op_sel_hi:[0,1,0]
  v_fma_mix_f32 v233, v153, v217, 0 op_sel_hi:[0,1,0]
  v_fma_mix_f32 v235, v169, v217, 0 op_sel_hi:[0,1,0]
  v_mfma_f32_32x32x16_bf16 v[184:199], v[16:19], v[92:95], v[184:199]
  v_fma_mix_f32 v232, v168, v216, v232 op_sel:[0,1,0] op_sel_hi:[0,1,0]
  v_fma_mix_f32 v234, -v152, v216, v234 op_sel:[0,1,0] op_sel_hi:[0,1,0]
  v_fma_mix_f32 v233, v169, v217, v233 op_sel:[0,1,0] op_sel_hi:[0,1,0]
  v_fma_mix_f32 v235, -v153, v217, v235 op_sel:[0,1,0] op_sel_hi:[0,1,0]
  v_cvt_pk_bf16_f32 v104, v232, v233
  v_cvt_pk_bf16_f32 v108, v234, v235
  v_mfma_f32_32x32x16_bf16 v[200:215], v[24:27], v[88:91], v[200:215]
  v_fma_mix_f32 v240, v154, v218, 0 op_sel_hi:[0,1,0]
  v_fma_mix_f32 v242, v170, v218, 0 op_sel_hi:[0,1,0]
  v_fma_mix_f32 v241, v155, v219, 0 op_sel_hi:[0,1,0]
  v_fma_mix_f32 v243, v171, v219, 0 op_sel_hi:[0,1,0]
  v_fma_mix_f32 v240, v170, v218, v240 op_sel:[0,1,0] op_sel_hi:[0,1,0]
  v_fma_mix_f32 v242, -v154, v218, v242 op_sel:[0,1,0] op_sel_hi:[0,1,0]
  v_fma_mix_f32 v241, v171, v219, v241 op_sel:[0,1,0] op_sel_hi:[0,1,0]
  v_mfma_f32_32x32x16_bf16 v[184:199], v[12:15], v[96:99], v[184:199]
  v_fma_mix_f32 v243, -v155, v219, v243 op_sel:[0,1,0] op_sel_hi:[0,1,0]
  v_cvt_pk_bf16_f32 v105, v240, v241
  v_cvt_pk_bf16_f32 v109, v242, v243
  v_fma_mix_f32 v232, v156, v220, 0 op_sel_hi:[0,1,0]
  v_fma_mix_f32 v234, v172, v220, 0 op_sel_hi:[0,1,0]
  v_fma_mix_f32 v233, v157, v221, 0 op_sel_hi:[0,1,0]
  v_mfma_f32_32x32x16_bf16 v[200:215], v[12:15], v[100:103], v[200:215]
  v_fma_mix_f32 v235, v173, v221, 0 op_sel_hi:[0,1,0]
  v_fma_mix_f32 v232, v172, v220, v232 op_sel:[0,1,0] op_sel_hi:[0,1,0]
  v_fma_mix_f32 v234, -v156, v220, v234 op_sel:[0,1,0] op_sel_hi:[0,1,0]
  v_fma_mix_f32 v233, v173, v221, v233 op_sel:[0,1,0] op_sel_hi:[0,1,0]
  v_fma_mix_f32 v235, -v157, v221, v235 op_sel:[0,1,0] op_sel_hi:[0,1,0]
  v_cvt_pk_bf16_f32 v106, v232, v233
  v_cvt_pk_bf16_f32 v110, v234, v235
  v_mfma_f32_32x32x16_bf16 v[184:199], v[20:23], v[100:103], v[184:199]
  v_fma_mix_f32 v240, v158, v222, 0 op_sel_hi:[0,1,0]
  v_fma_mix_f32 v242, v174, v222, 0 op_sel_hi:[0,1,0]
  v_fma_mix_f32 v241, v159, v223, 0 op_sel_hi:[0,1,0]
  v_fma_mix_f32 v243, v175, v223, 0 op_sel_hi:[0,1,0]
  v_fma_mix_f32 v240, v174, v222, v240 op_sel:[0,1,0] op_sel_hi:[0,1,0]
  v_fma_mix_f32 v242, -v158, v222, v242 op_sel:[0,1,0] op_sel_hi:[0,1,0]
  v_mfma_f32_32x32x16_bf16 v[200:215], v[28:31], v[96:99], v[200:215]
  v_fma_mix_f32 v241, v175, v223, v241 op_sel:[0,1,0] op_sel_hi:[0,1,0]
  v_fma_mix_f32 v243, -v159, v223, v243 op_sel:[0,1,0] op_sel_hi:[0,1,0]
  v_cvt_pk_bf16_f32 v107, v240, v241
  v_cvt_pk_bf16_f32 v111, v242, v243
  s_waitcnt lgkmcnt(0)
  ds_read_b128 v[216:219], v7 offset:12288
  ds_read_b128 v[220:223], v7 offset:13312
  v_fma_mix_f32 v232, v160, v224, 0 op_sel_hi:[0,1,0]
  v_fma_mix_f32 v234, v176, v224, 0 op_sel_hi:[0,1,0]
  v_fma_mix_f32 v233, v161, v225, 0 op_sel_hi:[0,1,0]
  v_fma_mix_f32 v235, v177, v225, 0 op_sel_hi:[0,1,0]
  v_fma_mix_f32 v232, v176, v224, v232 op_sel:[0,1,0] op_sel_hi:[0,1,0]
  v_fma_mix_f32 v234, -v160, v224, v234 op_sel:[0,1,0] op_sel_hi:[0,1,0]
  v_fma_mix_f32 v233, v177, v225, v233 op_sel:[0,1,0] op_sel_hi:[0,1,0]
  v_fma_mix_f32 v235, -v161, v225, v235 op_sel:[0,1,0] op_sel_hi:[0,1,0]
  v_cvt_pk_bf16_f32 v112, v232, v233
  v_cvt_pk_bf16_f32 v116, v234, v235
  v_fma_mix_f32 v240, v162, v226, 0 op_sel_hi:[0,1,0]
  v_fma_mix_f32 v242, v178, v226, 0 op_sel_hi:[0,1,0]
  v_fma_mix_f32 v241, v163, v227, 0 op_sel_hi:[0,1,0]
  v_fma_mix_f32 v243, v179, v227, 0 op_sel_hi:[0,1,0]
  v_mfma_f32_32x32x16_bf16 v[120:135], v[32:35], v[104:107], v[184:199]
  v_fma_mix_f32 v240, v178, v226, v240 op_sel:[0,1,0] op_sel_hi:[0,1,0]
  v_fma_mix_f32 v242, -v162, v226, v242 op_sel:[0,1,0] op_sel_hi:[0,1,0]
  v_fma_mix_f32 v241, v179, v227, v241 op_sel:[0,1,0] op_sel_hi:[0,1,0]
  v_fma_mix_f32 v243, -v163, v227, v243 op_sel:[0,1,0] op_sel_hi:[0,1,0]
  v_cvt_pk_bf16_f32 v113, v240, v241
  v_cvt_pk_bf16_f32 v117, v242, v243
  v_fma_mix_f32 v232, v164, v228, 0 op_sel_hi:[0,1,0]
  v_mfma_f32_32x32x16_bf16 v[136:151], v[32:35], v[108:111], v[200:215]
  v_fma_mix_f32 v234, v180, v228, 0 op_sel_hi:[0,1,0]
  v_fma_mix_f32 v233, v165, v229, 0 op_sel_hi:[0,1,0]
  v_fma_mix_f32 v235, v181, v229, 0 op_sel_hi:[0,1,0]
  v_fma_mix_f32 v232, v180, v228, v232 op_sel:[0,1,0] op_sel_hi:[0,1,0]
  v_fma_mix_f32 v234, -v164, v228, v234 op_sel:[0,1,0] op_sel_hi:[0,1,0]
  v_fma_mix_f32 v233, v181, v229, v233 op_sel:[0,1,0] op_sel_hi:[0,1,0]
  v_fma_mix_f32 v235, -v165, v229, v235 op_sel:[0,1,0] op_sel_hi:[0,1,0]
  v_mfma_f32_32x32x16_bf16 v[120:135], v[40:43], v[108:111], v[120:135]
  v_cvt_pk_bf16_f32 v114, v232, v233
  v_cvt_pk_bf16_f32 v118, v234, v235
  v_fma_mix_f32 v240, v166, v230, 0 op_sel_hi:[0,1,0]
  v_fma_mix_f32 v242, v182, v230, 0 op_sel_hi:[0,1,0]
  v_fma_mix_f32 v241, v167, v231, 0 op_sel_hi:[0,1,0]
  v_fma_mix_f32 v243, v183, v231, 0 op_sel_hi:[0,1,0]
  v_fma_mix_f32 v240, v182, v230, v240 op_sel:[0,1,0] op_sel_hi:[0,1,0]
  v_mfma_f32_32x32x16_bf16 v[136:151], v[48:51], v[104:107], v[136:151]
  v_fma_mix_f32 v242, -v166, v230, v242 op_sel:[0,1,0] op_sel_hi:[0,1,0]
  v_fma_mix_f32 v241, v183, v231, v241 op_sel:[0,1,0] op_sel_hi:[0,1,0]
  v_fma_mix_f32 v243, -v167, v231, v243 op_sel:[0,1,0] op_sel_hi:[0,1,0]
  v_cvt_pk_bf16_f32 v115, v240, v241
  v_cvt_pk_bf16_f32 v119, v242, v243
  ds_read_b128 v[224:227], v7 offset:14336
  ds_read_b128 v[228:231], v7 offset:15360
  v_mfma_f32_32x32x16_bf16 v[120:135], v[36:39], v[112:115], v[120:135]
  v_mfma_f32_32x32x16_bf16 v[136:151], v[36:39], v[116:119], v[136:151]
  v_mfma_f32_32x32x16_bf16 v[120:135], v[44:47], v[116:119], v[120:135]
  v_mfma_f32_32x32x16_bf16 v[136:151], v[52:55], v[112:115], v[136:151]
  v_xor_b32 v104, 0x80008000, v104
  v_xor_b32 v105, 0x80008000, v105
  v_xor_b32 v106, 0x80008000, v106
  v_xor_b32 v107, 0x80008000, v107
  v_xor_b32 v108, 0x80008000, v108
  v_xor_b32 v109, 0x80008000, v109
  v_xor_b32 v110, 0x80008000, v110
  v_xor_b32 v111, 0x80008000, v111
  v_xor_b32 v112, 0x80008000, v112
  v_xor_b32 v113, 0x80008000, v113
  v_xor_b32 v114, 0x80008000, v114
  v_xor_b32 v115, 0x80008000, v115
  v_xor_b32 v116, 0x80008000, v116
  v_xor_b32 v117, 0x80008000, v117
  v_xor_b32 v118, 0x80008000, v118
  v_xor_b32 v119, 0x80008000, v119
  s_waitcnt vmcnt(0)
  s_cmp_eq_u32 s41, 0
  s_cbranch_scc1 L_col_half
  s_cmp_lg_u32 s41, 320
  s_cbranch_scc1 L_col_nohalf
L_col_half:
  v_lshlrev_b32 v2, 16, v56
  v_and_b32 v3, 0xffff0000, v56
  v_mul_f32 v2, 0.5, v2
  v_mul_f32 v3, 0.5, v3
  v_cvt_pk_bf16_f32 v56, v2, v3
  v_lshlrev_b32 v2, 16, v57
  v_and_b32 v3, 0xffff0000, v57
  v_mul_f32 v2, 0.5, v2
  v_mul_f32 v3, 0.5, v3
  v_cvt_pk_bf16_f32 v57, v2, v3
  v_lshlrev_b32 v2, 16, v58
  v_and_b32 v3, 0xffff0000, v58
  v_mul_f32 v2, 0.5, v2
  v_mul_f32 v3, 0.5, v3
  v_cvt_pk_bf16_f32 v58, v2, v3
  v_lshlrev_b32 v2, 16, v59
  v_and_b32 v3, 0xffff0000, v59
  v_mul_f32 v2, 0.5, v2
  v_mul_f32 v3, 0.5, v3
  v_cvt_pk_bf16_f32 v59, v2, v3
  v_lshlrev_b32 v2, 16, v60
  v_and_b32 v3, 0xffff0000, v60
  v_mul_f32 v2, 0.5, v2
  v_mul_f32 v3, 0.5, v3
  v_cvt_pk_bf16_f32 v60, v2, v3
  v_lshlrev_b32 v2, 16, v61
  v_and_b32 v3, 0xffff0000, v61
  v_mul_f32 v2, 0.5, v2
  v_mul_f32 v3, 0.5, v3
  v_cvt_pk_bf16_f32 v61, v2, v3
  v_lshlrev_b32 v2, 16, v62
  v_and_b32 v3, 0xffff0000, v62
  v_mul_f32 v2, 0.5, v2
  v_mul_f32 v3, 0.5, v3
  v_cvt_pk_bf16_f32 v62, v2, v3
  v_lshlrev_b32 v2, 16, v63
  v_and_b32 v3, 0xffff0000, v63
  v_mul_f32 v2, 0.5, v2
  v_mul_f32 v3, 0.5, v3
  v_cvt_pk_bf16_f32 v63, v2, v3
  v_lshlrev_b32 v2, 16, v64
  v_and_b32 v3, 0xffff0000, v64
  v_mul_f32 v2, 0.5, v2
  v_mul_f32 v3, 0.5, v3
  v_cvt_pk_bf16_f32 v64, v2, v3
  v_lshlrev_b32 v2, 16, v65
  v_and_b32 v3, 0xffff0000, v65
  v_mul_f32 v2, 0.5, v2
  v_mul_f32 v3, 0.5, v3
  v_cvt_pk_bf16_f32 v65, v2, v3
  v_lshlrev_b32 v2, 16, v66
  v_and_b32 v3, 0xffff0000, v66
  v_mul_f32 v2, 0.5, v2
  v_mul_f32 v3, 0.5, v3
  v_cvt_pk_bf16_f32 v66, v2, v3
  v_lshlrev_b32 v2, 16, v67
  v_and_b32 v3, 0xffff0000, v67
  v_mul_f32 v2, 0.5, v2
  v_mul_f32 v3, 0.5, v3
  v_cvt_pk_bf16_f32 v67, v2, v3
  v_lshlrev_b32 v2, 16, v68
  v_and_b32 v3, 0xffff0000, v68
  v_mul_f32 v2, 0.5, v2
  v_mul_f32 v3, 0.5, v3
  v_cvt_pk_bf16_f32 v68, v2, v3
  v_lshlrev_b32 v2, 16, v69
  v_and_b32 v3, 0xffff0000, v69
  v_mul_f32 v2, 0.5, v2
  v_mul_f32 v3, 0.5, v3
  v_cvt_pk_bf16_f32 v69, v2, v3
  v_lshlrev_b32 v2, 16, v70
  v_and_b32 v3, 0xffff0000, v70
  v_mul_f32 v2, 0.5, v2
  v_mul_f32 v3, 0.5, v3
  v_cvt_pk_bf16_f32 v70, v2, v3
  v_lshlrev_b32 v2, 16, v71
  v_and_b32 v3, 0xffff0000, v71
  v_mul_f32 v2, 0.5, v2
  v_mul_f32 v3, 0.5, v3
  v_cvt_pk_bf16_f32 v71, v2, v3
  v_lshlrev_b32 v2, 16, v72
  v_and_b32 v3, 0xffff0000, v72
  v_mul_f32 v2, 0.5, v2
  v_mul_f32 v3, 0.5, v3
  v_cvt_pk_bf16_f32 v72, v2, v3
  v_lshlrev_b32 v2, 16, v73
  v_and_b32 v3, 0xffff0000, v73
  v_mul_f32 v2, 0.5, v2
  v_mul_f32 v3, 0.5, v3
  v_cvt_pk_bf16_f32 v73, v2, v3
  v_lshlrev_b32 v2, 16, v74
  v_and_b32 v3, 0xffff0000, v74
  v_mul_f32 v2, 0.5, v2
  v_mul_f32 v3, 0.5, v3
  v_cvt_pk_bf16_f32 v74, v2, v3
  v_lshlrev_b32 v2, 16, v75
  v_and_b32 v3, 0xffff0000, v75
  v_mul_f32 v2, 0.5, v2
  v_mul_f32 v3, 0.5, v3
  v_cvt_pk_bf16_f32 v75, v2, v3
  v_lshlrev_b32 v2, 16, v76
  v_and_b32 v3, 0xffff0000, v76
  v_mul_f32 v2, 0.5, v2
  v_mul_f32 v3, 0.5, v3
  v_cvt_pk_bf16_f32 v76, v2, v3
  v_lshlrev_b32 v2, 16, v77
  v_and_b32 v3, 0xffff0000, v77
  v_mul_f32 v2, 0.5, v2
  v_mul_f32 v3, 0.5, v3
  v_cvt_pk_bf16_f32 v77, v2, v3
  v_lshlrev_b32 v2, 16, v78
  v_and_b32 v3, 0xffff0000, v78
  v_mul_f32 v2, 0.5, v2
  v_mul_f32 v3, 0.5, v3
  v_cvt_pk_bf16_f32 v78, v2, v3
  v_lshlrev_b32 v2, 16, v79
  v_and_b32 v3, 0xffff0000, v79
  v_mul_f32 v2, 0.5, v2
  v_mul_f32 v3, 0.5, v3
  v_cvt_pk_bf16_f32 v79, v2, v3
  v_lshlrev_b32 v2, 16, v80
  v_and_b32 v3, 0xffff0000, v80
  v_mul_f32 v2, 0.5, v2
  v_mul_f32 v3, 0.5, v3
  v_cvt_pk_bf16_f32 v80, v2, v3
  v_lshlrev_b32 v2, 16, v81
  v_and_b32 v3, 0xffff0000, v81
  v_mul_f32 v2, 0.5, v2
  v_mul_f32 v3, 0.5, v3
  v_cvt_pk_bf16_f32 v81, v2, v3
  v_lshlrev_b32 v2, 16, v82
  v_and_b32 v3, 0xffff0000, v82
  v_mul_f32 v2, 0.5, v2
  v_mul_f32 v3, 0.5, v3
  v_cvt_pk_bf16_f32 v82, v2, v3
  v_lshlrev_b32 v2, 16, v83
  v_and_b32 v3, 0xffff0000, v83
  v_mul_f32 v2, 0.5, v2
  v_mul_f32 v3, 0.5, v3
  v_cvt_pk_bf16_f32 v83, v2, v3
  v_lshlrev_b32 v2, 16, v84
  v_and_b32 v3, 0xffff0000, v84
  v_mul_f32 v2, 0.5, v2
  v_mul_f32 v3, 0.5, v3
  v_cvt_pk_bf16_f32 v84, v2, v3
  v_lshlrev_b32 v2, 16, v85
  v_and_b32 v3, 0xffff0000, v85
  v_mul_f32 v2, 0.5, v2
  v_mul_f32 v3, 0.5, v3
  v_cvt_pk_bf16_f32 v85, v2, v3
  v_lshlrev_b32 v2, 16, v86
  v_and_b32 v3, 0xffff0000, v86
  v_mul_f32 v2, 0.5, v2
  v_mul_f32 v3, 0.5, v3
  v_cvt_pk_bf16_f32 v86, v2, v3
  v_lshlrev_b32 v2, 16, v87
  v_and_b32 v3, 0xffff0000, v87
  v_mul_f32 v2, 0.5, v2
  v_mul_f32 v3, 0.5, v3
  v_cvt_pk_bf16_f32 v87, v2, v3
L_col_nohalf:
  v_mfma_f32_32x32x16_bf16 v[152:167], v[32:35], v[104:107], v[184:199]
  v_lshlrev_b32 v236, 16, v56
  v_and_b32 v238, 0xffff0000, v56
  v_lshlrev_b32 v237, 16, v57
  v_and_b32 v239, 0xffff0000, v57
  v_mul_f32 v232, v120, v236
  v_mul_f32 v234, v120, v238
  v_mul_f32 v233, v121, v237
  v_mul_f32 v235, v121, v239
  v_mfma_f32_32x32x16_bf16 v[168:183], v[32:35], v[108:111], v[200:215]
  v_fma_f32 v232, -v136, v238, v232
  v_fmac_f32 v234, v136, v236
  v_fma_f32 v233, -v137, v239, v233
  v_fmac_f32 v235, v137, v237
  v_cvt_pk_bf16_f32 v88, v232, v233
  v_cvt_pk_bf16_f32 v92, v234, v235
  v_lshlrev_b32 v244, 16, v58
  v_mfma_f32_32x32x16_bf16 v[152:167], v[40:43], v[108:111], v[152:167]
  v_and_b32 v246, 0xffff0000, v58
  v_lshlrev_b32 v245, 16, v59
  v_and_b32 v247, 0xffff0000, v59
  v_mul_f32 v240, v122, v244
  v_mul_f32 v242, v122, v246
  v_mul_f32 v241, v123, v245
  v_mul_f32 v243, v123, v247
  v_fma_f32 v240, -v138, v246, v240
  v_mfma_f32_32x32x16_bf16 v[168:183], v[48:51], v[104:107], v[168:183]
  v_fmac_f32 v242, v138, v244
  v_fma_f32 v241, -v139, v247, v241
  v_fmac_f32 v243, v139, v245
  v_cvt_pk_bf16_f32 v89, v240, v241
  v_cvt_pk_bf16_f32 v93, v242, v243
  v_lshlrev_b32 v236, 16, v60
  v_and_b32 v238, 0xffff0000, v60
  v_lshlrev_b32 v237, 16, v61
  v_mfma_f32_32x32x16_bf16 v[152:167], v[36:39], v[112:115], v[152:167]
  v_and_b32 v239, 0xffff0000, v61
  v_mul_f32 v232, v124, v236
  v_mul_f32 v234, v124, v238
  v_mul_f32 v233, v125, v237
  v_mul_f32 v235, v125, v239
  v_fma_f32 v232, -v140, v238, v232
  v_fmac_f32 v234, v140, v236
  v_mfma_f32_32x32x16_bf16 v[168:183], v[36:39], v[116:119], v[168:183]
  v_fma_f32 v233, -v141, v239, v233
  v_fmac_f32 v235, v141, v237
  v_cvt_pk_bf16_f32 v90, v232, v233
  v_cvt_pk_bf16_f32 v94, v234, v235
  v_lshlrev_b32 v244, 16, v62
  v_and_b32 v246, 0xffff0000, v62
  v_lshlrev_b32 v245, 16, v63
  v_and_b32 v247, 0xffff0000, v63
  v_mfma_f32_32x32x16_bf16 v[152:167], v[44:47], v[116:119], v[152:167]
  v_mul_f32 v240, v126, v244
  v_mul_f32 v242, v126, v246
  v_mul_f32 v241, v127, v245
  v_mul_f32 v243, v127, v247
  v_fma_f32 v240, -v142, v246, v240
  v_fmac_f32 v242, v142, v244
  v_fma_f32 v241, -v143, v247, v241
  v_fmac_f32 v243, v143, v245
  v_mfma_f32_32x32x16_bf16 v[168:183], v[52:55], v[112:115], v[168:183]
  v_cvt_pk_bf16_f32 v91, v240, v241
  v_cvt_pk_bf16_f32 v95, v242, v243
  v_lshlrev_b32 v236, 16, v64
  v_and_b32 v238, 0xffff0000, v64
  v_lshlrev_b32 v237, 16, v65
  v_and_b32 v239, 0xffff0000, v65
  v_mul_f32 v232, v128, v236
  v_mul_f32 v234, v128, v238
  v_mul_f32 v233, v129, v237
  v_mul_f32 v235, v129, v239
  v_fma_f32 v232, -v144, v238, v232
  v_fmac_f32 v234, v144, v236
  v_fma_f32 v233, -v145, v239, v233
  v_fmac_f32 v235, v145, v237
  v_cvt_pk_bf16_f32 v96, v232, v233
  v_cvt_pk_bf16_f32 v100, v234, v235
  v_lshlrev_b32 v244, 16, v66
  v_and_b32 v246, 0xffff0000, v66
  v_lshlrev_b32 v245, 16, v67
  v_and_b32 v247, 0xffff0000, v67
  v_mul_f32 v240, v130, v244
  v_mul_f32 v242, v130, v246
  v_mul_f32 v241, v131, v245
  v_mul_f32 v243, v131, v247
  v_fma_f32 v240, -v146, v246, v240
  v_fmac_f32 v242, v146, v244
  v_fma_f32 v241, -v147, v247, v241
  v_fmac_f32 v243, v147, v245
  v_cvt_pk_bf16_f32 v97, v240, v241
  v_cvt_pk_bf16_f32 v101, v242, v243
  v_lshlrev_b32 v236, 16, v68
  v_and_b32 v238, 0xffff0000, v68
  v_lshlrev_b32 v237, 16, v69
  v_and_b32 v239, 0xffff0000, v69
  v_mul_f32 v232, v132, v236
  v_mul_f32 v234, v132, v238
  v_mul_f32 v233, v133, v237
  v_mul_f32 v235, v133, v239
  v_fma_f32 v232, -v148, v238, v232
  v_fmac_f32 v234, v148, v236
  v_fma_f32 v233, -v149, v239, v233
  v_fmac_f32 v235, v149, v237
  v_cvt_pk_bf16_f32 v98, v232, v233
  v_cvt_pk_bf16_f32 v102, v234, v235
  v_lshlrev_b32 v244, 16, v70
  v_and_b32 v246, 0xffff0000, v70
  v_lshlrev_b32 v245, 16, v71
  v_and_b32 v247, 0xffff0000, v71
  v_mul_f32 v240, v134, v244
  v_mul_f32 v242, v134, v246
  v_mul_f32 v241, v135, v245
  v_mul_f32 v243, v135, v247
  v_fma_f32 v240, -v150, v246, v240
  v_fmac_f32 v242, v150, v244
  v_fma_f32 v241, -v151, v247, v241
  v_fmac_f32 v243, v151, v245
  v_cvt_pk_bf16_f32 v99, v240, v241
  v_cvt_pk_bf16_f32 v103, v242, v243
  ds_read_b128 v[32:35], v7 offset:8192
  ds_read_b128 v[40:43], v7 offset:10240
  ds_read_b128 v[36:39], v7 offset:9216
  ds_read_b128 v[44:47], v7 offset:11264
  v_mfma_f32_32x32x16_bf16 v[184:199], v[88:91], v[8:11], 0
  v_lshlrev_b32 v236, 16, v72
  v_and_b32 v238, 0xffff0000, v72
  v_lshlrev_b32 v237, 16, v73
  v_and_b32 v239, 0xffff0000, v73
  v_mul_f32 v232, v152, v236
  v_mfma_f32_32x32x16_bf16 v[200:215], v[92:95], v[8:11], 0
  v_mul_f32 v234, v152, v238
  v_mul_f32 v233, v153, v237
  v_mul_f32 v235, v153, v239
  v_fma_f32 v232, -v168, v238, v232
  v_fmac_f32 v234, v168, v236
  v_mfma_f32_32x32x16_bf16 v[184:199], v[92:95], v[24:27], v[184:199]
  v_fma_f32 v233, -v169, v239, v233
  v_fmac_f32 v235, v169, v237
  v_cvt_pk_bf16_f32 v104, v232, v233
  v_cvt_pk_bf16_f32 v108, v234, v235
  v_lshlrev_b32 v244, 16, v74
  v_mfma_f32_32x32x16_bf16 v[200:215], v[88:91], v[16:19], v[200:215]
  v_and_b32 v246, 0xffff0000, v74
  v_lshlrev_b32 v245, 16, v75
  v_and_b32 v247, 0xffff0000, v75
  v_mul_f32 v240, v154, v244
  v_mfma_f32_32x32x16_bf16 v[184:199], v[96:99], v[12:15], v[184:199]
  v_mul_f32 v242, v154, v246
  v_mul_f32 v241, v155, v245
  v_mul_f32 v243, v155, v247
  v_fma_f32 v240, -v170, v246, v240
  v_fmac_f32 v242, v170, v244
  v_mfma_f32_32x32x16_bf16 v[200:215], v[100:103], v[12:15], v[200:215]
  v_fma_f32 v241, -v171, v247, v241
  v_fmac_f32 v243, v171, v245
  v_cvt_pk_bf16_f32 v105, v240, v241
  v_cvt_pk_bf16_f32 v109, v242, v243
  s_waitcnt lgkmcnt(0)
  v_mfma_f32_32x32x16_bf16 v[184:199], v[100:103], v[28:31], v[184:199]
  v_xor_b32 v48, 0x80008000, v40
  v_xor_b32 v49, 0x80008000, v41
  v_xor_b32 v50, 0x80008000, v42
  v_xor_b32 v51, 0x80008000, v43
  v_xor_b32 v52, 0x80008000, v44
  v_mfma_f32_32x32x16_bf16 v[200:215], v[96:99], v[20:23], v[200:215]
  v_xor_b32 v53, 0x80008000, v45
  v_xor_b32 v54, 0x80008000, v46
  v_xor_b32 v55, 0x80008000, v47
  v_lshlrev_b32 v236, 16, v76
  v_and_b32 v238, 0xffff0000, v76
  v_lshlrev_b32 v237, 16, v77
  v_and_b32 v239, 0xffff0000, v77
  v_mul_f32 v232, v156, v236
  v_mul_f32 v234, v156, v238
  v_mul_f32 v233, v157, v237
  v_mfma_f32_32x32x16_bf16 v[120:135], v[88:91], v[32:35], 0
  v_mul_f32 v235, v157, v239
  v_fma_f32 v232, -v172, v238, v232
  v_fmac_f32 v234, v172, v236
  v_fma_f32 v233, -v173, v239, v233
  v_fmac_f32 v235, v173, v237
  v_mfma_f32_32x32x16_bf16 v[136:151], v[92:95], v[32:35], 0
  v_cvt_pk_bf16_f32 v106, v232, v233
  v_cvt_pk_bf16_f32 v110, v234, v235
  v_lshlrev_b32 v244, 16, v78
  v_and_b32 v246, 0xffff0000, v78
  v_lshlrev_b32 v245, 16, v79
  v_mfma_f32_32x32x16_bf16 v[120:135], v[92:95], v[48:51], v[120:135]
  v_and_b32 v247, 0xffff0000, v79
  v_mul_f32 v240, v158, v244
  v_mul_f32 v242, v158, v246
  v_mul_f32 v241, v159, v245
  v_mul_f32 v243, v159, v247
  v_fma_f32 v240, -v174, v246, v240
  v_mfma_f32_32x32x16_bf16 v[136:151], v[88:91], v[40:43], v[136:151]
  v_fmac_f32 v242, v174, v244
  v_fma_f32 v241, -v175, v247, v241
  v_fmac_f32 v243, v175, v245
  v_cvt_pk_bf16_f32 v107, v240, v241
  v_cvt_pk_bf16_f32 v111, v242, v243
  v_mfma_f32_32x32x16_bf16 v[120:135], v[96:99], v[36:39], v[120:135]
  v_lshlrev_b32 v236, 16, v80
  v_and_b32 v238, 0xffff0000, v80
  v_lshlrev_b32 v237, 16, v81
  v_and_b32 v239, 0xffff0000, v81
  v_mul_f32 v232, v160, v236
  v_mul_f32 v234, v160, v238
  v_mfma_f32_32x32x16_bf16 v[136:151], v[100:103], v[36:39], v[136:151]
  v_mul_f32 v233, v161, v237
  v_mul_f32 v235, v161, v239
  v_fma_f32 v232, -v176, v238, v232
  v_fmac_f32 v234, v176, v236
  v_fma_f32 v233, -v177, v239, v233
  v_mfma_f32_32x32x16_bf16 v[120:135], v[100:103], v[52:55], v[120:135]
  v_fmac_f32 v235, v177, v237
  v_cvt_pk_bf16_f32 v112, v232, v233
  v_cvt_pk_bf16_f32 v116, v234, v235
  v_lshlrev_b32 v244, 16, v82
  v_and_b32 v246, 0xffff0000, v82
  v_lshlrev_b32 v245, 16, v83
  v_mfma_f32_32x32x16_bf16 v[136:151], v[96:99], v[44:47], v[136:151]
  v_and_b32 v247, 0xffff0000, v83
  v_mul_f32 v240, v162, v244
  v_mul_f32 v242, v162, v246
  v_mul_f32 v241, v163, v245
  v_mul_f32 v243, v163, v247
  v_fma_f32 v240, -v178, v246, v240
  v_fmac_f32 v242, v178, v244
  v_fma_f32 v241, -v179, v247, v241
  v_fmac_f32 v243, v179, v245
  v_cvt_pk_bf16_f32 v113, v240, v241
  v_cvt_pk_bf16_f32 v117, v242, v243
  v_lshlrev_b32 v236, 16, v84
  v_and_b32 v238, 0xffff0000, v84
  v_lshlrev_b32 v237, 16, v85
  v_and_b32 v239, 0xffff0000, v85
  v_mfma_f32_32x32x16_bf16 v[184:199], v[104:107], v[8:11], v[184:199]
  v_mul_f32 v232, v164, v236
  v_mul_f32 v234, v164, v238
  v_mul_f32 v233, v165, v237
  v_mul_f32 v235, v165, v239
  v_fma_f32 v232, -v180, v238, v232
  v_fmac_f32 v234, v180, v236
  v_mfma_f32_32x32x16_bf16 v[200:215], v[108:111], v[8:11], v[200:215]
  v_fma_f32 v233, -v181, v239, v233
  v_fmac_f32 v235, v181, v237
  v_cvt_pk_bf16_f32 v114, v232, v233
  v_cvt_pk_bf16_f32 v118, v234, v235
  v_lshlrev_b32 v244, 16, v86
  v_and_b32 v246, 0xffff0000, v86
  v_mfma_f32_32x32x16_bf16 v[184:199], v[108:111], v[24:27], v[184:199]
  v_lshlrev_b32 v245, 16, v87
  v_and_b32 v247, 0xffff0000, v87
  v_mul_f32 v240, v166, v244
  v_mul_f32 v242, v166, v246
  v_mul_f32 v241, v167, v245
  v_mul_f32 v243, v167, v247
  v_mfma_f32_32x32x16_bf16 v[200:215], v[104:107], v[16:19], v[200:215]
  v_fma_f32 v240, -v182, v246, v240
  v_fmac_f32 v242, v182, v244
  v_fma_f32 v241, -v183, v247, v241
  v_fmac_f32 v243, v183, v245
  v_cvt_pk_bf16_f32 v115, v240, v241
  v_cvt_pk_bf16_f32 v119, v242, v243
  s_nop 0
  v_mfma_f32_32x32x16_bf16 v[184:199], v[112:115], v[12:15], v[184:199]
  v_mfma_f32_32x32x16_bf16 v[200:215], v[116:119], v[12:15], v[200:215]
  v_mfma_f32_32x32x16_bf16 v[184:199], v[116:119], v[28:31], v[184:199]
  v_mfma_f32_32x32x16_bf16 v[200:215], v[112:115], v[20:23], v[200:215]
  v_xor_b32 v104, 0x80008000, v104
  v_xor_b32 v105, 0x80008000, v105
  v_xor_b32 v106, 0x80008000, v106
  v_xor_b32 v107, 0x80008000, v107
  v_xor_b32 v108, 0x80008000, v108
  v_xor_b32 v109, 0x80008000, v109
  v_xor_b32 v110, 0x80008000, v110
  v_xor_b32 v111, 0x80008000, v111
  v_xor_b32 v112, 0x80008000, v112
  v_xor_b32 v113, 0x80008000, v113
  v_xor_b32 v114, 0x80008000, v114
  v_xor_b32 v115, 0x80008000, v115
  v_xor_b32 v116, 0x80008000, v116
  v_xor_b32 v117, 0x80008000, v117
  v_xor_b32 v118, 0x80008000, v118
  v_xor_b32 v119, 0x80008000, v119
  v_mfma_f32_32x32x16_bf16 v[120:135], v[104:107], v[32:35], v[120:135]
  s_waitcnt lgkmcnt(0)
  v_fma_mix_f32 v232, v184, v216, 0 op_sel_hi:[0,1,0]
  v_fma_mix_f32 v234, v200, v216, 0 op_sel_hi:[0,1,0]
  v_fma_mix_f32 v233, v185, v217, 0 op_sel_hi:[0,1,0]
  v_fma_mix_f32 v235, v201, v217, 0 op_sel_hi:[0,1,0]
  v_fma_mix_f32 v232, -v200, v216, v232 op_sel:[0,1,0] op_sel_hi:[0,1,0]
  v_mfma_f32_32x32x16_bf16 v[136:151], v[108:111], v[32:35], v[136:151]
  v_fma_mix_f32 v234, v184, v216, v234 op_sel:[0,1,0] op_sel_hi:[0,1,0]
  v_fma_mix_f32 v233, -v201, v217, v233 op_sel:[0,1,0] op_sel_hi:[0,1,0]
  v_fma_mix_f32 v235, v185, v217, v235 op_sel:[0,1,0] op_sel_hi:[0,1,0]
  v_cvt_pk_bf16_f32 v88, v232, v233
  v_cvt_pk_bf16_f32 v92, v234, v235
  v_fma_mix_f32 v240, v186, v218, 0 op_sel_hi:[0,1,0]
  v_fma_mix_f32 v242, v202, v218, 0 op_sel_hi:[0,1,0]
  v_mfma_f32_32x32x16_bf16 v[120:135], v[108:111], v[48:51], v[120:135]
  v_fma_mix_f32 v241, v187, v219, 0 op_sel_hi:[0,1,0]
  v_fma_mix_f32 v243, v203, v219, 0 op_sel_hi:[0,1,0]
  v_fma_mix_f32 v240, -v202, v218, v240 op_sel:[0,1,0] op_sel_hi:[0,1,0]
  v_fma_mix_f32 v242, v186, v218, v242 op_sel:[0,1,0] op_sel_hi:[0,1,0]
  v_fma_mix_f32 v241, -v203, v219, v241 op_sel:[0,1,0] op_sel_hi:[0,1,0]
  v_fma_mix_f32 v243, v187, v219, v243 op_sel:[0,1,0] op_sel_hi:[0,1,0]
  v_mfma_f32_32x32x16_bf16 v[136:151], v[104:107], v[40:43], v[136:151]
  v_cvt_pk_bf16_f32 v89, v240, v241
  v_cvt_pk_bf16_f32 v93, v242, v243
  v_fma_mix_f32 v232, v188, v220, 0 op_sel_hi:[0,1,0]
  v_fma_mix_f32 v234, v204, v220, 0 op_sel_hi:[0,1,0]
  v_fma_mix_f32 v233, v189, v221, 0 op_sel_hi:[0,1,0]
  v_fma_mix_f32 v235, v205, v221, 0 op_sel_hi:[0,1,0]
  v_fma_mix_f32 v232, -v204, v220, v232 op_sel:[0,1,0] op_sel_hi:[0,1,0]
  v_mfma_f32_32x32x16_bf16 v[120:135], v[112:115], v[36:39], v[120:135]
  v_fma_mix_f32 v234, v188, v220, v234 op_sel:[0,1,0] op_sel_hi:[0,1,0]
  v_fma_mix_f32 v233, -v205, v221, v233 op_sel:[0,1,0] op_sel_hi:[0,1,0]
  v_fma_mix_f32 v235, v189, v221, v235 op_sel:[0,1,0] op_sel_hi:[0,1,0]
  v_cvt_pk_bf16_f32 v90, v232, v233
  v_cvt_pk_bf16_f32 v94, v234, v235
  v_fma_mix_f32 v240, v190, v222, 0 op_sel_hi:[0,1,0]
  v_mfma_f32_32x32x16_bf16 v[136:151], v[116:119], v[36:39], v[136:151]
  v_fma_mix_f32 v242, v206, v222, 0 op_sel_hi:[0,1,0]
  v_fma_mix_f32 v241, v191, v223, 0 op_sel_hi:[0,1,0]
  v_fma_mix_f32 v243, v207, v223, 0 op_sel_hi:[0,1,0]
  v_fma_mix_f32 v240, -v206, v222, v240 op_sel:[0,1,0] op_sel_hi:[0,1,0]
  v_fma_mix_f32 v242, v190, v222, v242 op_sel:[0,1,0] op_sel_hi:[0,1,0]
  v_fma_mix_f32 v241, -v207, v223, v241 op_sel:[0,1,0] op_sel_hi:[0,1,0]
  v_fma_mix_f32 v243, v191, v223, v243 op_sel:[0,1,0] op_sel_hi:[0,1,0]
  v_mfma_f32_32x32x16_bf16 v[120:135], v[116:119], v[52:55], v[120:135]
  v_cvt_pk_bf16_f32 v91, v240, v241
  v_cvt_pk_bf16_f32 v95, v242, v243
  s_waitcnt lgkmcnt(0)
  ds_read_b128 v[216:219], v7 offset:20480
  ds_read_b128 v[220:223], v7 offset:21504
  v_fma_mix_f32 v232, v192, v224, 0 op_sel_hi:[0,1,0]
  v_mfma_f32_32x32x16_bf16 v[136:151], v[112:115], v[44:47], v[136:151]
  v_fma_mix_f32 v234, v208, v224, 0 op_sel_hi:[0,1,0]
  v_fma_mix_f32 v233, v193, v225, 0 op_sel_hi:[0,1,0]
  v_fma_mix_f32 v235, v209, v225, 0 op_sel_hi:[0,1,0]
  v_fma_mix_f32 v232, -v208, v224, v232 op_sel:[0,1,0] op_sel_hi:[0,1,0]
  v_fma_mix_f32 v234, v192, v224, v234 op_sel:[0,1,0] op_sel_hi:[0,1,0]
  v_fma_mix_f32 v233, -v209, v225, v233 op_sel:[0,1,0] op_sel_hi:[0,1,0]
  v_fma_mix_f32 v235, v193, v225, v235 op_sel:[0,1,0] op_sel_hi:[0,1,0]
  v_cvt_pk_bf16_f32 v96, v232, v233
  v_cvt_pk_bf16_f32 v100, v234, v235
  v_fma_mix_f32 v240, v194, v226, 0 op_sel_hi:[0,1,0]
  v_fma_mix_f32 v242, v210, v226, 0 op_sel_hi:[0,1,0]
  v_fma_mix_f32 v241, v195, v227, 0 op_sel_hi:[0,1,0]
  v_fma_mix_f32 v243, v211, v227, 0 op_sel_hi:[0,1,0]
  v_fma_mix_f32 v240, -v210, v226, v240 op_sel:[0,1,0] op_sel_hi:[0,1,0]
  v_fma_mix_f32 v242, v194, v226, v242 op_sel:[0,1,0] op_sel_hi:[0,1,0]
  v_fma_mix_f32 v241, -v211, v227, v241 op_sel:[0,1,0] op_sel_hi:[0,1,0]
  v_fma_mix_f32 v243, v195, v227, v243 op_sel:[0,1,0] op_sel_hi:[0,1,0]
  v_cvt_pk_bf16_f32 v97, v240, v241
  v_cvt_pk_bf16_f32 v101, v242, v243
  v_fma_mix_f32 v232, v196, v228, 0 op_sel_hi:[0,1,0]
  v_fma_mix_f32 v234, v212, v228, 0 op_sel_hi:[0,1,0]
  v_fma_mix_f32 v233, v197, v229, 0 op_sel_hi:[0,1,0]
  v_fma_mix_f32 v235, v213, v229, 0 op_sel_hi:[0,1,0]
  v_fma_mix_f32 v232, -v212, v228, v232 op_sel:[0,1,0] op_sel_hi:[0,1,0]
  v_fma_mix_f32 v234, v196, v228, v234 op_sel:[0,1,0] op_sel_hi:[0,1,0]
  v_fma_mix_f32 v233, -v213, v229, v233 op_sel:[0,1,0] op_sel_hi:[0,1,0]
  v_fma_mix_f32 v235, v197, v229, v235 op_sel:[0,1,0] op_sel_hi:[0,1,0]
  v_cvt_pk_bf16_f32 v98, v232, v233
  v_cvt_pk_bf16_f32 v102, v234, v235
  v_fma_mix_f32 v240, v198, v230, 0 op_sel_hi:[0,1,0]
  v_fma_mix_f32 v242, v214, v230, 0 op_sel_hi:[0,1,0]
  v_fma_mix_f32 v241, v199, v231, 0 op_sel_hi:[0,1,0]
  v_fma_mix_f32 v243, v215, v231, 0 op_sel_hi:[0,1,0]
  v_fma_mix_f32 v240, -v214, v230, v240 op_sel:[0,1,0] op_sel_hi:[0,1,0]
  v_fma_mix_f32 v242, v198, v230, v242 op_sel:[0,1,0] op_sel_hi:[0,1,0]
  v_fma_mix_f32 v241, -v215, v231, v241 op_sel:[0,1,0] op_sel_hi:[0,1,0]
  v_fma_mix_f32 v243, v199, v231, v243 op_sel:[0,1,0] op_sel_hi:[0,1,0]
  v_cvt_pk_bf16_f32 v99, v240, v241
  v_cvt_pk_bf16_f32 v103, v242, v243
  ds_read_b128 v[224:227], v7 offset:22528
  ds_read_b128 v[228:231], v7 offset:23552
  v_mfma_f32_32x32x16_bf16 v[152:167], v[8:11], v[88:91], 0
  s_waitcnt lgkmcnt(2)
  v_fma_mix_f32 v232, v120, v216, 0 op_sel_hi:[0,1,0]
  v_fma_mix_f32 v234, v136, v216, 0 op_sel_hi:[0,1,0]
  v_fma_mix_f32 v233, v121, v217, 0 op_sel_hi:[0,1,0]
  v_fma_mix_f32 v235, v137, v217, 0 op_sel_hi:[0,1,0]
  v_fma_mix_f32 v232, -v136, v216, v232 op_sel:[0,1,0] op_sel_hi:[0,1,0]
  v_mfma_f32_32x32x16_bf16 v[168:183], v[8:11], v[92:95], 0
  v_fma_mix_f32 v234, v120, v216, v234 op_sel:[0,1,0] op_sel_hi:[0,1,0]
  v_fma_mix_f32 v233, -v137, v217, v233 op_sel:[0,1,0] op_sel_hi:[0,1,0]
  v_fma_mix_f32 v235, v121, v217, v235 op_sel:[0,1,0] op_sel_hi:[0,1,0]
  v_cvt_pk_bf16_f32 v104, v232, v233
  v_cvt_pk_bf16_f32 v108, v234, v235
  v_mfma_f32_32x32x16_bf16 v[152:167], v[24:27], v[92:95], v[152:167]
  v_fma_mix_f32 v240, v122, v218, 0 op_sel_hi:[0,1,0]
  v_fma_mix_f32 v242, v138, v218, 0 op_sel_hi:[0,1,0]
  v_fma_mix_f32 v241, v123, v219, 0 op_sel_hi:[0,1,0]
  v_fma_mix_f32 v243, v139, v219, 0 op_sel_hi:[0,1,0]
  v_fma_mix_f32 v240, -v138, v218, v240 op_sel:[0,1,0] op_sel_hi:[0,1,0]
  v_fma_mix_f32 v242, v122, v218, v242 op_sel:[0,1,0] op_sel_hi:[0,1,0]
  v_mfma_f32_32x32x16_bf16 v[168:183], v[16:19], v[88:91], v[168:183]
  v_fma_mix_f32 v241, -v139, v219, v241 op_sel:[0,1,0] op_sel_hi:[0,1,0]
  v_fma_mix_f32 v243, v123, v219, v243 op_sel:[0,1,0] op_sel_hi:[0,1,0]
  v_cvt_pk_bf16_f32 v105, v240, v241
  v_cvt_pk_bf16_f32 v109, v242, v243
  v_fma_mix_f32 v232, v124, v220, 0 op_sel_hi:[0,1,0]
  v_fma_mix_f32 v234, v140, v220, 0 op_sel_hi:[0,1,0]
  v_mfma_f32_32x32x16_bf16 v[152:167], v[12:15], v[96:99], v[152:167]
  v_fma_mix_f32 v233, v125, v221, 0 op_sel_hi:[0,1,0]
  v_fma_mix_f32 v235, v141, v221, 0 op_sel_hi:[0,1,0]
  v_fma_mix_f32 v232, -v140, v220, v232 op_sel:[0,1,0] op_sel_hi:[0,1,0]
  v_fma_mix_f32 v234, v124, v220, v234 op_sel:[0,1,0] op_sel_hi:[0,1,0]
  v_fma_mix_f32 v233, -v141, v221, v233 op_sel:[0,1,0] op_sel_hi:[0,1,0]
  v_mfma_f32_32x32x16_bf16 v[168:183], v[12:15], v[100:103], v[168:183]
  v_fma_mix_f32 v235, v125, v221, v235 op_sel:[0,1,0] op_sel_hi:[0,1,0]
  v_cvt_pk_bf16_f32 v106, v232, v233
  v_cvt_pk_bf16_f32 v110, v234, v235
  v_fma_mix_f32 v240, v126, v222, 0 op_sel_hi:[0,1,0]
  v_fma_mix_f32 v242, v142, v222, 0 op_sel_hi:[0,1,0]
  v_fma_mix_f32 v241, v127, v223, 0 op_sel_hi:[0,1,0]
  v_mfma_f32_32x32x16_bf16 v[152:167], v[28:31], v[100:103], v[152:167]
  v_fma_mix_f32 v243, v143, v223, 0 op_sel_hi:[0,1,0]
  v_fma_mix_f32 v240, -v142, v222, v240 op_sel:[0,1,0] op_sel_hi:[0,1,0]
  v_fma_mix_f32 v242, v126, v222, v242 op_sel:[0,1,0] op_sel_hi:[0,1,0]
  v_fma_mix_f32 v241, -v143, v223, v241 op_sel:[0,1,0] op_sel_hi:[0,1,0]
  v_fma_mix_f32 v243, v127, v223, v243 op_sel:[0,1,0] op_sel_hi:[0,1,0]
  v_mfma_f32_32x32x16_bf16 v[168:183], v[20:23], v[96:99], v[168:183]
  v_cvt_pk_bf16_f32 v107, v240, v241
  v_cvt_pk_bf16_f32 v111, v242, v243
  s_waitcnt lgkmcnt(0)
  v_fma_mix_f32 v232, v128, v224, 0 op_sel_hi:[0,1,0]
  v_fma_mix_f32 v234, v144, v224, 0 op_sel_hi:[0,1,0]
  v_fma_mix_f32 v233, v129, v225, 0 op_sel_hi:[0,1,0]
  v_fma_mix_f32 v235, v145, v225, 0 op_sel_hi:[0,1,0]
  v_fma_mix_f32 v232, -v144, v224, v232 op_sel:[0,1,0] op_sel_hi:[0,1,0]
  v_fma_mix_f32 v234, v128, v224, v234 op_sel:[0,1,0] op_sel_hi:[0,1,0]
  v_fma_mix_f32 v233, -v145, v225, v233 op_sel:[0,1,0] op_sel_hi:[0,1,0]
  v_fma_mix_f32 v235, v129, v225, v235 op_sel:[0,1,0] op_sel_hi:[0,1,0]
  v_cvt_pk_bf16_f32 v112, v232, v233
  v_cvt_pk_bf16_f32 v116, v234, v235
  v_fma_mix_f32 v240, v130, v226, 0 op_sel_hi:[0,1,0]
  v_fma_mix_f32 v242, v146, v226, 0 op_sel_hi:[0,1,0]
  v_fma_mix_f32 v241, v131, v227, 0 op_sel_hi:[0,1,0]
  v_fma_mix_f32 v243, v147, v227, 0 op_sel_hi:[0,1,0]
  v_fma_mix_f32 v240, -v146, v226, v240 op_sel:[0,1,0] op_sel_hi:[0,1,0]
  v_fma_mix_f32 v242, v130, v226, v242 op_sel:[0,1,0] op_sel_hi:[0,1,0]
  v_fma_mix_f32 v241, -v147, v227, v241 op_sel:[0,1,0] op_sel_hi:[0,1,0]
  v_mfma_f32_32x32x16_bf16 v[184:199], v[8:11], v[104:107], 0
  v_fma_mix_f32 v243, v131, v227, v243 op_sel:[0,1,0] op_sel_hi:[0,1,0]
  v_cvt_pk_bf16_f32 v113, v240, v241
  v_cvt_pk_bf16_f32 v117, v242, v243
  v_fma_mix_f32 v232, v132, v228, 0 op_sel_hi:[0,1,0]
  v_fma_mix_f32 v234, v148, v228, 0 op_sel_hi:[0,1,0]
  v_fma_mix_f32 v233, v133, v229, 0 op_sel_hi:[0,1,0]
  v_mfma_f32_32x32x16_bf16 v[200:215], v[8:11], v[108:111], 0
  v_fma_mix_f32 v235, v149, v229, 0 op_sel_hi:[0,1,0]
  v_fma_mix_f32 v232, -v148, v228, v232 op_sel:[0,1,0] op_sel_hi:[0,1,0]
  v_fma_mix_f32 v234, v132, v228, v234 op_sel:[0,1,0] op_sel_hi:[0,1,0]
  v_fma_mix_f32 v233, -v149, v229, v233 op_sel:[0,1,0] op_sel_hi:[0,1,0]
  v_fma_mix_f32 v235, v133, v229, v235 op_sel:[0,1,0] op_sel_hi:[0,1,0]
  v_cvt_pk_bf16_f32 v114, v232, v233
  v_mfma_f32_32x32x16_bf16 v[184:199], v[24:27], v[108:111], v[184:199]
  v_cvt_pk_bf16_f32 v118, v234, v235
  v_fma_mix_f32 v240, v134, v230, 0 op_sel_hi:[0,1,0]
  v_fma_mix_f32 v242, v150, v230, 0 op_sel_hi:[0,1,0]
  v_fma_mix_f32 v241, v135, v231, 0 op_sel_hi:[0,1,0]
  v_fma_mix_f32 v243, v151, v231, 0 op_sel_hi:[0,1,0]
  v_mfma_f32_32x32x16_bf16 v[200:215], v[16:19], v[104:107], v[200:215]
  v_fma_mix_f32 v240, -v150, v230, v240 op_sel:[0,1,0] op_sel_hi:[0,1,0]
  v_fma_mix_f32 v242, v134, v230, v242 op_sel:[0,1,0] op_sel_hi:[0,1,0]
  v_fma_mix_f32 v241, -v151, v231, v241 op_sel:[0,1,0] op_sel_hi:[0,1,0]
  v_fma_mix_f32 v243, v135, v231, v243 op_sel:[0,1,0] op_sel_hi:[0,1,0]
  v_cvt_pk_bf16_f32 v115, v240, v241
  v_cvt_pk_bf16_f32 v119, v242, v243
  s_nop 0
  v_mfma_f32_32x32x16_bf16 v[184:199], v[12:15], v[112:115], v[184:199]
  v_cvt_pk_bf16_f32 v88, v152, v153
  v_cvt_pk_bf16_f32 v92, v168, v169
  v_mfma_f32_32x32x16_bf16 v[200:215], v[12:15], v[116:119], v[200:215]
  v_cvt_pk_bf16_f32 v89, v154, v155
  v_cvt_pk_bf16_f32 v93, v170, v171
  v_mfma_f32_32x32x16_bf16 v[184:199], v[28:31], v[116:119], v[184:199]
  v_cvt_pk_bf16_f32 v90, v156, v157
  v_cvt_pk_bf16_f32 v94, v172, v173
  v_mfma_f32_32x32x16_bf16 v[200:215], v[20:23], v[112:115], v[200:215]
  v_cvt_pk_bf16_f32 v91, v158, v159
  v_cvt_pk_bf16_f32 v95, v174, v175
  v_cvt_pk_bf16_f32 v96, v160, v161
  v_cvt_pk_bf16_f32 v100, v176, v177
  v_cvt_pk_bf16_f32 v97, v162, v163
  v_cvt_pk_bf16_f32 v101, v178, v179
  v_cvt_pk_bf16_f32 v98, v164, v165
  v_cvt_pk_bf16_f32 v102, v180, v181
  v_cvt_pk_bf16_f32 v99, v166, v167
  v_cvt_pk_bf16_f32 v103, v182, v183
  ds_write_b128 v248, v[88:91]
  ds_write_b128 v249, v[92:95]
  ds_write_b128 v250, v[96:99]
  ds_write_b128 v251, v[100:103]
  v_lshrrev_b32 v2, 5, v0
  v_lshlrev_b32 v2, 10, v2
  v_and_b32 v3, 31, v0
  v_lshl_add_u32 v2, v3, 4, v2
  v_mov_b32 v3, v2
  v_cvt_pk_bf16_f32 v104, v184, v185
  v_cvt_pk_bf16_f32 v108, v200, v201
  v_cvt_pk_bf16_f32 v105, v186, v187
  v_cvt_pk_bf16_f32 v109, v202, v203
  v_cvt_pk_bf16_f32 v106, v188, v189
  v_cvt_pk_bf16_f32 v110, v204, v205
  v_cvt_pk_bf16_f32 v107, v190, v191
  v_cvt_pk_bf16_f32 v111, v206, v207
  v_cvt_pk_bf16_f32 v112, v192, v193
  v_cvt_pk_bf16_f32 v116, v208, v209
  v_cvt_pk_bf16_f32 v113, v194, v195
  v_cvt_pk_bf16_f32 v117, v210, v211
  v_cvt_pk_bf16_f32 v114, v196, v197
  v_cvt_pk_bf16_f32 v118, v212, v213
  v_cvt_pk_bf16_f32 v115, v198, v199
  v_cvt_pk_bf16_f32 v119, v214, v215
  s_waitcnt lgkmcnt(0)
  s_barrier
  ds_write_b128 v252, v[104:107]
  ds_write_b128 v253, v[108:111]
  ds_write_b128 v254, v[112:115]
  ds_write_b128 v255, v[116:119]
  s_waitcnt lgkmcnt(0)
  s_barrier
  s_lshl_b32 s50, s3, 12
  v_add_u32 v4, s50, v2
  s_add_u32 s44, s42, s50
  s_add_u32 s44, s44, 12583424
  ds_read_b128 v[24:27], v4 offset:512
  ds_read_b128 v[28:31], v4 offset:2560
  s_waitcnt lgkmcnt(1)
  buffer_store_dwordx4 v[24:27], v2, s[60:63], s44 offen offset:0 sc1
  s_waitcnt lgkmcnt(0)
  buffer_store_dwordx4 v[28:31], v2, s[60:63], s44 offen offset:2048 sc1
  s_endpgm
L_k2_cstub:
  s_and_b32 s41, s3, 3
  s_lshr_b32 s43, s3, 2
  s_sub_u32 s42, s2, 81
  s_lshl_b32 s42, s42, 2
  s_add_u32 s42, s42, s41
  s_mul_i32 s46, s41, 17664
  s_add_u32 s46, s46, 512
  v_lshlrev_b32 v2, 4, v0
  s_mul_i32 s48, s42, 1536
  s_add_u32 s48, s48, 9437184
  s_mul_i32 s52, s3, 1536
  s_add_u32 s52, s52, 71168
  s_lshl_b32 s50, s43, 11
  s_mul_i32 s51, s42, 4096
  s_add_u32 s51, s51, s50
  s_add_u32 s51, s51, 6291456
  s_add_u32 s50, s50, s46
  s_waitcnt lgkmcnt(0)
  s_mov_b32 m0, s52
  s_nop 0
  buffer_load_dwordx4 v2, s[60:63], s48 offen lds
  s_add_u32 m0, s52, 1024
  s_add_u32 s48, s48, 1024
  s_mov_b64 exec, 0x3ffff
  buffer_load_dwordx4 v2, s[60:63], s48 offen lds
  s_mov_b64 exec, -1
  s_add_u32 m0, s50, 8800
  s_nop 0
  buffer_load_dwordx4 v2, s[60:63], s51 offen lds
  s_add_u32 s51, s51, 1024
  s_add_u32 m0, s50, 9824
  s_nop 0
  buffer_load_dwordx4 v2, s[60:63], s51 offen lds
  s_waitcnt vmcnt(2)
  s_cmp_eq_u32 s43, 0
  s_cbranch_scc0 L_cv_x1
  v_lshlrev_b32 v3, 4, v0
  v_lshlrev_b32 v4, 3, v0
  v_add_u32 v4, 256, v4
  v_cmp_gt_u32 vcc, 32, v0
  s_nop 1
  v_cndmask_b32 v3, v4, v3, vcc
  v_add_u32 v3, s52, v3
  v_lshlrev_b32 v4, 2, v0
  v_add_u32 v4, s52, v4
  v_lshlrev_b32 v5, 1, v0
  v_add_u32 v5, s52, v5
  ds_read_b64 v[8:9], v3
  ds_read_b64 v[10:11], v3 offset:8
  ds_read2_b32 v[14:15], v4 offset0:192 offset1:193
  v_mov_b32 v13, s52
  ds_read_u16 v20, v13 offset:1024
  s_mov_b32 s64, 84148480
  s_mov_b32 s65, 117833984
  s_mov_b32 s66, 84148994
  s_mov_b32 s67, 117834498
  v_lshlrev_b32 v7, 4, v0
  v_sub_u32 v7, 1008, v7
  v_add_u32 v7, s46, v7
  s_waitcnt lgkmcnt(2)
  s_mov_b32 exec_hi, 0
  v_perm_b32 v24, v11, v11, s66
  v_perm_b32 v25, v10, v10, s66
  v_perm_b32 v26, v9, v9, s66
  v_perm_b32 v27, v8, v8, s66
  s_mov_b32 exec_lo, 0
  s_mov_b32 exec_hi, -1
  v_perm_b32 v24, v9, v10, s65
  v_perm_b32 v25, v9, v9, s64
  v_perm_b32 v26, v8, v9, s65
  v_perm_b32 v27, v8, v8, s64
  s_mov_b64 exec, -1
  ds_write_b128 v7, v[24:27] offset:3072
  s_waitcnt lgkmcnt(2)
  v_perm_b32 v28, v15, v15, s64
  v_perm_b32 v29, v14, v14, s67
  v_perm_b32 v30, v14, v14, s66
  v_perm_b32 v31, v14, v14, s64
  ds_write_b128 v7, v[28:31] offset:2048
  s_waitcnt lgkmcnt(2)
  v_cmp_eq_u32 vcc, 0, v0
  s_nop 1
  v_cndmask_b32 v20, 0, v20, vcc
  v_mov_b32 v32, 0
  v_perm_b32 v34, v20, v20, s64
  v_lshlrev_b32 v33, 16, v20
  v_mov_b32 v35, v34
  s_mov_b64 exec, 0xf
  ds_write_b128 v7, v[32:35] offset:1024
  s_mov_b64 exec, -1
  s_branch L_k2_conv
L_cv_x1:
  v_lshlrev_b32 v3, 4, v0
  v_lshlrev_b32 v4, 3, v0
  v_add_u32 v4, 256, v4
  v_cmp_gt_u32 vcc, 32, v0
  s_nop 1
  v_cndmask_b32 v3, v4, v3, vcc
  v_add_u32 v3, s52, v3
  v_lshlrev_b32 v4, 2, v0
  v_add_u32 v4, s52, v4
  v_lshlrev_b32 v5, 1, v0
  v_add_u32 v5, s52, v5
  ds_read_b64 v[8:9], v3
  ds_read_b64 v[10:11], v3 offset:8
  v_cmp_ge_u32 vcc, 32, v0
  v_mov_b32 v6, 2
  s_nop 0
  v_cndmask_b32 v6, 0, v6, vcc
  v_sub_u32 v6, v3, v6
  ds_read_u16 v12, v6
  ds_read2_b32 v[14:15], v4 offset0:192 offset1:193
  v_mov_b32 v13, s52
  ds_read_u16 v20, v13 offset:1024
  ds_read_u16 v16, v5 offset:1024
  ds_read_u16 v17, v5 offset:1026
  ds_read_u16 v18, v5 offset:1152
  ds_read_u16 v19, v5 offset:1154
  s_mov_b32 s64, 84148480
  s_mov_b32 s65, 117833984
  s_mov_b32 s66, 84148994
  s_mov_b32 s67, 117834498
  v_lshlrev_b32 v7, 4, v0
  v_sub_u32 v7, 5168, v7
  v_add_u32 v7, s46, v7
  s_waitcnt lgkmcnt(6)
  s_mov_b32 exec_hi, 0
  v_perm_b32 v24, v10, v11, s65
  v_perm_b32 v25, v9, v10, s65
  v_perm_b32 v26, v8, v9, s65
  v_perm_b32 v27, v12, v8, s64
  s_mov_b32 exec_lo, 0
  s_mov_b32 exec_hi, -1
  v_perm_b32 v24, v9, v9, s66
  v_perm_b32 v25, v9, v9, s64
  v_perm_b32 v26, v8, v8, s66
  v_perm_b32 v27, v12, v8, s64
  s_mov_b64 exec, -1
  ds_write_b128 v7, v[24:27] offset:3072
  s_waitcnt lgkmcnt(6)
  v_perm_b32 v28, v14, v15, s65
  v_perm_b32 v29, v14, v14, s67
  v_perm_b32 v30, v14, v14, s64
  v_mov_b32 v31, v30
  ds_write_b128 v7, v[28:31] offset:2048
  s_waitcnt lgkmcnt(6)
  v_cmp_eq_u32 vcc, 0, v0
  s_nop 1
  v_cndmask_b32 v20, 0, v20, vcc
  v_mov_b32 v32, 0
  v_perm_b32 v34, v20, v20, s64
  v_mov_b32 v33, v34
  v_mov_b32 v35, v34
  s_mov_b64 exec, 0xf
  ds_write_b128 v7, v[32:35] offset:1024
  s_mov_b64 exec, -1
  v_lshlrev_b32 v6, 1, v0
  v_add_u32 v6, s46, v6
  v_lshlrev_b32 v21, 2, v0
  v_add_u32 v21, s46, v21
  v_mov_b32 v22, 0
  s_mov_b64 exec, 0xffff
  ds_write_b32 v21, v22 offset:17280
  s_waitcnt lgkmcnt(4)
  s_mov_b32 exec_lo, 0xaaaaaaaa
  s_mov_b32 exec_hi, 0xaaaaaaaa
  v_perm_b32 v23, v17, v16, s64
  ds_write_b32 v6, v23 offset:17342
  v_perm_b32 v23, v19, v18, s64
  ds_write_b32 v6, v23 offset:17470
  s_mov_b64 exec, -1
  s_waitcnt vmcnt(0) lgkmcnt(0)
  s_barrier
  v_lshlrev_b32 v3, 5, v0
  v_add_u32 v3, s46, v3
  ds_read_b128 v[16:19], v3 offset:8752
  ds_read_b128 v[20:23], v3 offset:8768
  ds_read_b128 v[24:27], v3 offset:8784
  ds_read_b128 v[28:31], v3 offset:8800
  ds_read_b128 v[32:35], v3 offset:8816
  v_lshrrev_b32 v4, 2, v0
  v_mul_u32_u24 v4, 272, v4
  v_and_b32 v5, 3, v0
  v_lshl_add_u32 v4, v5, 2, v4
  v_add_u32 v4, s46, v4
  v_mov_b32 v40, 0
  s_waitcnt lgkmcnt(0)
  v_lshlrev_b32 v8, 16, v18
  v_add_f32 v41, v40, v8
  v_and_b32 v9, 0xffff0000, v18
  v_add_f32 v42, v41, v9
  v_lshlrev_b32 v8, 16, v19
  v_add_f32 v43, v42, v8
  v_and_b32 v9, 0xffff0000, v19
  v_add_f32 v44, v43, v9
  v_lshlrev_b32 v8, 16, v20
  v_add_f32 v45, v44, v8
  v_and_b32 v9, 0xffff0000, v20
  v_add_f32 v46, v45, v9
  v_lshlrev_b32 v8, 16, v21
  v_add_f32 v47, v46, v8
  v_and_b32 v9, 0xffff0000, v21
  v_add_f32 v48, v47, v9
  v_lshlrev_b32 v8, 16, v22
  v_add_f32 v49, v48, v8
  v_and_b32 v9, 0xffff0000, v22
  v_add_f32 v50, v49, v9
  v_lshlrev_b32 v8, 16, v23
  v_add_f32 v51, v50, v8
  v_and_b32 v9, 0xffff0000, v23
  v_add_f32 v52, v51, v9
  v_lshlrev_b32 v8, 16, v24
  v_add_f32 v53, v52, v8
  v_and_b32 v9, 0xffff0000, v24
  v_add_f32 v54, v53, v9
  v_lshlrev_b32 v8, 16, v25
  v_add_f32 v55, v54, v8
  v_and_b32 v9, 0xffff0000, v25
  v_add_f32 v56, v55, v9
  v_lshlrev_b32 v8, 16, v26
  v_add_f32 v57, v56, v8
  v_and_b32 v9, 0xffff0000, v26
  v_add_f32 v58, v57, v9
  v_lshlrev_b32 v8, 16, v27
  v_add_f32 v59, v58, v8
  v_and_b32 v9, 0xffff0000, v27
  v_add_f32 v60, v59, v9
  v_lshlrev_b32 v8, 16, v28
  v_add_f32 v61, v60, v8
  v_and_b32 v9, 0xffff0000, v28
  v_add_f32 v62, v61, v9
  v_lshlrev_b32 v8, 16, v29
  v_add_f32 v63, v62, v8
  v_and_b32 v9, 0xffff0000, v29
  v_add_f32 v64, v63, v9
  v_lshlrev_b32 v8, 16, v30
  v_add_f32 v65, v64, v8
  v_and_b32 v9, 0xffff0000, v30
  v_add_f32 v66, v65, v9
  v_lshlrev_b32 v8, 16, v31
  v_add_f32 v67, v66, v8
  v_and_b32 v9, 0xffff0000, v31
  v_add_f32 v68, v67, v9
  v_lshlrev_b32 v8, 16, v32
  v_add_f32 v69, v68, v8
  v_and_b32 v9, 0xffff0000, v32
  v_add_f32 v70, v69, v9
  v_lshlrev_b32 v8, 16, v33
  v_add_f32 v71, v70, v8
  v_sub_f32 v10, v56, v49
  v_sub_f32 v11, v49, v40
  v_cvt_pk_bf16_f32 v10, v10, v11
  ds_write_b32 v4, v10 offset:12928
  v_sub_f32 v12, v57, v50
  v_sub_f32 v13, v50, v41
  v_cvt_pk_bf16_f32 v12, v12, v13
  ds_write_b32 v4, v12 offset:12944
  v_sub_f32 v10, v58, v51
  v_sub_f32 v11, v51, v42
  v_cvt_pk_bf16_f32 v10, v10, v11
  ds_write_b32 v4, v10 offset:12960
  v_sub_f32 v12, v59, v52
  v_sub_f32 v13, v52, v43
  v_cvt_pk_bf16_f32 v12, v12, v13
  ds_write_b32 v4, v12 offset:12976
  v_sub_f32 v10, v60, v53
  v_sub_f32 v11, v53, v44
  v_cvt_pk_bf16_f32 v10, v10, v11
  ds_write_b32 v4, v10 offset:12992
  v_sub_f32 v12, v61, v54
  v_sub_f32 v13, v54, v45
  v_cvt_pk_bf16_f32 v12, v12, v13
  ds_write_b32 v4, v12 offset:13008
  v_sub_f32 v10, v62, v55
  v_sub_f32 v11, v55, v46
  v_cvt_pk_bf16_f32 v10, v10, v11
  ds_write_b32 v4, v10 offset:13024
  v_sub_f32 v12, v63, v56
  v_sub_f32 v13, v56, v47
  v_cvt_pk_bf16_f32 v12, v12, v13
  ds_write_b32 v4, v12 offset:13040
  v_sub_f32 v10, v64, v57
  v_sub_f32 v11, v57, v48
  v_cvt_pk_bf16_f32 v10, v10, v11
  ds_write_b32 v4, v10 offset:13056
  v_sub_f32 v12, v65, v58
  v_sub_f32 v13, v58, v49
  v_cvt_pk_bf16_f32 v12, v12, v13
  ds_write_b32 v4, v12 offset:13072
  v_sub_f32 v10, v66, v59
  v_sub_f32 v11, v59, v50
  v_cvt_pk_bf16_f32 v10, v10, v11
  ds_write_b32 v4, v10 offset:13088
  v_sub_f32 v12, v67, v60
  v_sub_f32 v13, v60, v51
  v_cvt_pk_bf16_f32 v12, v12, v13
  ds_write_b32 v4, v12 offset:13104
  v_sub_f32 v10, v68, v61
  v_sub_f32 v11, v61, v52
  v_cvt_pk_bf16_f32 v10, v10, v11
  ds_write_b32 v4, v10 offset:13120
  v_sub_f32 v12, v69, v62
  v_sub_f32 v13, v62, v53
  v_cvt_pk_bf16_f32 v12, v12, v13
  ds_write_b32 v4, v12 offset:13136
  v_sub_f32 v10, v70, v63
  v_sub_f32 v11, v63, v54
  v_cvt_pk_bf16_f32 v10, v10, v11
  ds_write_b32 v4, v10 offset:13152
  v_sub_f32 v12, v71, v64
  v_sub_f32 v13, v64, v55
  v_cvt_pk_bf16_f32 v12, v12, v13
  ds_write_b32 v4, v12 offset:13168
  s_waitcnt lgkmcnt(0)
  s_barrier
  s_endpgm
L_k2_conv:
  v_mov_b32 v4, 0
  v_mov_b32 v5, 0
  v_mov_b32 v6, 0
  v_mov_b32 v7, 0
  v_add_u32 v3, s46, v2
  v_cmp_gt_u32 vcc, 30, v0
  s_nop 3
  s_and_saveexec_b64 s[52:53], vcc
  ds_write_b128 v3, v[4:7] offset:8320
  s_mov_b64 exec, s[52:53]
  v_and_b32 v8, 15, v0
  v_lshrrev_b32 v9, 4, v0
  v_lshlrev_b32 v10, 5, v8
  v_lshl_add_u32 v10, v9, 4, v10
  v_add_u32 v10, s46, v10
  v_add_u32 v10, 8320, v10
  v_and_b32 v11, 1, v8
  v_sub_u32 v11, 1, v11
  v_mul_u32_u24 v12, 4158, v11
  v_lshlrev_b32 v13, 1, v8
  v_sub_u32 v12, v12, v13
  v_lshl_add_u32 v12, v9, 4, v12
  v_add_u32 v12, s46, v12
  v_add_u32 v14, 1054, v12
  v_add_u32 v13, 2078, v12
  v_add_u32 v12, 3102, v12
  v_lshlrev_b32 v4, 3, v9
  v_sub_u32 v4, v8, v4
  v_add_u32 v4, 16, v4
  v_add_u32 v5, 1, v4
  v_med3_i32 v5, v5, 0, 2
  v_lshlrev_b32 v5, 3, v5
  v_mov_b32 v6, 1
  v_lshlrev_b32 v6, v5, v6
  v_lshlrev_b32 v6, v5, v6
  v_add_u32 v16, -1, v6
  v_subrev_u32 v5, 1, v4
  v_med3_i32 v5, v5, 0, 2
  v_lshlrev_b32 v5, 3, v5
  v_mov_b32 v6, 1
  v_lshlrev_b32 v6, v5, v6
  v_lshlrev_b32 v6, v5, v6
  v_add_u32 v17, -1, v6
  v_subrev_u32 v5, 3, v4
  v_med3_i32 v5, v5, 0, 2
  v_lshlrev_b32 v5, 3, v5
  v_mov_b32 v6, 1
  v_lshlrev_b32 v6, v5, v6
  v_lshlrev_b32 v6, v5, v6
  v_add_u32 v18, -1, v6
  v_subrev_u32 v5, 5, v4
  v_med3_i32 v5, v5, 0, 2
  v_lshlrev_b32 v5, 3, v5
  v_mov_b32 v6, 1
  v_lshlrev_b32 v6, v5, v6
  v_lshlrev_b32 v6, v5, v6
  v_add_u32 v19, -1, v6
  v_and_b32 v4, 1, v9
  v_lshlrev_b32 v4, 9, v4
  v_lshl_add_u32 v4, v8, 5, v4
  v_lshrrev_b32 v6, 1, v9
  v_lshl_add_u32 v4, v6, 4, v4
  s_mul_i32 s49, s42, 4096
  s_add_u32 s49, s49, 15728640
  v_mov_b32 v20, 0
  v_mov_b32 v21, 0
  v_mov_b32 v22, 0
  v_mov_b32 v23, 0
  v_mov_b32 v24, 0
  v_mov_b32 v25, 0
  v_mov_b32 v26, 0
  v_mov_b32 v27, 0
  v_mov_b32 v28, 0
  v_mov_b32 v29, 0
  v_mov_b32 v30, 0
  v_mov_b32 v31, 0
  v_mov_b32 v32, 0
  v_mov_b32 v33, 0
  v_mov_b32 v34, 0
  v_mov_b32 v35, 0
  v_mov_b32 v36, 0
  v_mov_b32 v37, 0
  v_mov_b32 v38, 0
  v_mov_b32 v39, 0
  v_mov_b32 v40, 0
  v_mov_b32 v41, 0
  v_mov_b32 v42, 0
  v_mov_b32 v43, 0
  v_mov_b32 v44, 0
  v_mov_b32 v45, 0
  v_mov_b32 v46, 0
  v_mov_b32 v47, 0
  v_mov_b32 v48, 0
  v_mov_b32 v49, 0
  v_mov_b32 v50, 0
  v_mov_b32 v51, 0
  s_mov_b32 s47, 4
  s_waitcnt vmcnt(0) lgkmcnt(0)
  s_barrier
  ds_read2_b32 v[196:197], v14 offset0:240 offset1:241
  ds_read2_b32 v[198:199], v14 offset0:242 offset1:243
  ds_read_b128 v[200:203], v10 offset:448
  ds_read_b128 v[204:207], v10 offset:960
  ds_read_b128 v[208:211], v10 offset:1472
  ds_read_b128 v[212:215], v10 offset:1984
  v_lshlrev_b32 v5, 2, v8
  v_lshlrev_b32 v6, 4, v9
  v_sub_u32 v5, v5, v6
  v_add_u32 v5, s46, v5
  v_add_u32 v5, 17332, v5
  ds_read2_b32 v[180:181], v5 offset0:3 offset1:2
  ds_read2_b32 v[182:183], v5 offset0:1 offset1:0
  ds_read2_b32 v[184:185], v5 offset0:19 offset1:18
  ds_read2_b32 v[186:187], v5 offset0:17 offset1:16
  ds_read2_b32 v[188:189], v5 offset0:35 offset1:34
  ds_read2_b32 v[190:191], v5 offset0:33 offset1:32
  ds_read2_b32 v[192:193], v5 offset0:51 offset1:50
  ds_read2_b32 v[194:195], v5 offset0:49 offset1:48
  v_mul_u32_u24 v7, 272, v9
  v_lshl_add_u32 v7, v8, 4, v7
  v_add_u32 v7, s46, v7
  ds_read_b128 v[84:87], v10 offset:448
  ds_read2_b32 v[52:53], v12 offset0:240 offset1:241
  ds_read2_b32 v[54:55], v12 offset0:242 offset1:243
  ds_read_b128 v[88:91], v10 offset:960
  ds_read2_b32 v[56:57], v12 offset0:112 offset1:113
  ds_read2_b32 v[58:59], v12 offset0:114 offset1:115
  ds_read_b128 v[92:95], v10 offset:1472
  ds_read2_b32 v[60:61], v13 offset0:240 offset1:241
  ds_read2_b32 v[62:63], v13 offset0:242 offset1:243
  ds_read_b128 v[96:99], v10 offset:1984
  ds_read2_b32 v[64:65], v13 offset0:112 offset1:113
  ds_read2_b32 v[66:67], v13 offset0:114 offset1:115
  ds_read_b128 v[100:103], v10 offset:2496
L_cv_loop:
  s_waitcnt lgkmcnt(10)
  v_and_b32 v52, v52, v16
  v_and_b32 v53, v53, v17
  v_and_b32 v54, v54, v18
  v_and_b32 v55, v55, v19
  v_mov_b32 v16, -1
  v_mov_b32 v17, -1
  v_mov_b32 v18, -1
  v_mov_b32 v19, -1
  v_mfma_f32_16x16x32_bf16 v[20:23], v[52:55], v[84:87], v[20:23]
  ds_read_b128 v[104:107], v10 offset:3008
  s_waitcnt lgkmcnt(8)
  v_mfma_f32_16x16x32_bf16 v[24:27], v[56:59], v[84:87], v[24:27]
  ds_read_b128 v[108:111], v10 offset:3520
  v_mfma_f32_16x16x32_bf16 v[28:31], v[56:59], v[88:91], v[28:31]
  v_mfma_f32_16x16x32_bf16 v[24:27], v[52:55], v[88:91], v[24:27]
  s_waitcnt lgkmcnt(6)
  v_mfma_f32_16x16x32_bf16 v[28:31], v[60:63], v[84:87], v[28:31]
  ds_read_b128 v[112:115], v10 offset:4032
  v_mfma_f32_16x16x32_bf16 v[32:35], v[60:63], v[88:91], v[32:35]
  v_mfma_f32_16x16x32_bf16 v[36:39], v[60:63], v[92:95], v[36:39]
  v_mfma_f32_16x16x32_bf16 v[28:31], v[52:55], v[92:95], v[28:31]
  v_mfma_f32_16x16x32_bf16 v[32:35], v[56:59], v[92:95], v[32:35]
  s_waitcnt lgkmcnt(4)
  v_mfma_f32_16x16x32_bf16 v[32:35], v[64:67], v[84:87], v[32:35]
  ds_read_b128 v[148:151], v10 offset:384
  v_mfma_f32_16x16x32_bf16 v[36:39], v[64:67], v[88:91], v[36:39]
  ds_read2_b32 v[116:117], v12 offset0:224 offset1:225
  v_mfma_f32_16x16x32_bf16 v[40:43], v[64:67], v[92:95], v[40:43]
  ds_read2_b32 v[118:119], v12 offset0:226 offset1:227
  v_mfma_f32_16x16x32_bf16 v[44:47], v[64:67], v[96:99], v[44:47]
  v_mfma_f32_16x16x32_bf16 v[32:35], v[52:55], v[96:99], v[32:35]
  v_mfma_f32_16x16x32_bf16 v[36:39], v[56:59], v[96:99], v[36:39]
  v_mfma_f32_16x16x32_bf16 v[40:43], v[60:63], v[96:99], v[40:43]
  s_waitcnt lgkmcnt(6)
  v_mfma_f32_16x16x32_bf16 v[36:39], v[52:55], v[100:103], v[36:39]
  ds_read_b128 v[152:155], v10 offset:896
  v_mfma_f32_16x16x32_bf16 v[40:43], v[56:59], v[100:103], v[40:43]
  ds_read2_b32 v[120:121], v12 offset0:96 offset1:97
  v_mfma_f32_16x16x32_bf16 v[44:47], v[60:63], v[100:103], v[44:47]
  ds_read2_b32 v[122:123], v12 offset0:98 offset1:99
  v_mfma_f32_16x16x32_bf16 v[48:51], v[64:67], v[100:103], v[48:51]
  s_waitcnt lgkmcnt(8)
  v_mfma_f32_16x16x32_bf16 v[40:43], v[52:55], v[104:107], v[40:43]
  ds_read_b128 v[156:159], v10 offset:1408
  v_mfma_f32_16x16x32_bf16 v[44:47], v[56:59], v[104:107], v[44:47]
  ds_read2_b32 v[124:125], v13 offset0:224 offset1:225
  v_mfma_f32_16x16x32_bf16 v[48:51], v[60:63], v[104:107], v[48:51]
  ds_read2_b32 v[126:127], v13 offset0:226 offset1:227
  s_waitcnt lgkmcnt(10)
  v_mfma_f32_16x16x32_bf16 v[44:47], v[52:55], v[108:111], v[44:47]
  ds_read_b128 v[160:163], v10 offset:1920
  v_mfma_f32_16x16x32_bf16 v[48:51], v[56:59], v[108:111], v[48:51]
  ds_read2_b32 v[128:129], v13 offset0:96 offset1:97
  ds_read2_b32 v[130:131], v13 offset0:98 offset1:99
  s_waitcnt lgkmcnt(12)
  v_mfma_f32_16x16x32_bf16 v[48:51], v[52:55], v[112:115], v[48:51]
  ds_read_b128 v[164:167], v10 offset:2432
  s_waitcnt lgkmcnt(10)
  v_mfma_f32_16x16x32_bf16 v[20:23], v[116:119], v[148:151], v[20:23]
  ds_read_b128 v[168:171], v10 offset:2944
  s_waitcnt lgkmcnt(8)
  v_mfma_f32_16x16x32_bf16 v[24:27], v[120:123], v[148:151], v[24:27]
  ds_read_b128 v[172:175], v10 offset:3456
  v_mfma_f32_16x16x32_bf16 v[28:31], v[120:123], v[152:155], v[28:31]
  v_mfma_f32_16x16x32_bf16 v[24:27], v[116:119], v[152:155], v[24:27]
  s_waitcnt lgkmcnt(6)
  v_mfma_f32_16x16x32_bf16 v[28:31], v[124:127], v[148:151], v[28:31]
  ds_read_b128 v[176:179], v10 offset:3968
  v_mfma_f32_16x16x32_bf16 v[32:35], v[124:127], v[152:155], v[32:35]
  v_mfma_f32_16x16x32_bf16 v[36:39], v[124:127], v[156:159], v[36:39]
  v_mfma_f32_16x16x32_bf16 v[28:31], v[116:119], v[156:159], v[28:31]
  v_mfma_f32_16x16x32_bf16 v[32:35], v[120:123], v[156:159], v[32:35]
  s_waitcnt lgkmcnt(4)
  v_mfma_f32_16x16x32_bf16 v[32:35], v[128:131], v[148:151], v[32:35]
  ds_read_b128 v[84:87], v10 offset:320
  v_mfma_f32_16x16x32_bf16 v[36:39], v[128:131], v[152:155], v[36:39]
  ds_read2_b32 v[52:53], v12 offset0:208 offset1:209
  v_mfma_f32_16x16x32_bf16 v[40:43], v[128:131], v[156:159], v[40:43]
  ds_read2_b32 v[54:55], v12 offset0:210 offset1:211
  v_mfma_f32_16x16x32_bf16 v[44:47], v[128:131], v[160:163], v[44:47]
  v_mfma_f32_16x16x32_bf16 v[32:35], v[116:119], v[160:163], v[32:35]
  v_mfma_f32_16x16x32_bf16 v[36:39], v[120:123], v[160:163], v[36:39]
  v_mfma_f32_16x16x32_bf16 v[40:43], v[124:127], v[160:163], v[40:43]
  s_waitcnt lgkmcnt(6)
  v_mfma_f32_16x16x32_bf16 v[36:39], v[116:119], v[164:167], v[36:39]
  ds_read_b128 v[88:91], v10 offset:832
  v_mfma_f32_16x16x32_bf16 v[40:43], v[120:123], v[164:167], v[40:43]
  ds_read2_b32 v[56:57], v12 offset0:80 offset1:81
  v_mfma_f32_16x16x32_bf16 v[44:47], v[124:127], v[164:167], v[44:47]
  ds_read2_b32 v[58:59], v12 offset0:82 offset1:83
  v_mfma_f32_16x16x32_bf16 v[48:51], v[128:131], v[164:167], v[48:51]
  s_waitcnt lgkmcnt(8)
  v_mfma_f32_16x16x32_bf16 v[40:43], v[116:119], v[168:171], v[40:43]
  ds_read_b128 v[92:95], v10 offset:1344
  v_mfma_f32_16x16x32_bf16 v[44:47], v[120:123], v[168:171], v[44:47]
  ds_read2_b32 v[60:61], v13 offset0:208 offset1:209
  v_mfma_f32_16x16x32_bf16 v[48:51], v[124:127], v[168:171], v[48:51]
  ds_read2_b32 v[62:63], v13 offset0:210 offset1:211
  s_waitcnt lgkmcnt(10)
  v_mfma_f32_16x16x32_bf16 v[44:47], v[116:119], v[172:175], v[44:47]
  ds_read_b128 v[96:99], v10 offset:1856
  v_mfma_f32_16x16x32_bf16 v[48:51], v[120:123], v[172:175], v[48:51]
  ds_read2_b32 v[64:65], v13 offset0:80 offset1:81
  ds_read2_b32 v[66:67], v13 offset0:82 offset1:83
  s_waitcnt lgkmcnt(12)
  v_mfma_f32_16x16x32_bf16 v[48:51], v[116:119], v[176:179], v[48:51]
  ds_read_b128 v[100:103], v10 offset:2368
  v_subrev_u32 v10, 128, v10
  v_subrev_u32 v12, 128, v12
  v_subrev_u32 v13, 128, v13
  s_sub_u32 s47, s47, 1
  s_cmp_lg_u32 s47, 0
  s_cbranch_scc1 L_cv_loop
  s_barrier
  ds_read_b128 v[116:119], v7 offset:12928
  ds_read_b128 v[120:123], v7 offset:14016
  ds_read_b128 v[124:127], v7 offset:15104
  ds_read_b128 v[128:131], v7 offset:16192
  v_mfma_f32_16x16x32_bf16 v[36:39], v[196:199], v[200:203], v[36:39]
  v_mfma_f32_16x16x32_bf16 v[40:43], v[196:199], v[204:207], v[40:43]
  v_mfma_f32_16x16x32_bf16 v[44:47], v[196:199], v[208:211], v[44:47]
  v_mfma_f32_16x16x32_bf16 v[48:51], v[196:199], v[212:215], v[48:51]
  s_waitcnt lgkmcnt(0)
  v_mfma_f32_16x16x32_bf16 v[36:39], v[116:119], v[180:183], v[36:39]
  v_mfma_f32_16x16x32_bf16 v[40:43], v[116:119], v[184:187], v[40:43]
  v_mfma_f32_16x16x32_bf16 v[44:47], v[116:119], v[188:191], v[44:47]
  v_mfma_f32_16x16x32_bf16 v[48:51], v[116:119], v[192:195], v[48:51]
  v_mfma_f32_16x16x32_bf16 v[40:43], v[120:123], v[180:183], v[40:43]
  v_mfma_f32_16x16x32_bf16 v[44:47], v[120:123], v[184:187], v[44:47]
  v_mfma_f32_16x16x32_bf16 v[48:51], v[120:123], v[188:191], v[48:51]
  v_mfma_f32_16x16x32_bf16 v[44:47], v[124:127], v[180:183], v[44:47]
  v_mfma_f32_16x16x32_bf16 v[48:51], v[124:127], v[184:187], v[48:51]
  v_mfma_f32_16x16x32_bf16 v[48:51], v[128:131], v[180:183], v[48:51]
  s_nop 7
  v_cvt_pk_bf16_f32 v52, v20, v21
  v_cvt_pk_bf16_f32 v53, v22, v23
  v_cvt_pk_bf16_f32 v54, v24, v25
  v_cvt_pk_bf16_f32 v55, v26, v27
  s_nop 0
  v_permlane16_swap_b32 v52, v54
  v_permlane16_swap_b32 v53, v55
  buffer_store_dwordx4 v[52:55], v4, s[60:63], s49 offen offset:0 sc1
  v_cvt_pk_bf16_f32 v56, v28, v29
  v_cvt_pk_bf16_f32 v57, v30, v31
  v_cvt_pk_bf16_f32 v58, v32, v33
  v_cvt_pk_bf16_f32 v59, v34, v35
  s_nop 0
  v_permlane16_swap_b32 v56, v58
  v_permlane16_swap_b32 v57, v59
  buffer_store_dwordx4 v[56:59], v4, s[60:63], s49 offen offset:1024 sc1
  v_cvt_pk_bf16_f32 v60, v36, v37
  v_cvt_pk_bf16_f32 v61, v38, v39
  v_cvt_pk_bf16_f32 v62, v40, v41
  v_cvt_pk_bf16_f32 v63, v42, v43
  s_nop 0
  v_permlane16_swap_b32 v60, v62
  v_permlane16_swap_b32 v61, v63
  buffer_store_dwordx4 v[60:63], v4, s[60:63], s49 offen offset:2048 sc1
  v_cvt_pk_bf16_f32 v64, v44, v45
  v_cvt_pk_bf16_f32 v65, v46, v47
  v_cvt_pk_bf16_f32 v66, v48, v49
  v_cvt_pk_bf16_f32 v67, v50, v51
  s_nop 0
  v_permlane16_swap_b32 v64, v66
  v_permlane16_swap_b32 v65, v67
  buffer_store_dwordx4 v[64:67], v4, s[60:63], s49 offen offset:3072 sc1
  s_endpgm
L_k2_end:
  s_endpgm
.globl k3_kernel
.type k3_kernel,@function
.set STAMP_BASE, 0x40000
.p2align 8
k3_kernel:
  s_cmp_ge_u32 s2, 416
  s_cbranch_scc1 L_k3_end
  s_load_dwordx2 s[60:61], s[0:1], 96
  s_mov_b32 s62, 20971520
  s_mov_b32 s63, 0x20000
  v_lshrrev_b32 v1, 6, v0
  v_and_b32 v0, 63, v0
  v_readfirstlane_b32 s3, v1
  s_nop 3
  s_cmp_lt_u32 s2, 256
  s_cbranch_scc0 L_k3_astub
  s_load_dwordx2 s[64:65], s[0:1], 80
  s_mov_b32 s66, 5242880
  s_mov_b32 s67, 0x20000
  s_getpc_b64 s[68:69]
L_ir_pc:
  s_add_u32 s68, s68, T_P3 - L_ir_pc
  s_addc_u32 s69, s69, 0
  s_mov_b32 s70, 16384
  s_mov_b32 s71, 0x20000
  s_lshr_b32 s41, s2, 2
  s_and_b32 s42, s2, 3
  v_lshlrev_b32 v2, 4, v0
  s_lshl_b32 s45, s3, 12
  s_add_u32 m0, s45, 0
  s_add_u32 s49, s45, 0
  buffer_load_dwordx4 v2, s[68:71], s49 offen lds
  s_add_u32 m0, s45, 1024
  s_add_u32 s49, s45, 1024
  buffer_load_dwordx4 v2, s[68:71], s49 offen lds
  s_add_u32 m0, s45, 2048
  s_add_u32 s49, s45, 2048
  buffer_load_dwordx4 v2, s[68:71], s49 offen lds
  s_add_u32 m0, s45, 3072
  s_add_u32 s49, s45, 3072
  buffer_load_dwordx4 v2, s[68:71], s49 offen lds
  v_lshrrev_b32 v3, 3, v0
  v_and_b32 v4, 7, v0
  v_xor_b32 v4, v4, v3
  v_lshlrev_b32 v4, 4, v4
  s_mov_b32 s46, 32768
  v_mad_u32_u24 v4, v3, s46, v4
  s_bfe_u32 s46, s41, 0x10004
  s_xor_b32 s46, s46, s42
  s_lshl_b32 s46, s46, 7
  s_lshl_b32 s47, s41, 9
  s_add_u32 s46, s46, s47
  s_mul_i32 s47, s3, 262144
  s_add_u32 s46, s46, s47
  s_add_u32 s46, s46, 12582912
  s_lshl_b32 s47, s3, 10
  s_waitcnt lgkmcnt(0)
  s_add_u32 m0, s47, 16384
  s_nop 0
  buffer_load_dwordx4 v4, s[60:63], s46 offen lds
  s_add_u32 s46, s46, 1048576
  s_add_u32 m0, s47, 20480
  s_nop 0
  buffer_load_dwordx4 v4, s[60:63], s46 offen lds
  s_add_u32 s46, s46, 1048576
  s_cmp_eq_u32 s3, 3
  s_cbranch_scc1 L_k3_irow
  s_add_u32 m0, s47, 24576
  s_cmp_eq_u32 s3, 2
  s_cselect_b64 exec, 0xff, -1
  buffer_load_dwordx4 v4, s[60:63], s46 offen lds
  s_mov_b64 exec, -1
L_k3_irow:
  v_and_b32 v3, 31, v0
  v_lshrrev_b32 v4, 5, v0
  v_and_b32 v5, 3, v3
  v_lshl_add_u32 v5, v5, 1, v4
  s_lshr_b32 s47, s41, 1
  s_and_b32 s47, s47, 7
  v_xor_b32 v5, s47, v5
  v_lshrrev_b32 v6, 2, v3
  v_xor_b32 v5, v5, v6
  v_lshlrev_b32 v5, 4, v5
  v_lshl_add_u32 v5, v6, 7, v5
  s_lshl_b32 s47, s3, 2
  s_add_u32 s47, s47, 16384
  v_add_u32 v5, s47, v5
  s_lshr_b32 s43, s42, 1
  s_lshl_b32 s43, s43, 4
  s_and_b32 s44, s42, 1
  s_lshl_b32 s44, s44, 2
  s_add_u32 s43, s43, s44
  s_lshr_b32 s44, s3, 1
  s_lshl_b32 s44, s44, 3
  s_add_u32 s43, s43, s44
  s_and_b32 s44, s3, 1
  s_lshl_b32 s44, s44, 1
  s_add_u32 s43, s43, s44
  s_lshl_b32 s43, s43, 6
  s_add_u32 s43, s43, s41
  s_mul_i32 s43, s43, 2560
  s_add_u32 s43, s43, 1280
  s_mul_i32 s45, s3, 2560
  s_add_u32 s45, s45, 27648
  v_mul_u32_u24 v6, 40, v3
  v_lshl_add_u32 v6, v4, 3, v6
  v_add_u32 v6, s45, v6
  s_mov_b32 s54, 84148480
  s_mov_b32 s55, 117834498
  s_waitcnt vmcnt(0)
  s_barrier
  ds_read_b32 v8, v5 offset:0
  ds_read_b32 v9, v5 offset:1024
  ds_read_b32 v10, v5 offset:2048
  ds_read_b32 v11, v5 offset:3072
  ds_read_b32 v12, v5 offset:4096
  ds_read_b32 v13, v5 offset:5120
  ds_read_b32 v14, v5 offset:6144
  ds_read_b32 v15, v5 offset:7168
  ds_read_b32 v16, v5 offset:8192
  ds_read_b32 v17, v5 offset:9216
  ds_read_b32 v18, v5 offset:10240
  ds_read_b128 v[20:23], v2 offset:0
  ds_read_b128 v[24:27], v2 offset:1024
  ds_read_b128 v[28:31], v2 offset:2048
  ds_read_b128 v[32:35], v2 offset:3072
  s_waitcnt lgkmcnt(4)
  v_mov_b32 v19, 0
  v_cmp_eq_u32 vcc, 0, v3
  s_nop 1
  v_cndmask_b32 v18, 0, v18, vcc
  ds_read_b128 v[36:39], v2 offset:4096
  ds_read_b128 v[40:43], v2 offset:5120
  ds_read_b128 v[44:47], v2 offset:6144
  ds_read_b128 v[48:51], v2 offset:7168
  ds_read_b128 v[52:55], v2 offset:8192
  ds_read_b128 v[56:59], v2 offset:9216
  ds_read_b128 v[60:63], v2 offset:10240
  ds_read_b128 v[64:67], v2 offset:11264
  ds_read_b128 v[68:71], v2 offset:12288
  ds_read_b128 v[72:75], v2 offset:13312
  ds_read_b128 v[76:79], v2 offset:14336
  ds_read_b128 v[80:83], v2 offset:15360
  v_perm_b32 v84, v9, v8, s54
  v_perm_b32 v85, v11, v10, s54
  v_perm_b32 v86, v13, v12, s54
  v_perm_b32 v87, v15, v14, s54
  v_perm_b32 v88, v17, v16, s54
  v_perm_b32 v89, v19, v18, s54
  v_mov_b32 v90, 0
  v_mov_b32 v91, 0
  v_perm_b32 v92, v9, v8, s55
  v_perm_b32 v93, v11, v10, s55
  v_perm_b32 v94, v13, v12, s55
  v_perm_b32 v95, v15, v14, s55
  v_perm_b32 v96, v17, v16, s55
  v_perm_b32 v97, v19, v18, s55
  v_mov_b32 v98, 0
  v_mov_b32 v99, 0
  s_waitcnt lgkmcnt(12)
  v_mfma_f32_32x32x16_bf16 v[100:115], v[84:87], v[20:23], 0
  v_mfma_f32_32x32x16_bf16 v[116:131], v[84:87], v[28:31], 0
  v_mfma_f32_32x32x16_bf16 v[100:115], v[88:91], v[24:27], v[100:115]
  v_mfma_f32_32x32x16_bf16 v[116:131], v[88:91], v[32:35], v[116:131]
  v_mfma_f32_32x32x16_bf16 v[132:147], v[92:95], v[20:23], 0
  v_mfma_f32_32x32x16_bf16 v[148:163], v[92:95], v[28:31], 0
  v_mfma_f32_32x32x16_bf16 v[132:147], v[96:99], v[24:27], v[132:147]
  v_mfma_f32_32x32x16_bf16 v[148:163], v[96:99], v[32:35], v[148:163]
  s_waitcnt lgkmcnt(0)
  s_nop 5
  v_mul_f32 v8, v100, v36
  v_mul_f32 v9, v116, v36
  v_mul_f32 v10, v101, v37
  v_mul_f32 v11, v117, v37
  v_fma_f32 v8, -v116, v52, v8
  v_fmac_f32 v9, v100, v52
  v_fma_f32 v10, -v117, v53, v10
  v_fmac_f32 v11, v101, v53
  v_cvt_pk_bf16_f32 v20, v8, v9
  v_cvt_pk_bf16_f32 v21, v10, v11
  v_mul_f32 v8, v102, v38
  v_mul_f32 v9, v118, v38
  v_mul_f32 v10, v103, v39
  v_mul_f32 v11, v119, v39
  v_fma_f32 v8, -v118, v54, v8
  v_fmac_f32 v9, v102, v54
  v_fma_f32 v10, -v119, v55, v10
  v_fmac_f32 v11, v103, v55
  v_cvt_pk_bf16_f32 v22, v8, v9
  v_cvt_pk_bf16_f32 v23, v10, v11
  v_mul_f32 v8, v104, v40
  v_mul_f32 v9, v120, v40
  v_mul_f32 v10, v105, v41
  v_mul_f32 v11, v121, v41
  v_fma_f32 v8, -v120, v56, v8
  v_fmac_f32 v9, v104, v56
  v_fma_f32 v10, -v121, v57, v10
  v_fmac_f32 v11, v105, v57
  v_cvt_pk_bf16_f32 v24, v8, v9
  v_cvt_pk_bf16_f32 v25, v10, v11
  v_mul_f32 v8, v106, v42
  v_mul_f32 v9, v122, v42
  v_mul_f32 v10, v107, v43
  v_mul_f32 v11, v123, v43
  v_fma_f32 v8, -v122, v58, v8
  v_fmac_f32 v9, v106, v58
  v_fma_f32 v10, -v123, v59, v10
  v_fmac_f32 v11, v107, v59
  v_cvt_pk_bf16_f32 v26, v8, v9
  v_cvt_pk_bf16_f32 v27, v10, v11
  v_mul_f32 v8, v108, v44
  v_mul_f32 v9, v124, v44
  v_mul_f32 v10, v109, v45
  v_mul_f32 v11, v125, v45
  v_fma_f32 v8, -v124, v60, v8
  v_fmac_f32 v9, v108, v60
  v_fma_f32 v10, -v125, v61, v10
  v_fmac_f32 v11, v109, v61
  v_cvt_pk_bf16_f32 v28, v8, v9
  v_cvt_pk_bf16_f32 v29, v10, v11
  v_mul_f32 v8, v110, v46
  v_mul_f32 v9, v126, v46
  v_mul_f32 v10, v111, v47
  v_mul_f32 v11, v127, v47
  v_fma_f32 v8, -v126, v62, v8
  v_fmac_f32 v9, v110, v62
  v_fma_f32 v10, -v127, v63, v10
  v_fmac_f32 v11, v111, v63
  v_cvt_pk_bf16_f32 v30, v8, v9
  v_cvt_pk_bf16_f32 v31, v10, v11
  v_mul_f32 v8, v112, v48
  v_mul_f32 v9, v128, v48
  v_mul_f32 v10, v113, v49
  v_mul_f32 v11, v129, v49
  v_fma_f32 v8, -v128, v64, v8
  v_fmac_f32 v9, v112, v64
  v_fma_f32 v10, -v129, v65, v10
  v_fmac_f32 v11, v113, v65
  v_cvt_pk_bf16_f32 v32, v8, v9
  v_cvt_pk_bf16_f32 v33, v10, v11
  v_mul_f32 v8, v114, v50
  v_mul_f32 v9, v130, v50
  v_mul_f32 v10, v115, v51
  v_mul_f32 v11, v131, v51
  v_fma_f32 v8, -v130, v66, v8
  v_fmac_f32 v9, v114, v66
  v_fma_f32 v10, -v131, v67, v10
  v_fmac_f32 v11, v115, v67
  v_cvt_pk_bf16_f32 v34, v8, v9
  v_cvt_pk_bf16_f32 v35, v10, v11
  v_mul_f32 v8, v132, v36
  v_mul_f32 v9, v148, v36
  v_mul_f32 v10, v133, v37
  v_mul_f32 v11, v149, v37
  v_fma_f32 v8, -v148, v52, v8
  v_fmac_f32 v9, v132, v52
  v_fma_f32 v10, -v149, v53, v10
  v_fmac_f32 v11, v133, v53
  v_cvt_pk_bf16_f32 v84, v8, v9
  v_cvt_pk_bf16_f32 v85, v10, v11
  v_mul_f32 v8, v134, v38
  v_mul_f32 v9, v150, v38
  v_mfma_f32_32x32x16_bf16 v[100:115], v[20:23], v[68:71], 0
  v_mul_f32 v10, v135, v39
  v_mul_f32 v11, v151, v39
  v_fma_f32 v8, -v150, v54, v8
  v_fmac_f32 v9, v134, v54
  v_fma_f32 v10, -v151, v55, v10
  v_fmac_f32 v11, v135, v55
  v_cvt_pk_bf16_f32 v86, v8, v9
  v_cvt_pk_bf16_f32 v87, v10, v11
  v_mul_f32 v8, v136, v40
  v_mul_f32 v9, v152, v40
  v_mul_f32 v10, v137, v41
  v_mul_f32 v11, v153, v41
  v_mfma_f32_32x32x16_bf16 v[100:115], v[24:27], v[72:75], v[100:115]
  v_fma_f32 v8, -v152, v56, v8
  v_fmac_f32 v9, v136, v56
  v_fma_f32 v10, -v153, v57, v10
  v_fmac_f32 v11, v137, v57
  v_cvt_pk_bf16_f32 v88, v8, v9
  v_cvt_pk_bf16_f32 v89, v10, v11
  v_mul_f32 v8, v138, v42
  v_mul_f32 v9, v154, v42
  v_mul_f32 v10, v139, v43
  v_mul_f32 v11, v155, v43
  v_fma_f32 v8, -v154, v58, v8
  v_fmac_f32 v9, v138, v58
  v_mfma_f32_32x32x16_bf16 v[100:115], v[28:31], v[76:79], v[100:115]
  v_fma_f32 v10, -v155, v59, v10
  v_fmac_f32 v11, v139, v59
  v_cvt_pk_bf16_f32 v90, v8, v9
  v_cvt_pk_bf16_f32 v91, v10, v11
  v_mul_f32 v8, v140, v44
  v_mul_f32 v9, v156, v44
  v_mul_f32 v10, v141, v45
  v_mul_f32 v11, v157, v45
  v_fma_f32 v8, -v156, v60, v8
  v_fmac_f32 v9, v140, v60
  v_fma_f32 v10, -v157, v61, v10
  v_fmac_f32 v11, v141, v61
  v_mfma_f32_32x32x16_bf16 v[100:115], v[32:35], v[80:83], v[100:115]
  v_cvt_pk_bf16_f32 v92, v8, v9
  v_cvt_pk_bf16_f32 v93, v10, v11
  v_mul_f32 v8, v142, v46
  v_mul_f32 v9, v158, v46
  v_mul_f32 v10, v143, v47
  v_mul_f32 v11, v159, v47
  v_fma_f32 v8, -v158, v62, v8
  v_fmac_f32 v9, v142, v62
  v_fma_f32 v10, -v159, v63, v10
  v_fmac_f32 v11, v143, v63
  v_cvt_pk_bf16_f32 v94, v8, v9
  v_cvt_pk_bf16_f32 v95, v10, v11
  v_mul_f32 v8, v144, v48
  v_mul_f32 v9, v160, v48
  v_mul_f32 v10, v145, v49
  v_mul_f32 v11, v161, v49
  v_fma_f32 v8, -v160, v64, v8
  v_fmac_f32 v9, v144, v64
  v_fma_f32 v10, -v161, v65, v10
  v_fmac_f32 v11, v145, v65
  v_cvt_pk_bf16_f32 v96, v8, v9
  v_cvt_pk_bf16_f32 v97, v10, v11
  v_mul_f32 v8, v146, v50
  v_mul_f32 v9, v162, v50
  v_mul_f32 v10, v147, v51
  v_mul_f32 v11, v163, v51
  v_fma_f32 v8, -v162, v66, v8
  v_fmac_f32 v9, v146, v66
  v_fma_f32 v10, -v163, v67, v10
  v_fmac_f32 v11, v147, v67
  v_cvt_pk_bf16_f32 v98, v8, v9
  v_cvt_pk_bf16_f32 v99, v10, v11
  v_mfma_f32_32x32x16_bf16 v[132:147], v[84:87], v[68:71], 0
  v_mfma_f32_32x32x16_bf16 v[132:147], v[88:91], v[72:75], v[132:147]
  v_mfma_f32_32x32x16_bf16 v[132:147], v[92:95], v[76:79], v[132:147]
  v_mfma_f32_32x32x16_bf16 v[132:147], v[96:99], v[80:83], v[132:147]
  v_cvt_pk_bf16_f32 v116, v100, v101
  v_cvt_pk_bf16_f32 v117, v102, v103
  v_cvt_pk_bf16_f32 v118, v104, v105
  v_cvt_pk_bf16_f32 v119, v106, v107
  v_cvt_pk_bf16_f32 v120, v108, v109
  v_cvt_pk_bf16_f32 v121, v110, v111
  ds_write_b64 v6, v[116:117] offset:0
  ds_write_b64 v6, v[118:119] offset:16
  s_mov_b32 exec_hi, 0
  ds_write_b64 v6, v[120:121] offset:32
  s_mov_b32 exec_hi, -1
  s_nop 0
  v_cvt_pk_bf16_f32 v148, v132, v133
  v_cvt_pk_bf16_f32 v149, v134, v135
  v_cvt_pk_bf16_f32 v150, v136, v137
  v_cvt_pk_bf16_f32 v151, v138, v139
  v_cvt_pk_bf16_f32 v152, v140, v141
  v_cvt_pk_bf16_f32 v153, v142, v143
  ds_write_b64 v6, v[148:149] offset:1280
  ds_write_b64 v6, v[150:151] offset:1296
  s_mov_b32 exec_hi, 0
  ds_write_b64 v6, v[152:153] offset:1312
  s_mov_b32 exec_hi, -1
  v_add_u32 v7, s45, v2
  ds_read_b128 v[8:11], v7 offset:0
  ds_read_b128 v[12:15], v7 offset:1024
  ds_read_b128 v[16:19], v7 offset:2048
  v_lshrrev_b32 v5, 4, v0
  v_min_u32 v5, 1, v5
  v_mul_u32_u24 v5, 162560, v5
  v_add_u32 v4, v2, v5
  s_add_u32 s47, s43, 1024
  s_add_u32 s48, s43, 164608
  s_waitcnt lgkmcnt(2)
  buffer_store_dwordx4 v[8:11], v2, s[64:67], s43 offen sc1
  s_waitcnt lgkmcnt(1)
  buffer_store_dwordx4 v[12:15], v4, s[64:67], s47 offen sc1
  s_waitcnt lgkmcnt(0)
  s_mov_b32 exec_hi, 0
  buffer_store_dwordx4 v[16:19], v2, s[64:67], s48 offen sc1
  s_endpgm
L_k3_astub:
  s_load_dwordx2 s[64:65], s[0:1], 80
  s_mov_b32 s66, 5242880
  s_mov_b32 s67, 0x20000
  s_cmp_ge_u32 s3, 2
  s_cbranch_scc1 L_k3_end
  s_sub_u32 s41, s2, 256
  s_lshl_b32 s41, s41, 1
  s_add_u32 s41, s41, s3
  s_mul_i32 s42, s41, 6554
  s_lshr_b32 s42, s42, 16
  s_mul_i32 s43, s42, 10
  s_sub_u32 s43, s41, s43
  v_and_b32 v2, 7, v0
  v_lshrrev_b32 v3, 3, v0
  s_mul_i32 s44, s43, 262144
  s_lshl_b32 s45, s42, 7
  s_add_u32 s44, s44, s45
  s_add_u32 s44, s44, 15728640
  v_mul_u32_u24 v4, 4096, v3
  v_lshl_add_u32 v4, v2, 4, v4
  s_waitcnt lgkmcnt(0)
  buffer_load_dwordx4 v[16:19], v4, s[60:63], s44 offen
  s_add_u32 s44, s44, 32768
  buffer_load_dwordx4 v[20:23], v4, s[60:63], s44 offen
  s_add_u32 s44, s44, 32768
  buffer_load_dwordx4 v[24:27], v4, s[60:63], s44 offen
  s_add_u32 s44, s44, 32768
  buffer_load_dwordx4 v[28:31], v4, s[60:63], s44 offen
  s_add_u32 s44, s44, 32768
  buffer_load_dwordx4 v[32:35], v4, s[60:63], s44 offen
  s_add_u32 s44, s44, 32768
  buffer_load_dwordx4 v[36:39], v4, s[60:63], s44 offen
  s_add_u32 s44, s44, 32768
  buffer_load_dwordx4 v[40:43], v4, s[60:63], s44 offen
  s_add_u32 s44, s44, 32768
  buffer_load_dwordx4 v[44:47], v4, s[60:63], s44 offen
L_k3_aout:
  s_lshl_b32 s46, s3, 13
  s_mov_b32 s54, 84148480
  s_mov_b32 s55, 117834498
  v_lshlrev_b32 v6, 7, v3
  v_lshl_add_u32 v6, v2, 4, v6
  v_add_u32 v6, s46, v6
  v_mov_b32 v8, v6
  s_waitcnt vmcnt(7)
  ds_write_b128 v8, v[16:19] offset:0
  v_xor_b32 v8, 16, v6
  s_waitcnt vmcnt(6)
  ds_write_b128 v8, v[20:23] offset:1024
  v_xor_b32 v8, 32, v6
  s_waitcnt vmcnt(5)
  ds_write_b128 v8, v[24:27] offset:2048
  v_xor_b32 v8, 48, v6
  s_waitcnt vmcnt(4)
  ds_write_b128 v8, v[28:31] offset:3072
  v_xor_b32 v8, 64, v6
  s_waitcnt vmcnt(3)
  ds_write_b128 v8, v[32:35] offset:4096
  v_xor_b32 v8, 80, v6
  s_waitcnt vmcnt(2)
  ds_write_b128 v8, v[36:39] offset:5120
  v_xor_b32 v8, 96, v6
  s_waitcnt vmcnt(1)
  ds_write_b128 v8, v[40:43] offset:6144
  v_xor_b32 v8, 112, v6
  s_waitcnt vmcnt(0)
  ds_write_b128 v8, v[44:47] offset:7168
  v_xor_b32 v4, v2, v3
  v_lshlrev_b32 v4, 4, v4
  v_lshl_add_u32 v4, v2, 10, v4
  v_add_u32 v4, s46, v4
  ds_read_b128 v[64:67], v4 offset:0
  ds_read_b128 v[68:71], v4 offset:128
  ds_read_b128 v[72:75], v4 offset:256
  ds_read_b128 v[76:79], v4 offset:384
  ds_read_b128 v[80:83], v4 offset:512
  ds_read_b128 v[84:87], v4 offset:640
  ds_read_b128 v[88:91], v4 offset:768
  ds_read_b128 v[92:95], v4 offset:896
  s_mul_i32 s44, s42, 163840
  s_lshl_b32 s45, s43, 7
  s_add_u32 s44, s44, s45
  v_mul_u32_u24 v5, 20480, v3
  v_lshl_add_u32 v5, v2, 4, v5
  s_waitcnt lgkmcnt(0)
  v_perm_b32 v16, v68, v64, s54
  v_perm_b32 v17, v76, v72, s54
  v_perm_b32 v18, v84, v80, s54
  v_perm_b32 v19, v92, v88, s54
  buffer_store_dwordx4 v[16:19], v5, s[64:67], s44 offen sc1
  s_add_u32 s44, s44, 2560
  v_perm_b32 v20, v68, v64, s55
  v_perm_b32 v21, v76, v72, s55
  v_perm_b32 v22, v84, v80, s55
  v_perm_b32 v23, v92, v88, s55
  buffer_store_dwordx4 v[20:23], v5, s[64:67], s44 offen sc1
  s_add_u32 s44, s44, 2560
  v_perm_b32 v24, v69, v65, s54
  v_perm_b32 v25, v77, v73, s54
  v_perm_b32 v26, v85, v81, s54
  v_perm_b32 v27, v93, v89, s54
  buffer_store_dwordx4 v[24:27], v5, s[64:67], s44 offen sc1
  s_add_u32 s44, s44, 2560
  v_perm_b32 v28, v69, v65, s55
  v_perm_b32 v29, v77, v73, s55
  v_perm_b32 v30, v85, v81, s55
  v_perm_b32 v31, v93, v89, s55
  buffer_store_dwordx4 v[28:31], v5, s[64:67], s44 offen sc1
  s_add_u32 s44, s44, 2560
  v_perm_b32 v32, v70, v66, s54
  v_perm_b32 v33, v78, v74, s54
  v_perm_b32 v34, v86, v82, s54
  v_perm_b32 v35, v94, v90, s54
  buffer_store_dwordx4 v[32:35], v5, s[64:67], s44 offen sc1
  s_add_u32 s44, s44, 2560
  v_perm_b32 v36, v70, v66, s55
  v_perm_b32 v37, v78, v74, s55
  v_perm_b32 v38, v86, v82, s55
  v_perm_b32 v39, v94, v90, s55
  buffer_store_dwordx4 v[36:39], v5, s[64:67], s44 offen sc1
  s_add_u32 s44, s44, 2560
  v_perm_b32 v40, v71, v67, s54
  v_perm_b32 v41, v79, v75, s54
  v_perm_b32 v42, v87, v83, s54
  v_perm_b32 v43, v95, v91, s54
  buffer_store_dwordx4 v[40:43], v5, s[64:67], s44 offen sc1
  s_add_u32 s44, s44, 2560
  v_perm_b32 v44, v71, v67, s55
  v_perm_b32 v45, v79, v75, s55
  v_perm_b32 v46, v87, v83, s55
  v_perm_b32 v47, v95, v91, s55
  buffer_store_dwordx4 v[44:47], v5, s[64:67], s44 offen sc1
  s_endpgm
L_k3_end:
  s_endpgm
.p2align 8
T_P2:
.long 0x3f803f80,0x3f803f80,0x3f803f80,0x3f803f80,0x3f7b3f80,0x3f553f6d,0xbe48248d,0xbf0ebec4
.long 0x3f6d3f80,0x3ec43f35,0xbf6dbf80,0xbec4bf35,0x3f553f80,0xbe483ec4,0x3f0ea554,0x3f7b3f6d
.long 0x3f353f80,0xbf35248d,0x3f353f80,0xbf3525b0,0x3f0e3f80,0xbf7bbec4,0xbf5525b0,0xbe48bf6d
.long 0x3ec43f80,0xbf6dbf35,0xbec4bf80,0x3f6d3f35,0x3e483f80,0xbf0ebf6d,0x3f7ba5f7,0xbf553ec4
.long 0x248d3f80,0xa554bf80,0x261f3f80,0xa731bf80,0xbe483f80,0x3f0ebf6d,0xbf7b261f,0x3f553ec4
.long 0xbec43f80,0x3f6dbf35,0x3ec4bf80,0xbf6d3f35,0xbf0e3f80,0x3f7bbec4,0x3f55a731,0x3e48bf6d
.long 0xbf353f80,0x3f35a554,0xbf353f80,0x3f35a742,0xbf553f80,0x3e483ec4,0xbf0ea68d,0xbf7b3f6d
.long 0xbf6d3f80,0xbec43f35,0x3f6dbf80,0x3ec4bf35,0xbf7b3f80,0xbf553f6d,0x3e48a742,0x3f0ebec4
.long 0xbf803f80,0xbf803f80,0xbf803f80,0xbf803f80,0xbf7b3f80,0xbf553f6d,0x3e48a654,0x3f0ebec4
.long 0xbf6d3f80,0xbec43f35,0x3f6dbf80,0x3ec4bf35,0xbf553f80,0x3e483ec4,0xbf0ea754,0xbf7b3f6d
.long 0xbf353f80,0x3f3525b0,0xbf353f80,0x3f35a58e,0xbf0e3f80,0x3f7bbec4,0x3f55a60d,0x3e48bf6d
.long 0xbec43f80,0x3f6dbf35,0x3ec4bf80,0xbf6d3f35,0xbe483f80,0x3f0ebf6d,0xbf7ba765,0x3f553ec4
.long 0xa5543f80,0x261fbf80,0xa7773f80,0x258dbf80,0x3e483f80,0xbf0ebf6d,0x3f7ba58e,0xbf553ec4
.long 0x3ec43f80,0xbf6dbf35,0xbec4bf80,0x3f6d3f35,0x3f0e3f80,0xbf7bbec4,0xbf55a777,0xbe48bf6d
.long 0x3f353f80,0xbf35a5f7,0x3f353f80,0xbf35a78d,0x3f553f80,0xbe483ec4,0x3f0ea137,0x3f7b3f6d
.long 0x3f6d3f80,0x3ec43f35,0xbf6dbf80,0xbec4bf35,0x3f7b3f80,0x3f553f6d,0xbe48a784,0xbf0ebec4
.long 0x3f803f80,0x3f803f80,0x3f803f80,0x3f803f80,0x3f0e3f35,0x3e483ec4,0xbf55bf35,0xbf7bbf6d
.long 0xbec4248d,0xbf6dbf35,0x3ec4a554,0x3f6d3f35,0xbf7bbf35,0xbf0ebf6d,0x3e483f35,0xbf55bec4
.long 0xbf35bf80,0x3f35a554,0xbf35bf80,0x3f35a5f7,0x3e48bf35,0x3f553f6d,0x3f7b3f35,0xbf0e3ec4
.long 0x3f6da554,0xbec43f35,0xbf6d261f,0x3ec4bf35,0x3f553f35,0xbf7bbec4,0x3f0ebf35,0xbe483f6d
.long 0x25b03f80,0xa5f7bf80,0xa68d3f80,0xa742bf80,0xbf553f35,0x3f7bbec4,0xbf0ebf35,0x3e483f6d
.long 0xbf6d25b0,0x3ec43f35,0x3f6da742,0xbec4bf35,0xbe48bf35,0xbf553f6d,0xbf7b3f35,0x3f0e3ec4
.long 0x3f35bf80,0xbf35261f,0x3f35bf80,0xbf35a60d,0x3f7bbf35,0x3f0ebf6d,0xbe483f35,0x3f55bec4
.long 0x3ec4a5f7,0x3f6dbf35,0xbec4a60d,0xbf6d3f35,0xbf0e3f35,0xbe483ec4,0x3f55bf35,0x3f7bbf6d
.long 0xbf803f80,0xbf803f80,0xbf803f80,0xbf803f80,0xbf0e3f35,0xbe483ec4,0x3f55bf35,0x3f7bbf6d
.long 0x3ec4261f,0x3f6dbf35,0xbec4a777,0xbf6d3f35,0x3f7bbf35,0x3f0ebf6d,0xbe483f35,0x3f55bec4
.long 0x3f35bf80,0xbf35a742,0x3f35bf80,0xbf35a78d,0xbe48bf35,0xbf553f6d,0xbf7b3f35,0x3f0e3ec4
.long 0xbf6da731,0x3ec43f35,0x3f6d2804,0xbec4bf35,0xbf553f35,0x3f7bbec4,0xbf0ebf35,0x3e483f6d
.long 0xa7423f80,0xa60dbf80,0xa7963f80,0x268dbf80,0x3f553f35,0xbf7bbec4,0x3f0ebf35,0xbe483f6d
.long 0x3f6da68d,0xbec43f35,0xbf6d2754,0x3ec4bf35,0x3e48bf35,0x3f553f6d,0x3f7b3f35,0xbf0e3ec4
.long 0xbf35bf80,0x3f35a60d,0xbf35bf80,0x3f352816,0xbf7bbf35,0xbf0ebf6d,0x3e483f35,0xbf55bec4
.long 0xbec4a742,0xbf6dbf35,0x3ec42889,0x3f6d3f35,0x3f0e3f35,0x3e483ec4,0xbf55bf35,0xbf7bbf6d
.long 0x3f803f80,0x3f803f80,0x3f803f80,0x3f803f80,0xbf7bbf80,0xbf55bf6d,0x3e48a554,0x3f0e3ec4
.long 0x3f6d3f80,0x3ec43f35,0xbf6dbf80,0xbec4bf35,0xbf55bf80,0x3e48bec4,0xbf0e261f,0xbf7bbf6d
.long 0x3f353f80,0xbf35261f,0x3f353f80,0xbf35a68d,0xbf0ebf80,0x3f7b3ec4,0x3f55a742,0x3e483f6d
.long 0x3ec43f80,0xbf6dbf35,0xbec4bf80,0x3f6d3f35,0xbe48bf80,0x3f0e3f6d,0xbf7ba60d,0x3f55bec4
.long 0xa6543f80,0xa754bf80,0xa58e3f80,0xa777bf80,0x3e48bf80,0xbf0e3f6d,0x3f7ba777,0xbf55bec4
.long 0xbec43f80,0x3f6dbf35,0x3ec4bf80,0xbf6d3f35,0x3f0ebf80,0xbf7b3ec4,0xbf552804,0xbe483f6d
.long 0xbf353f80,0x3f35a777,0xbf353f80,0x3f35a796,0x3f55bf80,0xbe48bec4,0x3f0e2754,0x3f7bbf6d
.long 0xbf6d3f80,0xbec43f35,0x3f6dbf80,0x3ec4bf35,0x3f7bbf80,0x3f55bf6d,0xbe482889,0xbf0e3ec4
.long 0xbf803f80,0xbf803f80,0xbf803f80,0xbf803f80,0x3f7bbf80,0x3f55bf6d,0xbe482828,0xbf0e3ec4
.long 0xbf6d3f80,0xbec43f35,0x3f6dbf80,0x3ec4bf35,0x3f55bf80,0xbe48bec4,0x3f0e281f,0x3f7bbf6d
.long 0xbf353f80,0x3f35268d,0xbf353f80,0x3f352828,0x3f0ebf80,0xbf7b3ec4,0xbf5526d4,0xbe483f6d
.long 0xbec43f80,0x3f6dbf35,0x3ec4bf80,0xbf6d3f35,0x3e48bf80,0xbf0e3f6d,0x3f7b2730,0xbf55bec4
.long 0xa7b13f80,0x281fbf80,0xa7e53f80,0x2839bf80,0xbe48bf80,0x3f0e3f6d,0xbf7ba7e5,0x3f55bec4
.long 0x3ec43f80,0xbf6dbf35,0xbec4bf80,0x3f6d3f35,0xbf0ebf80,0x3f7b3ec4,0x3f552839,0x3e483f6d
.long 0x3f353f80,0xbf3526d4,0x3f353f80,0xbf35a804,0xbf55bf80,0x3e48bec4,0xbf0ea880,0xbf7bbf6d
.long 0x3f6d3f80,0x3ec43f35,0xbf6dbf80,0xbec4bf35,0xbf7bbf80,0xbf55bf6d,0x3e4828a3,0x3f0e3ec4
.long 0x3f803f80,0x3f803f80,0x3f803f80,0x3f803f80,0xbf0ebf35,0xbe48bec4,0x3f553f35,0x3f7b3f6d
.long 0xbec425b0,0xbf6dbf35,0x3ec4a5f7,0x3f6d3f35,0x3f7b3f35,0x3f0e3f6d,0xbe48bf35,0x3f553ec4
.long 0xbf35bf80,0x3f35a731,0xbf35bf80,0x3f35a742,0xbe483f35,0xbf55bf6d,0xbf7bbf35,0x3f0ebec4
.long 0x3f6da742,0xbec43f35,0xbf6da60d,0x3ec4bf35,0xbf55bf35,0x3f7b3ec4,0xbf0e3f35,0x3e48bf6d
.long 0xa60d3f80,0xa765bf80,0xa1373f80,0xa784bf80,0x3f55bf35,0xbf7b3ec4,0x3f0e3f35,0xbe48bf6d
.long 0xbf6da58e,0x3ec43f35,0x3f6da78d,0xbec4bf35,0x3e483f35,0x3f55bf6d,0x3f7bbf35,0xbf0ebec4
.long 0x3f35bf80,0xbf35258d,0x3f35bf80,0xbf35268d,0xbf7b3f35,0xbf0e3f6d,0x3e48bf35,0xbf553ec4
.long 0x3ec4a78d,0x3f6dbf35,0xbec42816,0xbf6d3f35,0x3f0ebf35,0x3e48bec4,0xbf553f35,0xbf7b3f6d
.long 0xbf803f80,0xbf803f80,0xbf803f80,0xbf803f80,0x3f0ebf35,0x3e48bec4,0xbf553f35,0xbf7b3f6d
.long 0x3ec4268d,0x3f6dbf35,0xbec426d4,0xbf6d3f35,0xbf7b3f35,0xbf0e3f6d,0x3e48bf35,0xbf553ec4
.long 0x3f35bf80,0xbf35270d,0x3f35bf80,0xbf35a7e5,0x3e483f35,0x3f55bf6d,0x3f7bbf35,0xbf0ebec4
.long 0xbf6da85d,0x3ec43f35,0x3f6d289a,0xbec4bf35,0x3f55bf35,0xbf7b3ec4,0x3f0e3f35,0xbe48bf6d
.long 0x26d43f80,0x2730bf80,0xa8803f80,0x28a3bf80,0xbf55bf35,0x3f7b3ec4,0xbf0e3f35,0x3e48bf6d
.long 0x3f6da7b1,0xbec43f35,0xbf6d28be,0x3ec4bf35,0xbe483f35,0xbf55bf6d,0xbf7bbf35,0x3f0ebec4
.long 0xbf35bf80,0x3f352754,0xbf35bf80,0x3f35a731,0x3f7b3f35,0x3f0e3f6d,0xbe48bf35,0x3f553ec4
.long 0xbec4a7e5,0xbf6dbf35,0x3ec428ea,0x3f6d3f35,0xbf0ebf35,0xbe48bec4,0x3f553f35,0x3f7b3f6d
.long 0x0,0x0,0x0,0x0,0x3e480000,0x3f0e3ec4,0x3f7b3f80,0x3f553f6d
.long 0x3ec40000,0x3f6d3f35,0xbec4250d,0xbf6dbf35,0x3f0e0000,0x3f7b3f6d,0xbf55bf80,0x3e48bec4
.long 0x3f350000,0x3f353f80,0x3f35a58d,0x3f353f80,0x3f550000,0x3e483f6d,0x3f0e3f80,0xbf7bbec4
.long 0x3f6d0000,0xbec43f35,0xbf6d25d4,0x3ec4bf35,0x3f7b0000,0xbf553ec4,0xbe48bf80,0x3f0e3f6d
.long 0x3f800000,0xbf80250d,0x3f80a60d,0xbf802630,0x3f7b0000,0xbf55bec4,0xbe483f80,0x3f0ebf6d
.long 0x3f6d0000,0xbec4bf35,0xbf6d2630,0x3ec43f35,0x3f550000,0x3e48bf6d,0x3f0ebf80,0xbf7b3ec4
.long 0x3f350000,0x3f35bf80,0x3f35a654,0x3f35bf80,0x3f0e0000,0x3f7bbf6d,0xbf553f80,0x3e483ec4
.long 0x3ec40000,0x3f6dbf35,0xbec42677,0xbf6d3f35,0x3e480000,0x3f0ebec4,0x3f7bbf80,0x3f55bf6d
.long 0x250d0000,0x25d4a58d,0x269fa68d,0x27b1a6b0,0xbe480000,0xbf0e3ec4,0xbf7b3f80,0xbf553f6d
.long 0xbec40000,0xbf6d3f35,0x3ec4269f,0x3f6dbf35,0xbf0e0000,0xbf7b3f6d,0x3f55bf80,0xbe48bec4
.long 0xbf350000,0xbf353f80,0xbf35a6b0,0xbf353f80,0xbf550000,0xbe483f6d,0xbf0e3f80,0x3f7bbec4
.long 0xbf6d0000,0x3ec43f35,0x3f6d27b1,0xbec4bf35,0xbf7b0000,0x3f553ec4,0x3e48bf80,0xbf0e3f6d
.long 0xbf800000,0x3f8025d4,0xbf80a6d4,0x3f8027c2,0xbf7b0000,0x3f55bec4,0x3e483f80,0xbf0ebf6d
.long 0xbf6d0000,0x3ec4bf35,0x3f6da70d,0xbec43f35,0xbf550000,0xbe48bf6d,0xbf0ebf80,0x3f7b3ec4
.long 0xbf350000,0xbf35bf80,0xbf35a6f7,0xbf35bf80,0xbf0e0000,0xbf7bbf6d,0x3f553f80,0xbe483ec4
.long 0xbec40000,0xbf6dbf35,0x3ec427c2,0x3f6d3f35,0xbe480000,0xbf0ebec4,0xbf7bbf80,0xbf55bf6d
.long 0x0,0x0,0x0,0x0,0x3f553f35,0x3f7b3f6d,0x3f0e3f35,0x3e483ec4
.long 0x3f6d3f80,0x3ec43f35,0xbf6dbf80,0xbec4bf35,0x3e483f35,0xbf55bec4,0x3f7b3f35,0x3f0e3f6d
.long 0xbf35250d,0xbf35bf80,0xbf3525d4,0xbf35bf80,0xbf7bbf35,0x3f0ebec4,0x3e48bf35,0x3f553f6d
.long 0xbec4bf80,0x3f6d3f35,0x3ec43f80,0xbf6dbf35,0x3f0ebf35,0xbe483f6d,0xbf55bf35,0x3f7b3ec4
.long 0x3f80a58d,0xbf8025d4,0x3f80a654,0xbf802677,0x3f0e3f35,0xbe48bf6d,0xbf553f35,0x3f7bbec4
.long 0xbec43f80,0x3f6dbf35,0x3ec4bf80,0xbf6d3f35,0xbf7b3f35,0x3f0e3ec4,0x3e483f35,0x3f55bf6d
.long 0xbf3525d4,0xbf353f80,0xbf35269f,0xbf353f80,0x3e48bf35,0xbf553ec4,0x3f7bbf35,0x3f0ebf6d
.long 0x3f6dbf80,0x3ec4bf35,0xbf6d3f80,0xbec43f35,0x3f55bf35,0x3f7bbf6d,0x3f0ebf35,0x3e48bec4
.long 0x2630a60d,0x2677a654,0xa70da6d4,0x27c2a6f7,0xbf553f35,0xbf7b3f6d,0xbf0e3f35,0xbe483ec4
.long 0xbf6d3f80,0xbec43f35,0x3f6dbf80,0x3ec4bf35,0xbe483f35,0x3f55bec4,0xbf7b3f35,0xbf0e3f6d
.long 0x3f352630,0x3f35bf80,0x3f3527c2,0x3f35bf80,0x3f7bbf35,0xbf0ebec4,0xbe48bf35,0xbf553f6d
.long 0x3ec4bf80,0xbf6d3f35,0xbec43f80,0x3f6dbf35,0xbf0ebf35,0x3e483f6d,0x3f55bf35,0xbf7b3ec4
.long 0xbf80a654,0x3f80269f,0xbf80a71f,0x3f80a68d,0xbf0e3f35,0x3e48bf6d,0x3f553f35,0xbf7bbec4
.long 0x3ec43f80,0xbf6dbf35,0xbec4bf80,0x3f6d3f35,0x3f7b3f35,0xbf0e3ec4,0xbe483f35,0xbf55bf6d
.long 0x3f352677,0x3f353f80,0x3f35a68d,0x3f353f80,0xbe48bf35,0x3f553ec4,0xbf7bbf35,0xbf0ebf6d
.long 0xbf6dbf80,0xbec4bf35,0x3f6d3f80,0x3ec43f35,0xbf55bf35,0xbf7bbf6d,0xbf0ebf35,0xbe48bec4
.long 0x0,0x0,0x0,0x0,0xbe48250d,0xbf0ebec4,0xbf7bbf80,0xbf55bf6d
.long 0x3ec4a58d,0x3f6d3f35,0xbec425d4,0xbf6dbf35,0xbf0e25d4,0xbf7bbf6d,0x3f553f80,0xbe483ec4
.long 0x3f35a60d,0x3f353f80,0x3f35a654,0x3f353f80,0xbf552630,0xbe48bf6d,0xbf0ebf80,0x3f7b3ec4
.long 0x3f6da654,0xbec43f35,0xbf6d269f,0x3ec4bf35,0xbf7b2677,0x3f55bec4,0x3e483f80,0xbf0ebf6d
.long 0x3f80a68d,0xbf80269f,0x3f80a6d4,0xbf80a70d,0xbf7b269f,0x3f553ec4,0x3e48bf80,0xbf0e3f6d
.long 0x3f6da6b0,0xbec4bf35,0xbf6d27c2,0x3ec43f35,0xbf5527b1,0xbe483f6d,0xbf0e3f80,0x3f7bbec4
.long 0x3f35a6d4,0x3f35bf80,0x3f35a71f,0x3f35bf80,0xbf0ea70d,0xbf7b3f6d,0x3f55bf80,0xbe48bec4
.long 0x3ec4a6f7,0x3f6dbf35,0xbec4a68d,0xbf6d3f35,0xbe4827c2,0xbf0e3ec4,0xbf7b3f80,0xbf553f6d
.long 0xa6d4a70d,0x27d4a71f,0xa60ea754,0x27f7278d,0x3e48a6d4,0x3f0ebec4,0x3f7bbf80,0x3f55bf6d
.long 0xbec4a71f,0xbf6d3f35,0x3ec427f7,0x3f6dbf35,0x3f0e27d4,0x3f7bbf6d,0xbf553f80,0x3e483ec4
.long 0xbf35a730,0xbf353f80,0xbf35a842,0xbf353f80,0x3f55a68d,0x3e48bf6d,0x3f0ebf80,0xbf7b3ec4
.long 0xbf6da831,0x3ec43f35,0x3f6d2884,0xbec4bf35,0x3f7b27e5,0xbf55bec4,0xbe483f80,0x3f0ebf6d
.long 0xbf80a754,0x3f8027f7,0xbf80a79f,0x3f802816,0x3f7ba60e,0xbf553ec4,0xbe48bf80,0x3f0e3f6d
.long 0xbf6d278d,0x3ec4bf35,0x3f6da7d4,0xbec43f35,0x3f5527f7,0x3e483f6d,0x3f0e3f80,0xbf7bbec4
.long 0xbf35a777,0xbf35bf80,0xbf35270d,0xbf35bf80,0x3f0ea1b7,0x3f7b3f6d,0xbf55bf80,0x3e48bec4
.long 0xbec4a842,0xbf6dbf35,0x3ec42909,0x3f6d3f35,0x3e482804,0x3f0e3ec4,0x3f7b3f80,0x3f553f6d
.long 0x0,0x0,0x0,0x0,0xbf55bf35,0xbf7bbf6d,0xbf0ebf35,0xbe48bec4
.long 0x3f6d3f80,0x3ec43f35,0xbf6dbf80,0xbec4bf35,0xbe48bf35,0x3f553ec4,0xbf7bbf35,0xbf0ebf6d
.long 0xbf352630,0xbf35bf80,0xbf352677,0xbf35bf80,0x3f7b3f35,0xbf0e3ec4,0xbe483f35,0xbf55bf6d
.long 0xbec4bf80,0x3f6d3f35,0x3ec43f80,0xbf6dbf35,0xbf0e3f35,0x3e48bf6d,0x3f553f35,0xbf7bbec4
.long 0x3f80a6b0,0xbf8027b1,0x3f80a6f7,0xbf8027c2,0xbf0ebf35,0x3e483f6d,0x3f55bf35,0xbf7b3ec4
.long 0xbec43f80,0x3f6dbf35,0x3ec4bf80,0xbf6d3f35,0x3f7bbf35,0xbf0ebec4,0xbe48bf35,0xbf553f6d
.long 0xbf3527c2,0xbf353f80,0xbf35a68d,0xbf353f80,0xbe483f35,0x3f55bec4,0xbf7b3f35,0xbf0e3f6d
.long 0x3f6dbf80,0x3ec4bf35,0xbf6d3f80,0xbec43f35,0xbf553f35,0xbf7b3f6d,0xbf0e3f35,0xbe483ec4
.long 0xa68da730,0x27e5a831,0xa1b7a777,0x2804a842,0x3f55bf35,0x3f7bbf6d,0x3f0ebf35,0x3e48bec4
.long 0xbf6d3f80,0xbec43f35,0x3f6dbf80,0x3ec4bf35,0x3e48bf35,0xbf553ec4,0x3f7bbf35,0x3f0ebf6d
.long 0x3f35a60e,0x3f35bf80,0x3f35280d,0x3f35bf80,0xbf7b3f35,0x3f0e3ec4,0x3e483f35,0x3f55bf6d
.long 0x3ec4bf80,0xbf6d3f35,0xbec43f80,0x3f6dbf35,0x3f0e3f35,0xbe48bf6d,0xbf553f35,0x3f7bbec4
.long 0xbf80a842,0x3f80260d,0xbf80270d,0x3f80270d,0x3f0ebf35,0xbe483f6d,0xbf55bf35,0x3f7b3ec4
.long 0x3ec43f80,0xbf6dbf35,0xbec4bf80,0x3f6d3f35,0xbf7bbf35,0x3f0ebec4,0x3e48bf35,0x3f553f6d
.long 0x3f35280d,0x3f353f80,0x3f352896,0x3f353f80,0x3e483f35,0xbf55bec4,0x3f7b3f35,0x3f0e3f6d
.long 0xbf6dbf80,0xbec4bf35,0x3f6d3f80,0x3ec43f35,0x3f553f35,0x3f7b3f6d,0x3f0e3f35,0x3e483ec4
.long 0x3f803f80,0x3f803f80,0x3f803f80,0x3f803f80,0x3f753f7f,0x3f463f62,0xbe95bdc9,0xbf22bef1
.long 0x3f553f7b,0x3e483f0e,0xbf55bf7b,0xbe48bf0e,0x3f223f75,0xbef13dc9,0x3f463e95,0x3f623f7f
.long 0x3ec43f6d,0xbf6dbec4,0x3ec43f6d,0xbf6dbec4,0x3dc93f62,0xbf75bf46,0xbf7fbef1,0x3e95bf22
.long 0xbe483f55,0xbf0ebf7b,0x3e48bf55,0x3f0e3f7b,0xbef13f46,0x3dc9bf75,0x3f623f22,0xbf7fbe95
.long 0xbf353f35,0x3f35bf35,0xbf353f35,0x3f35bf35,0xbf623f22,0x3f7fbe95,0xbef1bf46,0x3dc93f75
.long 0xbf7b3f0e,0x3f553e48,0x3f7bbf0e,0xbf55be48,0xbf7f3ef1,0x3e953f22,0xbdc93f62,0x3f75bf46
.long 0xbf6d3ec4,0xbec43f6d,0xbf6d3ec4,0xbec43f6d,0xbf463e95,0xbf623f7f,0x3f22bf75,0xbef1bdc9
.long 0xbf0e3e48,0xbf7b3f55,0x3f0ebe48,0x3f7bbf55,0xbe953dc9,0xbf223ef1,0xbf753f7f,0xbf463f62
.long 0xa554248d,0xa5f725b0,0xa754a654,0xa765a60d,0x3e95bdc9,0x3f22bef1,0x3f75bf7f,0x3f46bf62
.long 0x3f0ebe48,0x3f7bbf55,0xbf0e3e48,0xbf7b3f55,0x3f46be95,0x3f62bf7f,0xbf223f75,0x3ef13dc9
.long 0x3f6dbec4,0x3ec4bf6d,0x3f6dbec4,0x3ec4bf6d,0x3f7fbef1,0xbe95bf22,0x3dc9bf62,0xbf753f46
.long 0x3f7bbf0e,0xbf55be48,0xbf7b3f0e,0x3f553e48,0x3f62bf22,0xbf7f3e95,0x3ef13f46,0xbdc9bf75
.long 0x3f35bf35,0xbf353f35,0x3f35bf35,0xbf353f35,0x3ef1bf46,0xbdc93f75,0xbf62bf22,0x3f7f3e95
.long 0x3e48bf55,0x3f0e3f7b,0xbe483f55,0xbf0ebf7b,0xbdc9bf62,0x3f753f46,0x3f7f3ef1,0xbe953f22
.long 0xbec4bf6d,0x3f6d3ec4,0xbec4bf6d,0x3f6d3ec4,0xbf22bf75,0x3ef1bdc9,0xbf46be95,0xbf62bf7f
.long 0xbf55bf7b,0xbe48bf0e,0x3f553f7b,0x3e483f0e,0xbf75bf7f,0xbf46bf62,0x3e953dc9,0x3f223ef1
.long 0x3f803f80,0x3f803f80,0x3f803f80,0x3f803f80,0x3ef13f22,0x3dc93e95,0xbf62bf46,0xbf7fbf75
.long 0xbf0ebe48,0xbf7bbf55,0x3f0e3e48,0x3f7b3f55,0xbf7fbf62,0xbe95bf46,0xbdc93ef1,0xbf75bf22
.long 0xbec4bf6d,0x3f6d3ec4,0xbec4bf6d,0x3f6d3ec4,0x3f22be95,0x3ef13f7f,0x3f463f75,0xbf62bdc9
.long 0x3f7b3f0e,0xbf553e48,0xbf7bbf0e,0x3f55be48,0x3e953f7f,0xbf22bf62,0x3f75bdc9,0xbf463ef1
.long 0xbf353f35,0x3f35bf35,0xbf353f35,0x3f35bf35,0xbf75bdc9,0x3f463ef1,0x3e95bf7f,0xbf223f62
.long 0xbe48bf55,0xbf0e3f7b,0x3e483f55,0x3f0ebf7b,0x3f46bf75,0xbf623dc9,0xbf22be95,0xbef13f7f
.long 0x3f6dbec4,0x3ec4bf6d,0x3f6dbec4,0x3ec4bf6d,0x3dc93ef1,0x3f75bf22,0xbf7f3f62,0xbe953f46
.long 0xbf553f7b,0xbe483f0e,0x3f55bf7b,0x3e48bf0e,0xbf623f46,0xbf7f3f75,0xbef13f22,0xbdc93e95
.long 0xa731261f,0xa742a68d,0xa777a58e,0xa784a137,0x3f62bf46,0x3f7fbf75,0x3ef1bf22,0x3dc9be95
.long 0x3f55bf7b,0x3e48bf0e,0xbf553f7b,0xbe483f0e,0xbdc9bef1,0xbf753f22,0x3f7fbf62,0x3e95bf46
.long 0xbf6d3ec4,0xbec43f6d,0xbf6d3ec4,0xbec43f6d,0xbf463f75,0x3f62bdc9,0x3f223e95,0x3ef1bf7f
.long 0x3e483f55,0x3f0ebf7b,0xbe48bf55,0xbf0e3f7b,0x3f753dc9,0xbf46bef1,0xbe953f7f,0x3f22bf62
.long 0x3f35bf35,0xbf353f35,0x3f35bf35,0xbf353f35,0xbe95bf7f,0x3f223f62,0xbf753dc9,0x3f46bef1
.long 0xbf7bbf0e,0x3f55be48,0x3f7b3f0e,0xbf553e48,0xbf223e95,0xbef1bf7f,0xbf46bf75,0x3f623dc9
.long 0x3ec43f6d,0xbf6dbec4,0x3ec43f6d,0xbf6dbec4,0x3f7f3f62,0x3e953f46,0x3dc9bef1,0x3f753f22
.long 0x3f0e3e48,0x3f7b3f55,0xbf0ebe48,0xbf7bbf55,0xbef1bf22,0xbdc9be95,0x3f623f46,0x3f7f3f75
.long 0x3f803f80,0x3f803f80,0x3f803f80,0x3f803f80,0xbf75bf7f,0xbf46bf62,0x3e953dc9,0x3f223ef1
.long 0x3f553f7b,0x3e483f0e,0xbf55bf7b,0xbe48bf0e,0xbf22bf75,0x3ef1bdc9,0xbf46be95,0xbf62bf7f
.long 0x3ec43f6d,0xbf6dbec4,0x3ec43f6d,0xbf6dbec4,0xbdc9bf62,0x3f753f46,0x3f7f3ef1,0xbe953f22
.long 0xbe483f55,0xbf0ebf7b,0x3e48bf55,0x3f0e3f7b,0x3ef1bf46,0xbdc93f75,0xbf62bf22,0x3f7f3e95
.long 0xbf353f35,0x3f35bf35,0xbf353f35,0x3f35bf35,0x3f62bf22,0xbf7f3e95,0x3ef13f46,0xbdc9bf75
.long 0xbf7b3f0e,0x3f553e48,0x3f7bbf0e,0xbf55be48,0x3f7fbef1,0xbe95bf22,0x3dc9bf62,0xbf753f46
.long 0xbf6d3ec4,0xbec43f6d,0xbf6d3ec4,0xbec43f6d,0x3f46be95,0x3f62bf7f,0xbf223f75,0x3ef13dc9
.long 0xbf0e3e48,0xbf7b3f55,0x3f0ebe48,0x3f7bbf55,0x3e95bdc9,0x3f22bef1,0x3f75bf7f,0x3f46bf62
.long 0xa78d258d,0xa796260d,0xa7b12816,0x270d26d4,0xbe953dc9,0xbf223ef1,0xbf753f7f,0xbf463f62
.long 0x3f0ebe48,0x3f7bbf55,0xbf0e3e48,0xbf7b3f55,0xbf463e95,0xbf623f7f,0x3f22bf75,0xbef1bdc9
.long 0x3f6dbec4,0x3ec4bf6d,0x3f6dbec4,0x3ec4bf6d,0xbf7f3ef1,0x3e953f22,0xbdc93f62,0x3f75bf46
.long 0x3f7bbf0e,0xbf55be48,0xbf7b3f0e,0x3f553e48,0xbf623f22,0x3f7fbe95,0xbef1bf46,0x3dc93f75
.long 0x3f35bf35,0xbf353f35,0x3f35bf35,0xbf353f35,0xbef13f46,0x3dc9bf75,0x3f623f22,0xbf7fbe95
.long 0x3e48bf55,0x3f0e3f7b,0xbe483f55,0xbf0ebf7b,0x3dc93f62,0xbf75bf46,0xbf7fbef1,0x3e95bf22
.long 0xbec4bf6d,0x3f6d3ec4,0xbec4bf6d,0x3f6d3ec4,0x3f223f75,0xbef13dc9,0x3f463e95,0x3f623f7f
.long 0xbf55bf7b,0xbe48bf0e,0x3f553f7b,0x3e483f0e,0x3f753f7f,0x3f463f62,0xbe95bdc9,0xbf22bef1
.long 0x3f803f80,0x3f803f80,0x3f803f80,0x3f803f80,0xbef1bf22,0xbdc9be95,0x3f623f46,0x3f7f3f75
.long 0xbf0ebe48,0xbf7bbf55,0x3f0e3e48,0x3f7b3f55,0x3f7f3f62,0x3e953f46,0x3dc9bef1,0x3f753f22
.long 0xbec4bf6d,0x3f6d3ec4,0xbec4bf6d,0x3f6d3ec4,0xbf223e95,0xbef1bf7f,0xbf46bf75,0x3f623dc9
.long 0x3f7b3f0e,0xbf553e48,0xbf7bbf0e,0x3f55be48,0xbe95bf7f,0x3f223f62,0xbf753dc9,0x3f46bef1
.long 0xbf353f35,0x3f35bf35,0xbf353f35,0x3f35bf35,0x3f753dc9,0xbf46bef1,0xbe953f7f,0x3f22bf62
.long 0xbe48bf55,0xbf0e3f7b,0x3e483f55,0x3f0ebf7b,0xbf463f75,0x3f62bdc9,0x3f223e95,0x3ef1bf7f
.long 0x3f6dbec4,0x3ec4bf6d,0x3f6dbec4,0x3ec4bf6d,0xbdc9bef1,0xbf753f22,0x3f7fbf62,0x3e95bf46
.long 0xbf553f7b,0xbe483f0e,0x3f55bf7b,0x3e48bf0e,0x3f62bf46,0x3f7fbf75,0x3ef1bf22,0x3dc9be95
.long 0xa79f280d,0x2731268d,0xa7c2281f,0x26d4270d,0xbf623f46,0xbf7f3f75,0xbef13f22,0xbdc93e95
.long 0x3f55bf7b,0x3e48bf0e,0xbf553f7b,0xbe483f0e,0x3dc93ef1,0x3f75bf22,0xbf7f3f62,0xbe953f46
.long 0xbf6d3ec4,0xbec43f6d,0xbf6d3ec4,0xbec43f6d,0x3f46bf75,0xbf623dc9,0xbf22be95,0xbef13f7f
.long 0x3e483f55,0x3f0ebf7b,0xbe48bf55,0xbf0e3f7b,0xbf75bdc9,0x3f463ef1,0x3e95bf7f,0xbf223f62
.long 0x3f35bf35,0xbf353f35,0x3f35bf35,0xbf353f35,0x3e953f7f,0xbf22bf62,0x3f75bdc9,0xbf463ef1
.long 0xbf7bbf0e,0x3f55be48,0x3f7b3f0e,0xbf553e48,0x3f22be95,0x3ef13f7f,0x3f463f75,0xbf62bdc9
.long 0x3ec43f6d,0xbf6dbec4,0x3ec43f6d,0xbf6dbec4,0xbf7fbf62,0xbe95bf46,0xbdc93ef1,0xbf75bf22
.long 0x3f0e3e48,0x3f7b3f55,0xbf0ebe48,0xbf7bbf55,0x3ef13f22,0x3dc93e95,0xbf62bf46,0xbf7fbf75
.long 0x0,0x0,0x0,0x0,0x3e953dc9,0x3f223ef1,0x3f753f7f,0x3f463f62
.long 0x3f0e3e48,0x3f7b3f55,0xbf0ebe48,0xbf7bbf55,0x3f463e95,0x3f623f7f,0xbf22bf75,0x3ef1bdc9
.long 0x3f6d3ec4,0x3ec43f6d,0x3f6d3ec4,0x3ec43f6d,0x3f7f3ef1,0xbe953f22,0x3dc93f62,0xbf75bf46
.long 0x3f7b3f0e,0xbf553e48,0xbf7bbf0e,0x3f55be48,0x3f623f22,0xbf7fbe95,0x3ef1bf46,0xbdc93f75
.long 0x3f353f35,0xbf35bf35,0x3f353f35,0xbf35bf35,0x3ef13f46,0xbdc9bf75,0xbf623f22,0x3f7fbe95
.long 0x3e483f55,0x3f0ebf7b,0xbe48bf55,0xbf0e3f7b,0xbdc93f62,0x3f75bf46,0x3f7fbef1,0xbe95bf22
.long 0xbec43f6d,0x3f6dbec4,0xbec43f6d,0x3f6dbec4,0xbf223f75,0x3ef13dc9,0xbf463e95,0xbf623f7f
.long 0xbf553f7b,0xbe483f0e,0x3f55bf7b,0x3e48bf0e,0xbf753f7f,0xbf463f62,0x3e95bdc9,0x3f22bef1
.long 0xbf803f80,0xbf803f80,0xbf803f80,0xbf803f80,0xbf753f7f,0xbf463f62,0x3e95bdc9,0x3f22bef1
.long 0xbf553f7b,0xbe483f0e,0x3f55bf7b,0x3e48bf0e,0xbf223f75,0x3ef13dc9,0xbf463e95,0xbf623f7f
.long 0xbec43f6d,0x3f6dbec4,0xbec43f6d,0x3f6dbec4,0xbdc93f62,0x3f75bf46,0x3f7fbef1,0xbe95bf22
.long 0x3e483f55,0x3f0ebf7b,0xbe48bf55,0xbf0e3f7b,0x3ef13f46,0xbdc9bf75,0xbf623f22,0x3f7fbe95
.long 0x3f353f35,0xbf35bf35,0x3f353f35,0xbf35bf35,0x3f623f22,0xbf7fbe95,0x3ef1bf46,0xbdc93f75
.long 0x3f7b3f0e,0xbf553e48,0xbf7bbf0e,0x3f55be48,0x3f7f3ef1,0xbe953f22,0x3dc93f62,0xbf75bf46
.long 0x3f6d3ec4,0x3ec43f6d,0x3f6d3ec4,0x3ec43f6d,0x3f463e95,0x3f623f7f,0xbf22bf75,0x3ef1bdc9
.long 0x3f0e3e48,0x3f7b3f55,0xbf0ebe48,0xbf7bbf55,0x3e953dc9,0x3f223ef1,0x3f753f7f,0x3f463f62
.long 0x0,0x0,0x0,0x0,0x3f623f46,0x3f7f3f75,0x3ef13f22,0x3dc93e95
.long 0x3f553f7b,0x3e483f0e,0xbf55bf7b,0xbe48bf0e,0xbdc93ef1,0xbf75bf22,0x3f7f3f62,0x3e953f46
.long 0xbf6dbec4,0xbec4bf6d,0xbf6dbec4,0xbec4bf6d,0xbf46bf75,0x3f623dc9,0x3f22be95,0x3ef13f7f
.long 0x3e48bf55,0x3f0e3f7b,0xbe483f55,0xbf0ebf7b,0x3f75bdc9,0xbf463ef1,0xbe95bf7f,0x3f223f62
.long 0x3f353f35,0xbf35bf35,0x3f353f35,0xbf35bf35,0xbe953f7f,0x3f22bf62,0xbf75bdc9,0x3f463ef1
.long 0xbf7b3f0e,0x3f553e48,0x3f7bbf0e,0xbf55be48,0xbf22be95,0xbef13f7f,0xbf463f75,0x3f62bdc9
.long 0x3ec4bf6d,0xbf6d3ec4,0x3ec4bf6d,0xbf6d3ec4,0x3f7fbf62,0x3e95bf46,0x3dc93ef1,0x3f75bf22
.long 0x3f0ebe48,0x3f7bbf55,0xbf0e3e48,0xbf7b3f55,0xbef13f22,0xbdc93e95,0x3f62bf46,0x3f7fbf75
.long 0xbf803f80,0xbf803f80,0xbf803f80,0xbf803f80,0xbef13f22,0xbdc93e95,0x3f62bf46,0x3f7fbf75
.long 0x3f0ebe48,0x3f7bbf55,0xbf0e3e48,0xbf7b3f55,0x3f7fbf62,0x3e95bf46,0x3dc93ef1,0x3f75bf22
.long 0x3ec4bf6d,0xbf6d3ec4,0x3ec4bf6d,0xbf6d3ec4,0xbf22be95,0xbef13f7f,0xbf463f75,0x3f62bdc9
.long 0xbf7b3f0e,0x3f553e48,0x3f7bbf0e,0xbf55be48,0xbe953f7f,0x3f22bf62,0xbf75bdc9,0x3f463ef1
.long 0x3f353f35,0xbf35bf35,0x3f353f35,0xbf35bf35,0x3f75bdc9,0xbf463ef1,0xbe95bf7f,0x3f223f62
.long 0x3e48bf55,0x3f0e3f7b,0xbe483f55,0xbf0ebf7b,0xbf46bf75,0x3f623dc9,0x3f22be95,0x3ef13f7f
.long 0xbf6dbec4,0xbec4bf6d,0xbf6dbec4,0xbec4bf6d,0xbdc93ef1,0xbf75bf22,0x3f7f3f62,0x3e953f46
.long 0x3f553f7b,0x3e483f0e,0xbf55bf7b,0xbe48bf0e,0x3f623f46,0x3f7f3f75,0x3ef13f22,0x3dc93e95
.long 0x0,0x0,0x0,0x0,0xbe95bdc9,0xbf22bef1,0xbf75bf7f,0xbf46bf62
.long 0x3f0e3e48,0x3f7b3f55,0xbf0ebe48,0xbf7bbf55,0xbf46be95,0xbf62bf7f,0x3f223f75,0xbef13dc9
.long 0x3f6d3ec4,0x3ec43f6d,0x3f6d3ec4,0x3ec43f6d,0xbf7fbef1,0x3e95bf22,0xbdc9bf62,0x3f753f46
.long 0x3f7b3f0e,0xbf553e48,0xbf7bbf0e,0x3f55be48,0xbf62bf22,0x3f7f3e95,0xbef13f46,0x3dc9bf75
.long 0x3f353f35,0xbf35bf35,0x3f353f35,0xbf35bf35,0xbef1bf46,0x3dc93f75,0x3f62bf22,0xbf7f3e95
.long 0x3e483f55,0x3f0ebf7b,0xbe48bf55,0xbf0e3f7b,0x3dc9bf62,0xbf753f46,0xbf7f3ef1,0x3e953f22
.long 0xbec43f6d,0x3f6dbec4,0xbec43f6d,0x3f6dbec4,0x3f22bf75,0xbef1bdc9,0x3f46be95,0x3f62bf7f
.long 0xbf553f7b,0xbe483f0e,0x3f55bf7b,0x3e48bf0e,0x3f75bf7f,0x3f46bf62,0xbe953dc9,0xbf223ef1
.long 0xbf803f80,0xbf803f80,0xbf803f80,0xbf803f80,0x3f75bf7f,0x3f46bf62,0xbe953dc9,0xbf223ef1
.long 0xbf553f7b,0xbe483f0e,0x3f55bf7b,0x3e48bf0e,0x3f22bf75,0xbef1bdc9,0x3f46be95,0x3f62bf7f
.long 0xbec43f6d,0x3f6dbec4,0xbec43f6d,0x3f6dbec4,0x3dc9bf62,0xbf753f46,0xbf7f3ef1,0x3e953f22
.long 0x3e483f55,0x3f0ebf7b,0xbe48bf55,0xbf0e3f7b,0xbef1bf46,0x3dc93f75,0x3f62bf22,0xbf7f3e95
.long 0x3f353f35,0xbf35bf35,0x3f353f35,0xbf35bf35,0xbf62bf22,0x3f7f3e95,0xbef13f46,0x3dc9bf75
.long 0x3f7b3f0e,0xbf553e48,0xbf7bbf0e,0x3f55be48,0xbf7fbef1,0x3e95bf22,0xbdc9bf62,0x3f753f46
.long 0x3f6d3ec4,0x3ec43f6d,0x3f6d3ec4,0x3ec43f6d,0xbf46be95,0xbf62bf7f,0x3f223f75,0xbef13dc9
.long 0x3f0e3e48,0x3f7b3f55,0xbf0ebe48,0xbf7bbf55,0xbe95bdc9,0xbf22bef1,0xbf75bf7f,0xbf46bf62
.long 0x0,0x0,0x0,0x0,0xbf62bf46,0xbf7fbf75,0xbef1bf22,0xbdc9be95
.long 0x3f553f7b,0x3e483f0e,0xbf55bf7b,0xbe48bf0e,0x3dc9bef1,0x3f753f22,0xbf7fbf62,0xbe95bf46
.long 0xbf6dbec4,0xbec4bf6d,0xbf6dbec4,0xbec4bf6d,0x3f463f75,0xbf62bdc9,0xbf223e95,0xbef1bf7f
.long 0x3e48bf55,0x3f0e3f7b,0xbe483f55,0xbf0ebf7b,0xbf753dc9,0x3f46bef1,0x3e953f7f,0xbf22bf62
.long 0x3f353f35,0xbf35bf35,0x3f353f35,0xbf35bf35,0x3e95bf7f,0xbf223f62,0x3f753dc9,0xbf46bef1
.long 0xbf7b3f0e,0x3f553e48,0x3f7bbf0e,0xbf55be48,0x3f223e95,0x3ef1bf7f,0x3f46bf75,0xbf623dc9
.long 0x3ec4bf6d,0xbf6d3ec4,0x3ec4bf6d,0xbf6d3ec4,0xbf7f3f62,0xbe953f46,0xbdc9bef1,0xbf753f22
.long 0x3f0ebe48,0x3f7bbf55,0xbf0e3e48,0xbf7b3f55,0x3ef1bf22,0x3dc9be95,0xbf623f46,0xbf7f3f75
.long 0xbf803f80,0xbf803f80,0xbf803f80,0xbf803f80,0x3ef1bf22,0x3dc9be95,0xbf623f46,0xbf7f3f75
.long 0x3f0ebe48,0x3f7bbf55,0xbf0e3e48,0xbf7b3f55,0xbf7f3f62,0xbe953f46,0xbdc9bef1,0xbf753f22
.long 0x3ec4bf6d,0xbf6d3ec4,0x3ec4bf6d,0xbf6d3ec4,0x3f223e95,0x3ef1bf7f,0x3f46bf75,0xbf623dc9
.long 0xbf7b3f0e,0x3f553e48,0x3f7bbf0e,0xbf55be48,0x3e95bf7f,0xbf223f62,0x3f753dc9,0xbf46bef1
.long 0x3f353f35,0xbf35bf35,0x3f353f35,0xbf35bf35,0xbf753dc9,0x3f46bef1,0x3e953f7f,0xbf22bf62
.long 0x3e48bf55,0x3f0e3f7b,0xbe483f55,0xbf0ebf7b,0x3f463f75,0xbf62bdc9,0xbf223e95,0xbef1bf7f
.long 0xbf6dbec4,0xbec4bf6d,0xbf6dbec4,0xbec4bf6d,0x3dc9bef1,0x3f753f22,0xbf7fbf62,0xbe95bf46
.long 0x3f553f7b,0x3e483f0e,0xbf55bf7b,0xbe48bf0e,0xbf62bf46,0xbf7fbf75,0xbef1bf22,0xbdc9be95
.long 0x3f7f3f80,0x3f753f7b,0x3f223f35,0x3ef13f0e,0x3f753f80,0x3f223f55,0xbf62bf35,0xbf7fbf7b
.long 0x3f623f80,0x3dc93f0e,0xbe95bf35,0x3f223e48,0x3f463f80,0xbef13e48,0x3f7f3f35,0x3e953f55
.long 0x3f223f80,0xbf62be48,0xbdc93f35,0xbf75bf55,0x3ef13f80,0xbf7fbf0e,0xbf75bf35,0x3f46be48
.long 0x3e953f80,0xbf46bf55,0x3ef1bf35,0x3dc93f7b,0x3dc93f80,0xbe95bf7b,0x3f463f35,0xbf62bf0e
.long 0xbdc93f80,0x3e95bf7b,0xbf463f35,0x3f62bf0e,0xbe953f80,0x3f46bf55,0xbef1bf35,0xbdc93f7b
.long 0xbef13f80,0x3f7fbf0e,0x3f75bf35,0xbf46be48,0xbf223f80,0x3f62be48,0x3dc93f35,0x3f75bf55
.long 0xbf463f80,0x3ef13e48,0xbf7f3f35,0xbe953f55,0xbf623f80,0xbdc93f0e,0x3e95bf35,0xbf223e48
.long 0xbf753f80,0xbf223f55,0x3f62bf35,0x3f7fbf7b,0xbf7f3f80,0xbf753f7b,0xbf223f35,0xbef13f0e
.long 0xbf7f3f80,0xbf753f7b,0xbf223f35,0xbef13f0e,0xbf753f80,0xbf223f55,0x3f62bf35,0x3f7fbf7b
.long 0xbf623f80,0xbdc93f0e,0x3e95bf35,0xbf223e48,0xbf463f80,0x3ef13e48,0xbf7f3f35,0xbe953f55
.long 0xbf223f80,0x3f62be48,0x3dc93f35,0x3f75bf55,0xbef13f80,0x3f7fbf0e,0x3f75bf35,0xbf46be48
.long 0xbe953f80,0x3f46bf55,0xbef1bf35,0xbdc93f7b,0xbdc93f80,0x3e95bf7b,0xbf463f35,0x3f62bf0e
.long 0x3dc93f80,0xbe95bf7b,0x3f463f35,0xbf62bf0e,0x3e953f80,0xbf46bf55,0x3ef1bf35,0x3dc93f7b
.long 0x3ef13f80,0xbf7fbf0e,0xbf75bf35,0x3f46be48,0x3f223f80,0xbf62be48,0xbdc93f35,0xbf75bf55
.long 0x3f463f80,0xbef13e48,0x3f7f3f35,0x3e953f55,0x3f623f80,0x3dc93f0e,0xbe95bf35,0x3f223e48
.long 0x3f753f80,0x3f223f55,0xbf62bf35,0xbf7fbf7b,0x3f7f3f80,0x3f753f7b,0x3f223f35,0x3ef13f0e
.long 0x3f623f6d,0x3f463f55,0x3e953ec4,0x3dc93e48,0x3dc93ec4,0xbef1be48,0xbf46bf6d,0xbe95bf0e
.long 0xbf46bec4,0xbf75bf7b,0x3f7f3f6d,0x3ef13f55,0xbf75bf6d,0x3dc9bf0e,0xbf62bec4,0xbf22bf7b
.long 0xbe95bf6d,0x3f7f3f0e,0x3ef1bec4,0x3f463f7b,0x3f22bec4,0x3e953f7b,0x3dc93f6d,0xbf62bf55
.long 0x3f7f3ec4,0xbf623e48,0xbf22bf6d,0x3f753f0e,0x3ef13f6d,0xbf22bf55,0x3f753ec4,0xbf7fbe48
.long 0xbef13f6d,0x3f22bf55,0xbf753ec4,0x3f7fbe48,0xbf7f3ec4,0x3f623e48,0x3f22bf6d,0xbf753f0e
.long 0xbf22bec4,0xbe953f7b,0xbdc93f6d,0x3f62bf55,0x3e95bf6d,0xbf7f3f0e,0xbef1bec4,0xbf463f7b
.long 0x3f75bf6d,0xbdc9bf0e,0x3f62bec4,0x3f22bf7b,0x3f46bec4,0x3f75bf7b,0xbf7f3f6d,0xbef13f55
.long 0xbdc93ec4,0x3ef1be48,0x3f46bf6d,0x3e95bf0e,0xbf623f6d,0xbf463f55,0xbe953ec4,0xbdc93e48
.long 0xbf623f6d,0xbf463f55,0xbe953ec4,0xbdc93e48,0xbdc93ec4,0x3ef1be48,0x3f46bf6d,0x3e95bf0e
.long 0x3f46bec4,0x3f75bf7b,0xbf7f3f6d,0xbef13f55,0x3f75bf6d,0xbdc9bf0e,0x3f62bec4,0x3f22bf7b
.long 0x3e95bf6d,0xbf7f3f0e,0xbef1bec4,0xbf463f7b,0xbf22bec4,0xbe953f7b,0xbdc93f6d,0x3f62bf55
.long 0xbf7f3ec4,0x3f623e48,0x3f22bf6d,0xbf753f0e,0xbef13f6d,0x3f22bf55,0xbf753ec4,0x3f7fbe48
.long 0x3ef13f6d,0xbf22bf55,0x3f753ec4,0xbf7fbe48,0x3f7f3ec4,0xbf623e48,0xbf22bf6d,0x3f753f0e
.long 0x3f22bec4,0x3e953f7b,0x3dc93f6d,0xbf62bf55,0xbe95bf6d,0x3f7f3f0e,0x3ef1bec4,0x3f463f7b
.long 0xbf75bf6d,0x3dc9bf0e,0xbf62bec4,0xbf22bf7b,0xbf46bec4,0xbf75bf7b,0x3f7f3f6d,0x3ef13f55
.long 0x3dc93ec4,0xbef1be48,0xbf46bf6d,0xbe95bf0e,0x3f623f6d,0x3f463f55,0x3e953ec4,0x3dc93e48
.long 0xbdc9248d,0xbe95be48,0xbf46bf35,0xbf62bf55,0x3e95a554,0x3f463f0e,0x3ef13f35,0xbdc93e48
.long 0xbef125b0,0xbf7fbf55,0x3f753f35,0x3f463f7b,0x3f22a5f7,0x3f623f7b,0xbdc9bf35,0x3f753f0e
.long 0xbf46261f,0xbef1bf7b,0xbf7fbf35,0x3e95bf0e,0x3f62a731,0xbdc93f55,0xbe953f35,0xbf22bf7b
.long 0xbf75a68d,0x3f22bf0e,0x3f623f35,0xbf7fbe48,0x3f7fa742,0xbf753e48,0x3f22bf35,0xbef13f55
.long 0xbf7fa654,0x3f753e48,0xbf22bf35,0x3ef13f55,0x3f75a754,0xbf22bf0e,0xbf623f35,0x3f7fbe48
.long 0xbf62a60d,0x3dc93f55,0x3e953f35,0x3f22bf7b,0x3f46a765,0x3ef1bf7b,0x3f7fbf35,0xbe95bf0e
.long 0xbf22a58e,0xbf623f7b,0x3dc9bf35,0xbf753f0e,0x3ef1a777,0x3f7fbf55,0xbf753f35,0xbf463f7b
.long 0xbe95a137,0xbf463f0e,0xbef13f35,0x3dc93e48,0x3dc9a784,0x3e95be48,0x3f46bf35,0x3f62bf55
.long 0x3dc9258d,0x3e95be48,0x3f46bf35,0x3f62bf55,0xbe95a78d,0xbf463f0e,0xbef13f35,0x3dc93e48
.long 0x3ef1260d,0x3f7fbf55,0xbf753f35,0xbf463f7b,0xbf22a796,0xbf623f7b,0x3dc9bf35,0xbf753f0e
.long 0x3f46280d,0x3ef1bf7b,0x3f7fbf35,0xbe95bf0e,0xbf62a79f,0x3dc93f55,0x3e953f35,0x3f22bf7b
.long 0x3f75268d,0xbf22bf0e,0xbf623f35,0x3f7fbe48,0xbf7f2731,0x3f753e48,0xbf22bf35,0x3ef13f55
.long 0x3f7f2816,0xbf753e48,0x3f22bf35,0xbef13f55,0xbf75a7b1,0x3f22bf0e,0x3f623f35,0xbf7fbe48
.long 0x3f6226d4,0xbdc93f55,0xbe953f35,0xbf22bf7b,0xbf46270d,0xbef1bf7b,0xbf7fbf35,0x3e95bf0e
.long 0x3f22281f,0x3f623f7b,0xbdc9bf35,0x3f753f0e,0xbef1a7c2,0xbf7fbf55,0x3f753f35,0x3f463f7b
.long 0x3e95270d,0x3f463f0e,0x3ef13f35,0xbdc93e48,0xbdc926d4,0xbe95be48,0xbf46bf35,0xbf62bf55
.long 0xbef1bec4,0xbf22bf0e,0xbf75bf6d,0xbf7fbf7b,0x3f7f3f6d,0x3f623f7b,0xbf22bec4,0xbf75bf55
.long 0xbf22bf6d,0x3e95be48,0xbdc93ec4,0xbf62bf0e,0xbe953ec4,0xbf7fbf55,0x3ef13f6d,0xbf46be48
.long 0x3f753ec4,0x3dc93f55,0x3f623f6d,0xbf223e48,0xbf46bf6d,0x3f753e48,0x3f7f3ec4,0xbef13f0e
.long 0xbdc93f6d,0xbef1bf7b,0x3f46bec4,0xbe953f55,0x3f62bec4,0xbf463f0e,0x3e95bf6d,0xbdc93f7b
.long 0xbf62bec4,0x3f463f0e,0xbe95bf6d,0x3dc93f7b,0x3dc93f6d,0x3ef1bf7b,0xbf46bec4,0x3e953f55
.long 0x3f46bf6d,0xbf753e48,0xbf7f3ec4,0x3ef13f0e,0xbf753ec4,0xbdc93f55,0xbf623f6d,0x3f223e48
.long 0x3e953ec4,0x3f7fbf55,0xbef13f6d,0x3f46be48,0x3f22bf6d,0xbe95be48,0x3dc93ec4,0x3f62bf0e
.long 0xbf7f3f6d,0xbf623f7b,0x3f22bec4,0x3f75bf55,0x3ef1bec4,0x3f22bf0e,0x3f75bf6d,0x3f7fbf7b
.long 0x3ef1bec4,0x3f22bf0e,0x3f75bf6d,0x3f7fbf7b,0xbf7f3f6d,0xbf623f7b,0x3f22bec4,0x3f75bf55
.long 0x3f22bf6d,0xbe95be48,0x3dc93ec4,0x3f62bf0e,0x3e953ec4,0x3f7fbf55,0xbef13f6d,0x3f46be48
.long 0xbf753ec4,0xbdc93f55,0xbf623f6d,0x3f223e48,0x3f46bf6d,0xbf753e48,0xbf7f3ec4,0x3ef13f0e
.long 0x3dc93f6d,0x3ef1bf7b,0xbf46bec4,0x3e953f55,0xbf62bec4,0x3f463f0e,0xbe95bf6d,0x3dc93f7b
.long 0x3f62bec4,0xbf463f0e,0x3e95bf6d,0xbdc93f7b,0xbdc93f6d,0xbef1bf7b,0x3f46bec4,0xbe953f55
.long 0xbf46bf6d,0x3f753e48,0x3f7f3ec4,0xbef13f0e,0x3f753ec4,0x3dc93f55,0x3f623f6d,0xbf223e48
.long 0xbe953ec4,0xbf7fbf55,0x3ef13f6d,0xbf46be48,0xbf22bf6d,0x3e95be48,0xbdc93ec4,0xbf62bf0e
.long 0x3f7f3f6d,0x3f623f7b,0xbf22bec4,0xbf75bf55,0xbef1bec4,0xbf22bf0e,0xbf75bf6d,0xbf7fbf7b
.long 0x3dc90000,0x3e953e48,0x3f463f35,0x3f623f55,0x3e950000,0x3f463f0e,0x3ef13f35,0xbdc93e48
.long 0x3ef10000,0x3f7f3f55,0xbf75bf35,0xbf46bf7b,0x3f220000,0x3f623f7b,0xbdc9bf35,0x3f753f0e
.long 0x3f460000,0x3ef13f7b,0x3f7f3f35,0xbe953f0e,0x3f620000,0xbdc93f55,0xbe953f35,0xbf22bf7b
.long 0x3f750000,0xbf223f0e,0xbf62bf35,0x3f7f3e48,0x3f7f0000,0xbf753e48,0x3f22bf35,0xbef13f55
.long 0x3f7f0000,0xbf75be48,0x3f223f35,0xbef1bf55,0x3f750000,0xbf22bf0e,0xbf623f35,0x3f7fbe48
.long 0x3f620000,0xbdc9bf55,0xbe95bf35,0xbf223f7b,0x3f460000,0x3ef1bf7b,0x3f7fbf35,0xbe95bf0e
.long 0x3f220000,0x3f62bf7b,0xbdc93f35,0x3f75bf0e,0x3ef10000,0x3f7fbf55,0xbf753f35,0xbf463f7b
.long 0x3e950000,0x3f46bf0e,0x3ef1bf35,0xbdc9be48,0x3dc90000,0x3e95be48,0x3f46bf35,0x3f62bf55
.long 0xbdc90000,0xbe953e48,0xbf463f35,0xbf623f55,0xbe950000,0xbf463f0e,0xbef13f35,0x3dc93e48
.long 0xbef10000,0xbf7f3f55,0x3f75bf35,0x3f46bf7b,0xbf220000,0xbf623f7b,0x3dc9bf35,0xbf753f0e
.long 0xbf460000,0xbef13f7b,0xbf7f3f35,0x3e953f0e,0xbf620000,0x3dc93f55,0x3e953f35,0x3f22bf7b
.long 0xbf750000,0x3f223f0e,0x3f62bf35,0xbf7f3e48,0xbf7f0000,0x3f753e48,0xbf22bf35,0x3ef13f55
.long 0xbf7f0000,0x3f75be48,0xbf223f35,0x3ef1bf55,0xbf750000,0x3f22bf0e,0x3f623f35,0xbf7fbe48
.long 0xbf620000,0x3dc9bf55,0x3e95bf35,0x3f223f7b,0xbf460000,0xbef1bf7b,0xbf7fbf35,0x3e95bf0e
.long 0xbf220000,0xbf62bf7b,0x3dc93f35,0xbf75bf0e,0xbef10000,0xbf7fbf55,0x3f753f35,0x3f463f7b
.long 0xbe950000,0xbf46bf0e,0xbef1bf35,0x3dc9be48,0xbdc90000,0xbe95be48,0xbf46bf35,0xbf62bf55
.long 0x3ef13ec4,0x3f223f0e,0x3f753f6d,0x3f7f3f7b,0x3f7f3f6d,0x3f623f7b,0xbf22bec4,0xbf75bf55
.long 0x3f223f6d,0xbe953e48,0x3dc9bec4,0x3f623f0e,0xbe953ec4,0xbf7fbf55,0x3ef13f6d,0xbf46be48
.long 0xbf75bec4,0xbdc9bf55,0xbf62bf6d,0x3f22be48,0xbf46bf6d,0x3f753e48,0x3f7f3ec4,0xbef13f0e
.long 0x3dc9bf6d,0x3ef13f7b,0xbf463ec4,0x3e95bf55,0x3f62bec4,0xbf463f0e,0x3e95bf6d,0xbdc93f7b
.long 0x3f623ec4,0xbf46bf0e,0x3e953f6d,0xbdc9bf7b,0x3dc93f6d,0x3ef1bf7b,0xbf46bec4,0x3e953f55
.long 0xbf463f6d,0x3f75be48,0x3f7fbec4,0xbef1bf0e,0xbf753ec4,0xbdc93f55,0xbf623f6d,0x3f223e48
.long 0xbe95bec4,0xbf7f3f55,0x3ef1bf6d,0xbf463e48,0x3f22bf6d,0xbe95be48,0x3dc93ec4,0x3f62bf0e
.long 0x3f7fbf6d,0x3f62bf7b,0xbf223ec4,0xbf753f55,0x3ef1bec4,0x3f22bf0e,0x3f75bf6d,0x3f7fbf7b
.long 0xbef13ec4,0xbf223f0e,0xbf753f6d,0xbf7f3f7b,0xbf7f3f6d,0xbf623f7b,0x3f22bec4,0x3f75bf55
.long 0xbf223f6d,0x3e953e48,0xbdc9bec4,0xbf623f0e,0x3e953ec4,0x3f7fbf55,0xbef13f6d,0x3f46be48
.long 0x3f75bec4,0x3dc9bf55,0x3f62bf6d,0xbf22be48,0x3f46bf6d,0xbf753e48,0xbf7f3ec4,0x3ef13f0e
.long 0xbdc9bf6d,0xbef13f7b,0x3f463ec4,0xbe95bf55,0xbf62bec4,0x3f463f0e,0xbe95bf6d,0x3dc93f7b
.long 0xbf623ec4,0x3f46bf0e,0xbe953f6d,0x3dc9bf7b,0xbdc93f6d,0xbef1bf7b,0x3f46bec4,0xbe953f55
.long 0x3f463f6d,0xbf75be48,0xbf7fbec4,0x3ef1bf0e,0x3f753ec4,0x3dc93f55,0x3f623f6d,0xbf223e48
.long 0x3e95bec4,0x3f7f3f55,0xbef1bf6d,0x3f463e48,0xbf22bf6d,0x3e95be48,0xbdc93ec4,0xbf62bf0e
.long 0xbf7fbf6d,0xbf62bf7b,0x3f223ec4,0x3f753f55,0xbef1bec4,0xbf22bf0e,0xbf75bf6d,0xbf7fbf7b
.long 0x3f7f3f80,0x3f753f7b,0x3f223f35,0x3ef13f0e,0xbf75bf80,0xbf22bf55,0x3f623f35,0x3f7f3f7b
.long 0x3f623f80,0x3dc93f0e,0xbe95bf35,0x3f223e48,0xbf46bf80,0x3ef1be48,0xbf7fbf35,0xbe95bf55
.long 0x3f223f80,0xbf62be48,0xbdc93f35,0xbf75bf55,0xbef1bf80,0x3f7f3f0e,0x3f753f35,0xbf463e48
.long 0x3e953f80,0xbf46bf55,0x3ef1bf35,0x3dc93f7b,0xbdc9bf80,0x3e953f7b,0xbf46bf35,0x3f623f0e
.long 0xbdc93f80,0x3e95bf7b,0xbf463f35,0x3f62bf0e,0x3e95bf80,0xbf463f55,0x3ef13f35,0x3dc9bf7b
.long 0xbef13f80,0x3f7fbf0e,0x3f75bf35,0xbf46be48,0x3f22bf80,0xbf623e48,0xbdc9bf35,0xbf753f55
.long 0xbf463f80,0x3ef13e48,0xbf7f3f35,0xbe953f55,0x3f62bf80,0x3dc9bf0e,0xbe953f35,0x3f22be48
.long 0xbf753f80,0xbf223f55,0x3f62bf35,0x3f7fbf7b,0x3f7fbf80,0x3f75bf7b,0x3f22bf35,0x3ef1bf0e
.long 0xbf7f3f80,0xbf753f7b,0xbf223f35,0xbef13f0e,0x3f75bf80,0x3f22bf55,0xbf623f35,0xbf7f3f7b
.long 0xbf623f80,0xbdc93f0e,0x3e95bf35,0xbf223e48,0x3f46bf80,0xbef1be48,0x3f7fbf35,0x3e95bf55
.long 0xbf223f80,0x3f62be48,0x3dc93f35,0x3f75bf55,0x3ef1bf80,0xbf7f3f0e,0xbf753f35,0x3f463e48
.long 0xbe953f80,0x3f46bf55,0xbef1bf35,0xbdc93f7b,0x3dc9bf80,0xbe953f7b,0x3f46bf35,0xbf623f0e
.long 0x3dc93f80,0xbe95bf7b,0x3f463f35,0xbf62bf0e,0xbe95bf80,0x3f463f55,0xbef13f35,0xbdc9bf7b
.long 0x3ef13f80,0xbf7fbf0e,0xbf75bf35,0x3f46be48,0xbf22bf80,0x3f623e48,0x3dc9bf35,0x3f753f55
.long 0x3f463f80,0xbef13e48,0x3f7f3f35,0x3e953f55,0xbf62bf80,0xbdc9bf0e,0x3e953f35,0xbf22be48
.long 0x3f753f80,0x3f223f55,0xbf62bf35,0xbf7fbf7b,0xbf7fbf80,0xbf75bf7b,0xbf22bf35,0xbef1bf0e
.long 0x3f623f6d,0x3f463f55,0x3e953ec4,0x3dc93e48,0xbdc9bec4,0x3ef13e48,0x3f463f6d,0x3e953f0e
.long 0xbf46bec4,0xbf75bf7b,0x3f7f3f6d,0x3ef13f55,0x3f753f6d,0xbdc93f0e,0x3f623ec4,0x3f223f7b
.long 0xbe95bf6d,0x3f7f3f0e,0x3ef1bec4,0x3f463f7b,0xbf223ec4,0xbe95bf7b,0xbdc9bf6d,0x3f623f55
.long 0x3f7f3ec4,0xbf623e48,0xbf22bf6d,0x3f753f0e,0xbef1bf6d,0x3f223f55,0xbf75bec4,0x3f7f3e48
.long 0xbef13f6d,0x3f22bf55,0xbf753ec4,0x3f7fbe48,0x3f7fbec4,0xbf62be48,0xbf223f6d,0x3f75bf0e
.long 0xbf22bec4,0xbe953f7b,0xbdc93f6d,0x3f62bf55,0xbe953f6d,0x3f7fbf0e,0x3ef13ec4,0x3f46bf7b
.long 0x3f75bf6d,0xbdc9bf0e,0x3f62bec4,0x3f22bf7b,0xbf463ec4,0xbf753f7b,0x3f7fbf6d,0x3ef1bf55
.long 0xbdc93ec4,0x3ef1be48,0x3f46bf6d,0x3e95bf0e,0x3f62bf6d,0x3f46bf55,0x3e95bec4,0x3dc9be48
.long 0xbf623f6d,0xbf463f55,0xbe953ec4,0xbdc93e48,0x3dc9bec4,0xbef13e48,0xbf463f6d,0xbe953f0e
.long 0x3f46bec4,0x3f75bf7b,0xbf7f3f6d,0xbef13f55,0xbf753f6d,0x3dc93f0e,0xbf623ec4,0xbf223f7b
.long 0x3e95bf6d,0xbf7f3f0e,0xbef1bec4,0xbf463f7b,0x3f223ec4,0x3e95bf7b,0x3dc9bf6d,0xbf623f55
.long 0xbf7f3ec4,0x3f623e48,0x3f22bf6d,0xbf753f0e,0x3ef1bf6d,0xbf223f55,0x3f75bec4,0xbf7f3e48
.long 0x3ef13f6d,0xbf22bf55,0x3f753ec4,0xbf7fbe48,0xbf7fbec4,0x3f62be48,0x3f223f6d,0xbf75bf0e
.long 0x3f22bec4,0x3e953f7b,0x3dc93f6d,0xbf62bf55,0x3e953f6d,0xbf7fbf0e,0xbef13ec4,0xbf46bf7b
.long 0xbf75bf6d,0x3dc9bf0e,0xbf62bec4,0xbf22bf7b,0x3f463ec4,0x3f753f7b,0xbf7fbf6d,0xbef1bf55
.long 0x3dc93ec4,0xbef1be48,0xbf46bf6d,0xbe95bf0e,0xbf62bf6d,0xbf46bf55,0xbe95bec4,0xbdc9be48
.long 0x3c00,0x3c00,0x3c00,0x3c00,0x3c00,0x1e483c00,0x22483c00,0x24b63c00
.long 0x3c00,0x22483c00,0x26483bff,0x28b63bff,0x3c00,0x24b63c00,0x28b63bff,0x2b113bfd
.long 0x3c00,0x26483bff,0x2a483bfe,0x2cb53bfa,0x3c00,0x27da3bff,0x2bd93bfc,0x2de23bf7
.long 0x3c00,0x28b63bff,0x2cb53bfa,0x2f0e3bf4,0x3c00,0x297f3bfe,0x2d7e3bf8,0x301d3bef
.long 0x3c00,0x2a483bfe,0x2e463bf6,0x30b23bea,0x3c00,0x2b113bfd,0x2f0e3bf4,0x31473be4
.long 0x3c00,0x2bd93bfc,0x2fd63bf1,0x31db3bdd,0x3c00,0x2c513bfb,0x304e3bed,0x326f3bd6
.long 0x3c00,0x2cb53bfa,0x30b23bea,0x33033bce,0x3c00,0x2d1a3bf9,0x31153be6,0x33963bc6
.long 0x3c00,0x2d7e3bf8,0x31793be2,0x34143bbc,0x3c00,0x2de23bf7,0x31db3bdd,0x345d3bb2
.long 0x3c00,0x2e463bf6,0x323e3bd9,0x34a53ba8,0x3c00,0x2eaa3bf5,0x32a13bd4,0x34ed3b9d
.long 0x3c00,0x2f0e3bf4,0x33033bce,0x35343b91,0x3c00,0x2f723bf2,0x33653bc9,0x357c3b84
.long 0x3c00,0x2fd63bf1,0x33c63bc3,0x35c23b77,0x3c00,0x301d3bef,0x34143bbc,0x36083b69
.long 0x3c00,0x304e3bed,0x34443bb6,0x364e3b5a,0x3c00,0x30803bec,0x34753baf,0x36933b4b
.long 0x3c00,0x30b23bea,0x34a53ba8,0x36d73b3b,0x3c00,0x30e43be8,0x34d53ba0,0x371b3b2b
.long 0x3c00,0x31153be6,0x35053b99,0x375e3b1a,0x3c00,0x31473be4,0x35343b91,0x37a13b08
.long 0x3c00,0x31793be2,0x35643b88,0x37e33af6,0x3c00,0x31aa3be0,0x35933b80,0x38123ae3
.long 0x3c00,0x31db3bdd,0x35c23b77,0x38323ad0,0x3c00,0x320d3bdb,0x35f13b6e,0x38523abc
.long 0x3c00,0x3c00,0x3c00,0x3c00,0x26483bff,0x27da3bff,0x28b63bff,0x297f3bfe
.long 0x2a483bfe,0x2bd93bfc,0x2cb53bfa,0x2d7e3bf8,0x2cb53bfa,0x2de23bf7,0x2f0e3bf4,0x301d3bef
.long 0x2e463bf6,0x2fd63bf1,0x30b23bea,0x31793be2,0x2fd63bf1,0x30e43be8,0x31db3bdd,0x32d23bd1
.long 0x30b23bea,0x31db3bdd,0x33033bce,0x34143bbc,0x31793be2,0x32d23bd1,0x34143bbc,0x34bd3ba4
.long 0x323e3bd9,0x33c63bc3,0x34a53ba8,0x35643b88,0x33033bce,0x345d3bb2,0x35343b91,0x36083b69
.long 0x33c63bc3,0x34d53ba0,0x35c23b77,0x36aa3b46,0x34443bb6,0x354c3b8c,0x364e3b5a,0x37483b20
.long 0x34a53ba8,0x35c23b77,0x36d73b3b,0x37e33af6,0x35053b99,0x36373b5f,0x375e3b1a,0x383d3ac9
.long 0x35643b88,0x36aa3b46,0x37e33af6,0x38873a99,0x35c23b77,0x371b3b2b,0x38323ad0,0x38ce3a65
.long 0x361f3b64,0x378b3b0e,0x38723aa7,0x39133a2f,0x367c3b50,0x37f93af0,0x38b03a7c,0x395639f6
.long 0x36d73b3b,0x38323ad0,0x38ec3a4f,0x399639ba,0x37323b25,0x38673aae,0x39273a1f,0x39d4397b
.long 0x378b3b0e,0x389b3a8a,0x395f39ed,0x3a0f393a,0x37e33af6,0x38ce3a65,0x399639ba,0x3a4738f6
.long 0x381d3add,0x39003a3f,0x39cb3984,0x3a7c38b0,0x38483ac2,0x39303a17,0x39fe394d,0x3aae3867
.long 0x38723aa7,0x395f39ed,0x3a2f3913,0x3add381d,0x389b3a8a,0x398d39c3,0x3a5e38d8,0x3b0837a1
.long 0x38c43a6d,0x39ba3996,0x3a8a389b,0x3b303705,0x38ec3a4f,0x39e53969,0x3ab5385d,0x3b553665
.long 0x39133a2f,0x3a0f393a,0x3add381d,0x3b7735c2,0x393a3a0f,0x3a373909,0x3b0237b7,0x3b95351d
.long 0x395f39ed,0x3a5e38d8,0x3b253732,0x3baf3475,0x398439cb,0x3a8338a6,0x3b4636aa,0x3bc63396
.long 0x3c00,0x3c00,0x3c00,0x3c00,0x2a483bfe,0x2b113bfd,0x2bd93bfc,0x2c513bfb
.long 0x2e463bf6,0x2f0e3bf4,0x2fd63bf1,0x304e3bed,0x30b23bea,0x31473be4,0x31db3bdd,0x326f3bd6
.long 0x323e3bd9,0x33033bce,0x33c63bc3,0x34443bb6,0x33c63bc3,0x345d3bb2,0x34d53ba0,0x354c3b8c
.long 0x34a53ba8,0x35343b91,0x35c23b77,0x364e3b5a,0x35643b88,0x36083b69,0x36aa3b46,0x37483b20
.long 0x361f3b64,0x36d73b3b,0x378b3b0e,0x381d3add,0x36d73b3b,0x37a13b08,0x38323ad0,0x38913a92
.long 0x378b3b0e,0x38323ad0,0x389b3a8a,0x39003a3f,0x381d3add,0x38913a92,0x39003a3f,0x396939e5
.long 0x38723aa7,0x38ec3a4f,0x395f39ed,0x39cb3984,0x38c43a6d,0x39433a07,0x39ba3996,0x3a27391d
.long 0x39133a2f,0x399639ba,0x3a0f393a,0x3a7c38b0,0x395f39ed,0x39e53969,0x3a5e38d8,0x3ac9383d
.long 0x39a839a8,0x3a2f3913,0x3aa73872,0x3b0e378b,0x39ed395f,0x3a7438ba,0x3ae93807,0x3b4b3693
.long 0x3a2f3913,0x3ab5385d,0x3b253732,0x3b803593,0x3a6d38c4,0x3af037f9,0x3b5a364e,0x3bab348d
.long 0x3aa73872,0x3b253732,0x3b883564,0x3bce3303,0x3add381d,0x3b553665,0x3baf3475,0x3be830e4
.long 0x3b0e378b,0x3b803593,0x3bce3303,0x3bf82d7e,0x3b3b36d7,0x3ba434bd,0x3be63115,0x3c0024b6
.long 0x3b64361f,0x3bc333c6,0x3bf62e46,0x3bfeaa48,0x3b883564,0x3bdb320d,0x3bff28b6,0x3bf2af72
.long 0x3ba834a5,0x3bed304e,0x3bffa648,0x3bddb1db,0x3bc333c6,0x3bf92d1a,0x3bf8ad7e,0x3bc0b3f7
.long 0x3bd9323e,0x3bff2648,0x3beab0b2,0x3b99b505,0x3bea30b2,0x3bffa7da,0x3bd4b2a1,0x3b69b608
.long 0x3bf62e46,0x3bf8ad7e,0x3bb6b444,0x3b30b705,0x3bfe2a48,0x3becb080,0x3b91b534,0x3af0b7f9
.long 0x3c00,0x3c00,0x3c00,0x3c00,0x2cb53bfa,0x2d1a3bf9,0x2d7e3bf8,0x2de23bf7
.long 0x30b23bea,0x31153be6,0x31793be2,0x31db3bdd,0x33033bce,0x33963bc6,0x34143bbc,0x345d3bb2
.long 0x34a53ba8,0x35053b99,0x35643b88,0x35c23b77,0x35c23b77,0x36373b5f,0x36aa3b46,0x371b3b2b
.long 0x36d73b3b,0x375e3b1a,0x37e33af6,0x38323ad0,0x37e33af6,0x383d3ac9,0x38873a99,0x38ce3a65
.long 0x38723aa7,0x38c43a6d,0x39133a2f,0x395f39ed,0x38ec3a4f,0x39433a07,0x399639ba,0x39e53969
.long 0x395f39ed,0x39ba3996,0x3a0f393a,0x3a5e38d8,0x39cb3984,0x3a27391d,0x3a7c38b0,0x3ac9383d
.long 0x3a2f3913,0x3a8a389b,0x3add381d,0x3b253732,0x3a8a389b,0x3ae33812,0x3b303705,0x3b7235da
.long 0x3add381d,0x3b303705,0x3b7735c2,0x3baf3475,0x3b253732,0x3b7235da,0x3baf3475,0x3bdb320d
.long 0x3b64361f,0x3ba834a5,0x3bd9323e,0x3bf62e46,0x3b993505,0x3bd132d2,0x3bf42f0e,0x3c001e48
.long 0x3bc333c6,0x3bed304e,0x3bff2648,0x3bf8ad7e,0x3be23179,0x3bfd2b11,0x3bfcabd9,0x3be0b1aa
.long 0x3bf62e46,0x3bffa648,0x3beab0b2,0x3bb6b444,0x3bff2648,0x3bf5aeaa,0x3bc9b365,0x3b7bb5ab
.long 0x3bfeaa48,0x3bddb1db,0x3b99b505,0x3b30b705,0x3bf1afd6,0x3bb9b42c,0x3b5ab64e,0x3ad6b828
.long 0x3bd9b23e,0x3b88b564,0x3b0eb78b,0x3a6db8c4,0x3bb6b444,0x3b4bb693,0x3ab5b85d,0x39f6b956
.long 0x3b88b564,0x3b02b7b7,0x3a4fb8ec,0x3972b9dc,0x3b50b67c,0x3aaeb867,0x39dcb972,0x38e2ba56
.long 0x3b0eb78b,0x3a4fb8ec,0x395fb9ed,0x3848bac2,0x3ac2b848,0x39e5b969,0x38d8ba5e,0x3748bb20
.long 0x3a6db8c4,0x3972b9dc,0x3848bac2,0x35f1bb6e,0x3a0fb93a,0x38f6ba47,0x375ebb1a,0x348dbbab
.long 0x3c00,0x3c00,0x3c00,0x3c00,0x2e463bf6,0x2eaa3bf5,0x2f0e3bf4,0x2f723bf2
.long 0x323e3bd9,0x32a13bd4,0x33033bce,0x33653bc9,0x34a53ba8,0x34ed3b9d,0x35343b91,0x357c3b84
.long 0x361f3b64,0x367c3b50,0x36d73b3b,0x37323b25,0x378b3b0e,0x37f93af0,0x38323ad0,0x38673aae
.long 0x38723aa7,0x38b03a7c,0x38ec3a4f,0x39273a1f,0x39133a2f,0x395639f6,0x399639ba,0x39d4397b
.long 0x39a839a8,0x39ed395f,0x3a2f3913,0x3a6d38c4,0x3a2f3913,0x3a7438ba,0x3ab5385d,0x3af037f9
.long 0x3aa73872,0x3ae93807,0x3b253732,0x3b5a364e,0x3b0e378b,0x3b4b3693,0x3b803593,0x3bab348d
.long 0x3b64361f,0x3b993505,0x3bc333c6,0x3be23179,0x3ba834a5,0x3bd132d2,0x3bed304e,0x3bfd2b11
.long 0x3bd9323e,0x3bf42f0e,0x3bff2648,0x3bfcabd9,0x3bf62e46,0x3c001e48,0x3bf8ad7e,0x3be0b1aa
.long 0x3c000000,0x3bf6ae46,0x3bd9b23e,0x3ba8b4a5,0x3bf6ae46,0x3bd6b26f,0x3ba0b4d5,0x3b55b665
.long 0x3bd9b23e,0x3ba0b4d5,0x3b50b67c,0x3ae9b807,0x3ba8b4a5,0x3b55b665,0x3ae9b807,0x3a65b8ce
.long 0x3b64b61f,0x3af6b7e3,0x3a6db8c4,0x39cbb984,0x3b0eb78b,0x3a83b8a6,0x39dcb972,0x391dba27
.long 0x3aa7b872,0x39feb94d,0x393aba0f,0x385dbab5,0x3a2fb913,0x3969b9e5,0x3887ba99,0x371bbb2b
.long 0x39a8b9a8,0x38c4ba6d,0x378bbb0e,0x3564bb88,0x3913ba2f,0x3812bae3,0x35f1bb6e,0x3334bbcb
.long 0x3872baa7,0x36aabb46,0x3444bbb6,0x2f0ebbf4,0x378bbb0e,0x351dbb95,0x3115bbe6,0x9e48bc00
.long 0x361fbb64,0x3303bbce,0x2a48bbfe,0xafd6bbf1,0x34a5bba8,0x2f72bbf2,0xabd9bbfc,0xb396bbc6
.long 0x323ebbd9,0x2248bc00,0xb179bbe2,0xb593bb80,0x2e46bbf6,0xade2bbf7,0xb475bbaf,0xb748bb20
.long 0x3c00,0x3c00,0x3c00,0x3c00,0x2fd63bf1,0x301d3bef,0x304e3bed,0x30803bec
.long 0x33c63bc3,0x34143bbc,0x34443bb6,0x34753baf,0x35c23b77,0x36083b69,0x364e3b5a,0x36933b4b
.long 0x378b3b0e,0x37e33af6,0x381d3add,0x38483ac2,0x389b3a8a,0x38ce3a65,0x39003a3f,0x39303a17
.long 0x395f39ed,0x399639ba,0x39cb3984,0x39fe394d,0x3a0f393a,0x3a4738f6,0x3a7c38b0,0x3aae3867
.long 0x3aa73872,0x3add381d,0x3b0e378b,0x3b3b36d7,0x3b253732,0x3b553665,0x3b803593,0x3ba434bd
.long 0x3b883564,0x3baf3475,0x3bce3303,0x3be63115,0x3bce3303,0x3be830e4,0x3bf82d7e,0x3c0024b6
.long 0x3bf62e46,0x3bff2648,0x3bfeaa48,0x3bf1afd6,0x3bffa648,0x3bf5aeaa,0x3bddb1db,0x3bb9b42c
.long 0x3beab0b2,0x3bc9b365,0x3b99b505,0x3b5ab64e,0x3bb6b444,0x3b7bb5ab,0x3b30b705,0x3ad6b828
.long 0x3b64b61f,0x3b0eb78b,0x3aa7b872,0x3a2fb913,0x3af6b7e3,0x3a83b8a6,0x39feb94d,0x3969b9e5
.long 0x3a6db8c4,0x39dcb972,0x393aba0f,0x3887ba99,0x39cbb984,0x391dba27,0x385dbab5,0x371bbb2b
.long 0x3913ba2f,0x3848bac2,0x36d7bb3b,0x3505bb99,0x3848bac2,0x36c1bb41,0x34d5bba0,0x31aabbe0
.long 0x36d7bb3b,0x34d5bba0,0x3179bbe2,0x28b6bbff,0x3505bb99,0x31aabbe0,0x28b6bbff,0xaeaabbf5
.long 0x323ebbd9,0x2a48bbfe,0xae46bbf6,0xb3c6bbc3,0x2cb5bbfa,0xad1abbf9,0xb365bbc9,0xb608bb69
.long 0xaa48bbfe,0xb2a1bbd4,0xb5c2bb77,0xb807bae9,0xb179bbe2,0xb54cbb8c,0xb7b7bb02,0xb8f6ba47
.long 0xb4a5bba8,0xb732bb25,0xb8c4ba6d,0xb9cbb984,0xb67cbb50,0xb87cbaa0,0xb996b9ba,0xba83b8a6
.long 0xb81dbadd,0xb94db9fe,0xba4fb8ec,0xbb1ab75e,0xb8ecba4f,0xba07b943,0xbae9b807,0xbb8cb54c
.long 0x3c00,0x3c00,0x3c00,0x3c00,0x30b23bea,0x30e43be8,0x31153be6,0x31473be4
.long 0x34a53ba8,0x34d53ba0,0x35053b99,0x35343b91,0x36d73b3b,0x371b3b2b,0x375e3b1a,0x37a13b08
.long 0x38723aa7,0x389b3a8a,0x38c43a6d,0x38ec3a4f,0x395f39ed,0x398d39c3,0x39ba3996,0x39e53969
.long 0x3a2f3913,0x3a5e38d8,0x3a8a389b,0x3ab5385d,0x3add381d,0x3b0837a1,0x3b303705,0x3b553665
.long 0x3b64361f,0x3b883564,0x3ba834a5,0x3bc333c6,0x3bc333c6,0x3bdb320d,0x3bed304e,0x3bf92d1a
.long 0x3bf62e46,0x3bff28b6,0x3bffa648,0x3bf8ad7e,0x3bfeaa48,0x3bf2af72,0x3bddb1db,0x3bc0b3f7
.long 0x3bd9b23e,0x3bb6b444,0x3b88b564,0x3b50b67c,0x3b88b564,0x3b4bb693,0x3b02b7b7,0x3aaeb867
.long 0x3b0eb78b,0x3ab5b85d,0x3a4fb8ec,0x39dcb972,0x3a6db8c4,0x39f6b956,0x3972b9dc,0x38e2ba56
.long 0x39a8b9a8,0x3913ba2f,0x3872baa7,0x378bbb0e,0x38c4ba6d,0x3812bae3,0x36aabb46,0x351dbb95
.long 0x378bbb0e,0x35f1bb6e,0x3444bbb6,0x3115bbe6,0x3564bb88,0x3334bbcb,0x2f0ebbf4,0x9e48bc00
.long 0x323ebbd9,0x2cb5bbfa,0xaa48bbfe,0xb179bbe2,0x2a48bbfe,0xad1abbf9,0xb2a1bbd4,0xb54cbb8c
.long 0xae46bbf6,0xb365bbc9,0xb5c2bb77,0xb7b7bb02,0xb3c6bbc3,0xb608bb69,0xb807bae9,0xb8f6ba47
.long 0xb61fbb64,0xb81dbadd,0xb913ba2f,0xb9edb95f,0xb81dbadd,0xb91dba27,0xb9feb94d,0xbabcb852
.long 0xb913ba2f,0xb9feb94d,0xbac2b848,0xbb5ab64e,0xb9edb95f,0xbabcb852,0xbb5ab64e,0xbbc6b396
.long 0xbaa7b872,0xbb50b67c,0xbbc3b3c6,0xbbfaacb5,0xbb3bb6d7,0xbbb9b42c,0xbbf8ad7e,0xbbf72de2
.long 0xbba8b4a5,0xbbf4af0e,0xbbfa2cb5,0xbbbc3414,0xbbeab0b2,0xbbfe297f,0xbbc93365,0xbb4b3693
.long 0x3c00,0x3c00,0x3c00,0x3c00,0x31793be2,0x31aa3be0,0x31db3bdd,0x320d3bdb
.long 0x35643b88,0x35933b80,0x35c23b77,0x35f13b6e,0x37e33af6,0x38123ae3,0x38323ad0,0x38523abc
.long 0x39133a2f,0x393a3a0f,0x395f39ed,0x398439cb,0x3a0f393a,0x3a373909,0x3a5e38d8,0x3a8338a6
.long 0x3add381d,0x3b0237b7,0x3b253732,0x3b4636aa,0x3b7735c2,0x3b95351d,0x3baf3475,0x3bc63396
.long 0x3bd9323e,0x3bea30b2,0x3bf62e46,0x3bfe2a48,0x3bff2648,0x3bffa7da,0x3bf8ad7e,0x3becb080
.long 0x3beab0b2,0x3bd4b2a1,0x3bb6b444,0x3b91b534,0x3b99b505,0x3b69b608,0x3b30b705,0x3af0b7f9
.long 0x3b0eb78b,0x3ac2b848,0x3a6db8c4,0x3a0fb93a,0x3a4fb8ec,0x39e5b969,0x3972b9dc,0x38f6ba47
.long 0x395fb9ed,0x38d8ba5e,0x3848bac2,0x375ebb1a,0x3848bac2,0x3748bb20,0x35f1bb6e,0x348dbbab
.long 0x361fbb64,0x34a5bba8,0x323ebbd9,0x2e46bbf6,0x3303bbce,0x2f72bbf2,0x2248bc00,0xade2bbf7
.long 0x2a48bbfe,0xabd9bbfc,0xb179bbe2,0xb475bbaf,0xafd6bbf1,0xb396bbc6,0xb593bb80,0xb748bb20
.long 0xb4a5bba8,0xb67cbb50,0xb81dbadd,0xb8ecba4f,0xb732bb25,0xb87cbaa0,0xb94db9fe,0xba07b943
.long 0xb8c4ba6d,0xb996b9ba,0xba4fb8ec,0xbae9b807,0xb9cbb984,0xba83b8a6,0xbb1ab75e,0xbb8cb54c
.long 0xbaa7b872,0xbb3bb6d7,0xbba8b4a5,0xbbeab0b2,0xbb50b67c,0xbbb9b42c,0xbbf4af0e,0xbbfe297f
.long 0xbbc3b3c6,0xbbf8ad7e,0xbbfa2cb5,0xbbc93365,0xbbfaacb5,0xbbf72de2,0xbbbc3414,0xbb4b3693
.long 0xbbf62e46,0xbbb63444,0xbb3b36d7,0xba8a389b,0xbbb63444,0xbb3636ee,0xba7c38b0,0xb98d39c3
.long 0xbb3b36d7,0xba7c38b0,0xb98439cb,0xb85d3ab5,0xba8a389b,0xb98d39c3,0xb85d3ab5,0xb6083b69
.long 0x3c00,0x3c00,0x3c00,0x3c00,0x1a483c00,0x20b63c00,0x23db3c00,0x257f3c00
.long 0x1e483c00,0x24b63c00,0x27da3bff,0x297f3bfe,0x20b63c00,0x27113bff,0x29e33bfe,0x2c1f3bfc
.long 0x22483c00,0x28b63bff,0x2bd93bfc,0x2d7e3bf8,0x23db3c00,0x29e33bfe,0x2ce73bfa,0x2edc3bf4
.long 0x24b63c00,0x2b113bfd,0x2de23bf7,0x301d3bef,0x257f3c00,0x2c1f3bfc,0x2edc3bf4,0x30cb3be9
.long 0x26483bff,0x2cb53bfa,0x2fd63bf1,0x31793be2,0x27113bff,0x2d4c3bf9,0x30673bed,0x32263bda
.long 0x27da3bff,0x2de23bf7,0x30e43be8,0x32d23bd1,0x28523bff,0x2e783bf6,0x31603be3,0x337d3bc7
.long 0x28b63bff,0x2f0e3bf4,0x31db3bdd,0x34143bbc,0x291b3bfe,0x2fa43bf1,0x32573bd7,0x34693bb1
.long 0x297f3bfe,0x301d3bef,0x32d23bd1,0x34bd3ba4,0x29e33bfe,0x30673bed,0x334c3bca,0x35113b97
.long 0x2a483bfe,0x30b23bea,0x33c63bc3,0x35643b88,0x2aac3bfd,0x30fd3be7,0x34203bbb,0x35b63b79
.long 0x2b113bfd,0x31473be4,0x345d3bb2,0x36083b69,0x2b753bfd,0x31913be1,0x34993baa,0x36593b58
.long 0x2bd93bfc,0x31db3bdd,0x34d53ba0,0x36aa3b46,0x2c1f3bfc,0x32263bda,0x35113b97,0x36f93b33
.long 0x2c513bfb,0x326f3bd6,0x354c3b8c,0x37483b20,0x2c833bfb,0x32b93bd2,0x35873b82,0x37963b0b
.long 0x2cb53bfa,0x33033bce,0x35c23b77,0x37e33af6,0x2ce73bfa,0x334c3bca,0x35fd3b6b,0x38173ae0
.long 0x2d1a3bf9,0x33963bc6,0x36373b5f,0x383d3ac9,0x2d4c3bf9,0x33df3bc1,0x36703b53,0x38623ab1
.long 0x2d7e3bf8,0x34143bbc,0x36aa3b46,0x38873a99,0x2db03bf8,0x34383bb7,0x36e33b39,0x38ab3a7f
.long 0x2de23bf7,0x345d3bb2,0x371b3b2b,0x38ce3a65,0x2e143bf7,0x34813bad,0x37533b1d,0x38f13a4b
.long 0x3c00,0x3c00,0x3c00,0x3c00,0x27113bff,0x28523bff,0x291b3bfe,0x29e33bfe
.long 0x2b113bfd,0x2c513bfb,0x2d1a3bf9,0x2de23bf7,0x2d4c3bf9,0x2e783bf6,0x2fa43bf1,0x30673bed
.long 0x2f0e3bf4,0x304e3bed,0x31153be6,0x31db3bdd,0x30673bed,0x31603be3,0x32573bd7,0x334c3bca
.long 0x31473be4,0x326f3bd6,0x33963bc6,0x345d3bb2,0x32263bda,0x337d3bc7,0x34693bb1,0x35113b97
.long 0x33033bce,0x34443bb6,0x35053b99,0x35c23b77,0x33df3bc1,0x34c93ba2,0x359f3b7d,0x36703b53
.long 0x345d3bb2,0x354c3b8c,0x36373b5f,0x371b3b2b,0x34c93ba2,0x35ce3b74,0x36cc3b3e,0x37c23aff
.long 0x35343b91,0x364e3b5a,0x375e3b1a,0x38323ad0,0x359f3b7d,0x36cc3b3e,0x37ee3af3,0x38813a9c
.long 0x36083b69,0x37483b20,0x383d3ac9,0x38ce3a65,0x36703b53,0x37c23aff,0x38813a9c,0x39183a2b
.long 0x36d73b3b,0x381d3add,0x38c43a6d,0x395f39ed,0x373d3b22,0x38583ab8,0x39053a3b,0x39a439ad
.long 0x37a13b08,0x38913a92,0x39433a07,0x39e53969,0x38023aed,0x38c93a69,0x398039d0,0x3a233922
.long 0x38323ad0,0x39003a3f,0x39ba3996,0x3a5e38d8,0x38623ab1,0x39353a13,0x39f2395b,0x3a95388c
.long 0x38913a92,0x396939e5,0x3a27391d,0x3ac9383d,0x38bf3a71,0x399b39b5,0x3a5a38dd,0x3af937d8
.long 0x38ec3a4f,0x39cb3984,0x3a8a389b,0x3b253732,0x39183a2b,0x39fa3951,0x3ab83858,0x3b4e3687
.long 0x39433a07,0x3a27391d,0x3ae33812,0x3b7235da,0x396d39e1,0x3a5238e7,0x3b0b3796,0x3b933529
.long 0x399639ba,0x3a7c38b0,0x3b303705,0x3baf3475,0x39be3992,0x3aa33877,0x3b533670,0x3bc7337d
.long 0x39e53969,0x3ac9383d,0x3b7235da,0x3bdb320d,0x3a0b393e,0x3aed3802,0x3b8f3540,0x3beb3099
.long 0x3c00,0x3c00,0x3c00,0x3c00,0x2aac3bfd,0x2b753bfd,0x2c1f3bfc,0x2c833bfb
.long 0x2eaa3bf5,0x2f723bf2,0x301d3bef,0x30803bec,0x30fd3be7,0x31913be1,0x32263bda,0x32b93bd2
.long 0x32a13bd4,0x33653bc9,0x34143bbc,0x34753baf,0x34203bbb,0x34993baa,0x35113b97,0x35873b82
.long 0x34ed3b9d,0x357c3b84,0x36083b69,0x36933b4b,0x35b63b79,0x36593b58,0x36f93b33,0x37963b0b
.long 0x367c3b50,0x37323b25,0x37e33af6,0x38483ac2,0x373d3b22,0x38023aed,0x38623ab1,0x38bf3a71
.long 0x37f93af0,0x38673aae,0x38ce3a65,0x39303a17,0x38583ab8,0x38c93a69,0x39353a13,0x399b39b5
.long 0x38b03a7c,0x39273a1f,0x399639ba,0x39fe394d,0x39053a3b,0x398039d0,0x39f2395b,0x3a5a38dd
.long 0x395639f6,0x39d4397b,0x3a4738f6,0x3aae3867,0x39a439ad,0x3a233922,0x3a95388c,0x3af937d8
.long 0x39ed395f,0x3a6d38c4,0x3add381d,0x3b3b36d7,0x3a33390e,0x3ab13862,0x3b1d3753,0x3b7435ce
.long 0x3a7438ba,0x3af037f9,0x3b553665,0x3ba434bd,0x3ab13862,0x3b283726,0x3b863570,0x3bca334c
.long 0x3ae93807,0x3b5a364e,0x3baf3475,0x3be63115,0x3b1d3753,0x3b863570,0x3bd032ea,0x3bf82db0
.long 0x3b4b3693,0x3bab348d,0x3be830e4,0x3c0024b6,0x3b7435ce,0x3bca334c,0x3bf82db0,0x3bfdaaac
.long 0x3b993505,0x3be23179,0x3bff2648,0x3bf1afd6,0x3bb73438,0x3bf32f40,0x3bfea91b,0x3bdab226
.long 0x3bd132d2,0x3bfd2b11,0x3bf5aeaa,0x3bb9b42c,0x3be5312e,0x3c009a48,0x3be3b160,0x3b8fb540
.long 0x3bf42f0e,0x3bfcabd9,0x3bc9b365,0x3b5ab64e,0x3bfd2b75,0x3bf1afa4,0x3ba6b4b1,0x3b1db753
.long 0x3c001e48,0x3be0b1aa,0x3b7bb5ab,0x3ad6b828,0x3bfea9e3,0x3bc7b37d,0x3b49b69e,0x3a87b8a0
.long 0x3c00,0x3c00,0x3c00,0x3c00,0x2ce73bfa,0x2d4c3bf9,0x2db03bf8,0x2e143bf7
.long 0x30e43be8,0x31473be4,0x31aa3be0,0x320d3bdb,0x334c3bca,0x33df3bc1,0x34383bb7,0x34813bad
.long 0x34d53ba0,0x35343b91,0x35933b80,0x35f13b6e,0x35fd3b6b,0x36703b53,0x36e33b39,0x37533b1d
.long 0x371b3b2b,0x37a13b08,0x38123ae3,0x38523abc,0x38173ae0,0x38623ab1,0x38ab3a7f,0x38f13a4b
.long 0x389b3a8a,0x38ec3a4f,0x393a3a0f,0x398439cb,0x39183a2b,0x396d39e1,0x39be3992,0x3a0b393e
.long 0x398d39c3,0x39e53969,0x3a373909,0x3a8338a6,0x39fa3951,0x3a5238e7,0x3aa33877,0x3aed3802
.long 0x3a5e38d8,0x3ab5385d,0x3b0237b7,0x3b4636aa,0x3ab83858,0x3b0b3796,0x3b533670,0x3b8f3540
.long 0x3b0837a1,0x3b553665,0x3b95351d,0x3bc63396,0x3b4e3687,0x3b933529,0x3bc7337d,0x3beb3099
.long 0x3b883564,0x3bc333c6,0x3bea30b2,0x3bfe2a48,0x3bb73438,0x3be5312e,0x3bfd2b75,0x3bfea9e3
.long 0x3bdb320d,0x3bf92d1a,0x3bffa7da,0x3becb080,0x3bf32f40,0x3c009a48,0x3bf1afa4,0x3bc7b37d
.long 0x3bff28b6,0x3bf8ad7e,0x3bd4b2a1,0x3b91b534,0x3bfea91b,0x3be3b160,0x3ba6b4b1,0x3b49b69e
.long 0x3bf2af72,0x3bc0b3f7,0x3b69b608,0x3af0b7f9,0x3bdab226,0x3b8fb540,0x3b1db753,0x3a87b8a0
.long 0x3bb6b444,0x3b50b67c,0x3ac2b848,0x3a0fb93a,0x3b86b570,0x3b05b7ac,0x3a5ab8dd,0x3989b9c7
.long 0x3b4bb693,0x3aaeb867,0x39e5b969,0x38f6ba47,0x3b05b7ac,0x3a4bb8f1,0x3964b9e9,0x3858bab8
.long 0x3ab5b85d,0x39dcb972,0x38d8ba5e,0x375ebb1a,0x3a5ab8dd,0x3964b9e9,0x3842bac6,0x35fdbb6b
.long 0x39f6b956,0x38e2ba56,0x3748bb20,0x348dbbab,0x3989b9c7,0x3858bab8,0x35fdbb6b,0x3226bbda
.long 0x3c00,0x3c00,0x3c00,0x3c00,0x2e783bf6,0x2edc3bf4,0x2f403bf3,0x2fa43bf1
.long 0x326f3bd6,0x32d23bd1,0x33343bcb,0x33963bc6,0x34c93ba2,0x35113b97,0x35583b8a,0x359f3b7d
.long 0x364e3b5a,0x36aa3b46,0x37053b30,0x375e3b1a,0x37c23aff,0x38173ae0,0x384d3abf,0x38813a9c
.long 0x38913a92,0x38ce3a65,0x39093a37,0x39433a07,0x39353a13,0x397639d8,0x39b5399b,0x39f2395b
.long 0x39cb3984,0x3a0f393a,0x3a4f38ec,0x3a8a389b,0x3a5238e7,0x3a95388c,0x3ad3382d,0x3b0b3796
.long 0x3ac9383d,0x3b0837a1,0x3b4136c1,0x3b7235da,0x3b2e3710,0x3b673614,0x3b973511,0x3bbe3408
.long 0x3b803593,0x3baf3475,0x3bd432a1,0x3bed304e,0x3bbe3408,0x3be13191,0x3bf72e14,0x3c0023db
.long 0x3be830e4,0x3bfb2c51,0x3c00a4b6,0x3bf5aeaa,0x3bfd2aac,0x3bfea91b,0x3beeb036,0x3bcdb31b
.long 0x3bfeaa48,0x3beab0b2,0x3bc3b3c6,0x3b88b564,0x3be9b0cb,0x3bbeb408,0x3b7db59f,0x3b28b726
.long 0x3bc0b3f7,0x3b7bb5ab,0x3b20b748,0x3aaeb867,0x3b82b587,0x3b22b73d,0x3aaab86d,0x3a1bb92b
.long 0x3b30b705,0x3ab5b85d,0x3a1fb927,0x3972b9dc,0x3accb838,0x3a33b90e,0x3980b9d0,0x38b5ba78
.long 0x3a56b8e2,0x399fb9b1,0x38ceba65,0x37cdbafc,0x39d0b980,0x38fbba43,0x380dbae6,0x3614bb67
.long 0x393aba0f,0x3848bac2,0x367cbb50,0x3444bbb6,0x3896ba8e,0x3710bb2e,0x34c9bba2,0x30cbbbe9
.long 0x37cdbafc,0x357cbb84,0x320dbbdb,0x27dabbff,0x3659bb58,0x33aebbc4,0x2ce7bbfa,0xadb0bbf8
.long 0x34d5bba0,0x304ebbed,0xa8b6bbff,0xb2a1bbd4,0x3288bbd5,0x2711bbff,0xb0cbbbe9,0xb529bb93
.long 0x2eaabbf5,0xad1abbf9,0xb42cbbb9,0xb6eebb36,0x1a48bc00,0xb1f4bbdc,0xb5e5bb70,0xb84dbabf
.long 0x3c00,0x3c00,0x3c00,0x3c00,0x30043bf0,0x30363bee,0x30673bed,0x30993beb
.long 0x33f73bc0,0x342c3bb9,0x345d3bb2,0x348d3bab,0x35e53b70,0x362b3b62,0x36703b53,0x36b53b43
.long 0x37b73b02,0x38073ae9,0x38323ad0,0x385d3ab5,0x38b53a78,0x38e73a52,0x39183a2b,0x39483a02
.long 0x397b39d4,0x39b1399f,0x39e53969,0x3a173930,0x3a2b3918,0x3a6238d3,0x3a95388c,0x3ac63842
.long 0x3ac23848,0x3af637e3,0x3b253732,0x3b50367c,0x3b3e36cc,0x3b6b35fd,0x3b933529,0x3bb43451
.long 0x3b9d34ed,0x3bc033f7,0x3bdb320d,0x3bef301d,0x3bdc31f4,0x3bf12fa4,0x3bfd2aac,0x3c00a3db
.long 0x3bfc2bd9,0x3c00a248,0x3bf8ad7e,0x3be6b115,0x3bfcac1f,0x3bebb099,0x3bcdb31b,0x3ba2b4c9
.long 0x3bdbb20d,0x3bb2b45d,0x3b7bb5ab,0x3b36b6ee,0x3b9bb4f9,0x3b58b659,0x3b05b7ac,0x3aa3b877
.long 0x3b3bb6d7,0x3addb81d,0x3a6db8c4,0x39edb95f,0x3abfb84d,0x3a43b8fb,0x39b5b99b,0x3918ba2b
.long 0x3a27b91d,0x398db9c3,0x38e2ba56,0x3828bad6,0x3976b9d8,0x38bfba71,0x37eebaf3,0x3642bb5d
.long 0x38b0ba7c,0x37b7bb02,0x35f1bb6e,0x3414bbbc,0x37acbb05,0x35cebb74,0x33aebbc4,0x2f40bbf3
.long 0x35dabb72,0x3396bbc6,0x2eaabbf5,0xa7dabbff,0x33dfbbc1,0x2edcbbf4,0xa852bbff,0xb191bbe1
.long 0x2fd6bbf1,0xa648bbff,0xb179bbe2,0xb505bb99,0x9a48bc00,0xb0fdbbe7,0xb4e1bb9e,0xb726bb28
.long 0xb01dbbef,0xb48dbbab,0xb6eebb36,0xb891ba92,0xb408bbbe,0xb687bb4e,0xb86dbaaa,0xb976b9d8
.long 0xb5f1bb6e,0xb832bad0,0xb94db9fe,0xba3fb900,0xb7c2baff,0xb90eba33,0xba13b935,0xbae6b80d
.long 0xb8baba74,0xb9d4b97b,0xbabcb852,0xbb69b608,0xb980b9d0,0xba7fb8ab,0xbb43b6b5,0xbbc4b3ae
.long 0x3c00,0x3c00,0x3c00,0x3c00,0x30cb3be9,0x30fd3be7,0x312e3be5,0x31603be3
.long 0x34bd3ba4,0x34ed3b9d,0x351d3b95,0x354c3b8c,0x36f93b33,0x373d3b22,0x37803b11,0x37c23aff
.long 0x38873a99,0x38b03a7c,0x38d83a5e,0x39003a3f,0x397639d8,0x39a439ad,0x39d03980,0x39fa3951
.long 0x3a4738f6,0x3a7438ba,0x3aa0387c,0x3ac9383d,0x3af337ee,0x3b1d3753,0x3b4336b5,0x3b673614
.long 0x3b7735c2,0x3b993505,0x3bb63444,0x3bce3303,0x3bd032ea,0x3be5312e,0x3bf42edc,0x3bfd2aac
.long 0x3bfb2c51,0x3c001e48,0x3bfdab11,0x3bf2af72,0x3bf9ad4c,0x3be9b0cb,0x3bd0b2ea,0x3badb481
.long 0x3bc9b365,0x3ba0b4d5,0x3b6eb5f1,0x3b30b705,0x3b6bb5fd,0x3b28b726,0x3ad9b822,0x3a7fb8ab
.long 0x3ae3b812,0x3a83b8a6,0x3a17b930,0x399fb9b1,0x3a33b90e,0x39b5b99b,0x392bba1b,0x3896ba8e
.long 0x395fb9ed,0x38c4ba6d,0x381dbadd,0x36d7bb3b,0x386dbaaa,0x376abb17,0x35e5bb70,0x3451bbb4
.long 0x36c1bb41,0x351dbb95,0x32d2bbd1,0x2eaabbf5,0x3481bbad,0x3160bbe3,0x2aacbbfd,0xac1fbbfc
.long 0x304ebbed,0x2248bc00,0xaf0ebbf4,0xb365bbc9,0xa3dbbc00,0xb099bbeb,0xb451bbb4,0xb642bb5d
.long 0xb147bbe4,0xb4bdbba4,0xb6c1bb41,0xb852babc,0xb4f9bb9b,0xb710bb2e,0xb881ba9c,0xb964b9e9
.long 0xb732bb25,0xb89bba8a,0xb984b9cb,0xba4fb8ec,0xb8a0ba87,0xb992b9be,0xba62b8d3,0xbb0bb796
.long 0xb98db9c3,0xba65b8ce,0xbb14b775,0xbb95b51d,0xba5ab8dd,0xbb11b780,0xbb97b511,0xbbe7b0fd
.long 0xbb02b7b7,0xbb91b534,0xbbe6b115,0xbc002248,0xbb82b587,0xbbe1b191,0xbc001a48,0xbbdf31c3
.long 0xbbd6b26f,0xbc00a4b6,0xbbe43147,0xbb84357c,0xbbfdaaac,0xbbed3067,0xbb933529,0xbaf337ee
.long 0x3c00,0x3c00,0x3c00,0x3c00,0x31913be1,0x31c33bdf,0x31f43bdc,0x32263bda
.long 0x357c3b84,0x35ab3b7b,0x35da3b72,0x36083b69,0x38023aed,0x38223ad9,0x38423ac6,0x38623ab1
.long 0x39273a1f,0x394d39fe,0x397239dc,0x399639ba,0x3a233922,0x3a4b38f1,0x3a7138bf,0x3a95388c
.long 0x3af037f9,0x3b143775,0x3b3636ee,0x3b553665,0x3b863570,0x3ba234c9,0x3bbb3420,0x3bd032ea
.long 0x3be23179,0x3bf12fd6,0x3bfa2cb5,0x3bff2648,0x3c009a48,0x3bfdab75,0x3bf3af40,0x3be3b160
.long 0x3be0b1aa,0x3bc6b396,0x3ba4b4bd,0x3b7bb5ab,0x3b82b587,0x3b4eb687,0x3b11b780,0x3accb838
.long 0x3ae9b807,0x3a99b887,0x3a3fb900,0x39dcb972,0x3a1bb92b,0x39adb9a4,0x3935ba13,0x38b5ba78
.long 0x391dba27,0x3891ba92,0x37f9baf0,0x36c1bb41,0x37eebaf3,0x369ebb49,0x3540bb8f,0x33aebbc4
.long 0x3564bb88,0x33c6bbc3,0x30b2bbea,0x2a48bbfe,0x3160bbe3,0x2c1fbbfc,0xa91bbbfe,0xb099bbeb
.long 0x9e48bc00,0xaf72bbf2,0xb334bbcb,0xb54cbb8c,0xb1c3bbdf,0xb4b1bba6,0xb670bb53,0xb80dbae6
.long 0xb593bb80,0xb75ebb1a,0xb887ba99,0xb94db9fe,0xb80dbae6,0xb8e7ba52,0xb9adb9a4,0xba5ab8dd
.long 0xb930ba17,0xb9f6b956,0xbaa0b87c,0xbb2bb71b,0xba2bb918,0xbad3b82d,0xbb58b659,0xbbb7b438
.long 0xbaf6b7e3,0xbb77b5c2,0xbbceb303,0xbbfaacb5,0xbb8ab558,0xbbdcb1f4,0xbbffa852,0xbbf12fa4
.long 0xbbe4b147,0xbc009e48,0xbbe830e4,0xbb9d34ed,0xbc0020b6,0xbbe13191,0xbb8a3558,0xbaff37c2
.long 0xbbdd31db,0xbb803593,0xbae93807,0xba1f3927,0xbb7d359f,0xbae03817,0xba0b393e,0xb9053a3b
.long 0xbae33812,0xba073943,0xb8f63a47,0xb7753b14,0xba133935,0xb8fb3a43,0xb76a3b17,0xb4993baa
.long 0x3c00,0x1a483c00,0x1e483c00,0x20b63c00,0x3c00,0x20b63c00,0x24b63c00,0x27113bff
.long 0x3c00,0x23db3c00,0x27da3bff,0x29e33bfe,0x3c00,0x257f3c00,0x297f3bfe,0x2c1f3bfc
.long 0x3c00,0x27113bff,0x2b113bfd,0x2d4c3bf9,0x3c00,0x28523bff,0x2c513bfb,0x2e783bf6
.long 0x3c00,0x291b3bfe,0x2d1a3bf9,0x2fa43bf1,0x3c00,0x29e33bfe,0x2de23bf7,0x30673bed
.long 0x3c00,0x2aac3bfd,0x2eaa3bf5,0x30fd3be7,0x3c00,0x2b753bfd,0x2f723bf2,0x31913be1
.long 0x3c00,0x2c1f3bfc,0x301d3bef,0x32263bda,0x3c00,0x2c833bfb,0x30803bec,0x32b93bd2
.long 0x3c00,0x2ce73bfa,0x30e43be8,0x334c3bca,0x3c00,0x2d4c3bf9,0x31473be4,0x33df3bc1
.long 0x3c00,0x2db03bf8,0x31aa3be0,0x34383bb7,0x3c00,0x2e143bf7,0x320d3bdb,0x34813bad
.long 0x3c00,0x2e783bf6,0x326f3bd6,0x34c93ba2,0x3c00,0x2edc3bf4,0x32d23bd1,0x35113b97
.long 0x3c00,0x2f403bf3,0x33343bcb,0x35583b8a,0x3c00,0x2fa43bf1,0x33963bc6,0x359f3b7d
.long 0x3c00,0x30043bf0,0x33f73bc0,0x35e53b70,0x3c00,0x30363bee,0x342c3bb9,0x362b3b62
.long 0x3c00,0x30673bed,0x345d3bb2,0x36703b53,0x3c00,0x30993beb,0x348d3bab,0x36b53b43
.long 0x3c00,0x30cb3be9,0x34bd3ba4,0x36f93b33,0x3c00,0x30fd3be7,0x34ed3b9d,0x373d3b22
.long 0x3c00,0x312e3be5,0x351d3b95,0x37803b11,0x3c00,0x31603be3,0x354c3b8c,0x37c23aff
.long 0x3c00,0x31913be1,0x357c3b84,0x38023aed,0x3c00,0x31c33bdf,0x35ab3b7b,0x38223ad9
.long 0x3c00,0x31f43bdc,0x35da3b72,0x38423ac6,0x3c00,0x32263bda,0x36083b69,0x38623ab1
.long 0x22483c00,0x23db3c00,0x24b63c00,0x257f3c00,0x28b63bff,0x29e33bfe,0x2b113bfd,0x2c1f3bfc
.long 0x2bd93bfc,0x2ce73bfa,0x2de23bf7,0x2edc3bf4,0x2d7e3bf8,0x2edc3bf4,0x301d3bef,0x30cb3be9
.long 0x2f0e3bf4,0x30673bed,0x31473be4,0x32263bda,0x304e3bed,0x31603be3,0x326f3bd6,0x337d3bc7
.long 0x31153be6,0x32573bd7,0x33963bc6,0x34693bb1,0x31db3bdd,0x334c3bca,0x345d3bb2,0x35113b97
.long 0x32a13bd4,0x34203bbb,0x34ed3b9d,0x35b63b79,0x33653bc9,0x34993baa,0x357c3b84,0x36593b58
.long 0x34143bbc,0x35113b97,0x36083b69,0x36f93b33,0x34753baf,0x35873b82,0x36933b4b,0x37963b0b
.long 0x34d53ba0,0x35fd3b6b,0x371b3b2b,0x38173ae0,0x35343b91,0x36703b53,0x37a13b08,0x38623ab1
.long 0x35933b80,0x36e33b39,0x38123ae3,0x38ab3a7f,0x35f13b6e,0x37533b1d,0x38523abc,0x38f13a4b
.long 0x364e3b5a,0x37c23aff,0x38913a92,0x39353a13,0x36aa3b46,0x38173ae0,0x38ce3a65,0x397639d8
.long 0x37053b30,0x384d3abf,0x39093a37,0x39b5399b,0x375e3b1a,0x38813a9c,0x39433a07,0x39f2395b
.long 0x37b73b02,0x38b53a78,0x397b39d4,0x3a2b3918,0x38073ae9,0x38e73a52,0x39b1399f,0x3a6238d3
.long 0x38323ad0,0x39183a2b,0x39e53969,0x3a95388c,0x385d3ab5,0x39483a02,0x3a173930,0x3ac63842
.long 0x38873a99,0x397639d8,0x3a4738f6,0x3af337ee,0x38b03a7c,0x39a439ad,0x3a7438ba,0x3b1d3753
.long 0x38d83a5e,0x39d03980,0x3aa0387c,0x3b4336b5,0x39003a3f,0x39fa3951,0x3ac9383d,0x3b673614
.long 0x39273a1f,0x3a233922,0x3af037f9,0x3b863570,0x394d39fe,0x3a4b38f1,0x3b143775,0x3ba234c9
.long 0x397239dc,0x3a7138bf,0x3b3636ee,0x3bbb3420,0x399639ba,0x3a95388c,0x3b553665,0x3bd032ea
.long 0x26483bff,0x27113bff,0x27da3bff,0x28523bff,0x2cb53bfa,0x2d4c3bf9,0x2de23bf7,0x2e783bf6
.long 0x2fd63bf1,0x30673bed,0x30e43be8,0x31603be3,0x31793be2,0x32263bda,0x32d23bd1,0x337d3bc7
.long 0x33033bce,0x33df3bc1,0x345d3bb2,0x34c93ba2,0x34443bb6,0x34c93ba2,0x354c3b8c,0x35ce3b74
.long 0x35053b99,0x359f3b7d,0x36373b5f,0x36cc3b3e,0x35c23b77,0x36703b53,0x371b3b2b,0x37c23aff
.long 0x367c3b50,0x373d3b22,0x37f93af0,0x38583ab8,0x37323b25,0x38023aed,0x38673aae,0x38c93a69
.long 0x37e33af6,0x38623ab1,0x38ce3a65,0x39353a13,0x38483ac2,0x38bf3a71,0x39303a17,0x399b39b5
.long 0x389b3a8a,0x39183a2b,0x398d39c3,0x39fa3951,0x38ec3a4f,0x396d39e1,0x39e53969,0x3a5238e7
.long 0x393a3a0f,0x39be3992,0x3a373909,0x3aa33877,0x398439cb,0x3a0b393e,0x3a8338a6,0x3aed3802
.long 0x39cb3984,0x3a5238e7,0x3ac9383d,0x3b2e3710,0x3a0f393a,0x3a95388c,0x3b0837a1,0x3b673614
.long 0x3a4f38ec,0x3ad3382d,0x3b4136c1,0x3b973511,0x3a8a389b,0x3b0b3796,0x3b7235da,0x3bbe3408
.long 0x3ac23848,0x3b3e36cc,0x3b9d34ed,0x3bdc31f4,0x3af637e3,0x3b6b35fd,0x3bc033f7,0x3bf12fa4
.long 0x3b253732,0x3b933529,0x3bdb320d,0x3bfd2aac,0x3b50367c,0x3bb43451,0x3bef301d,0x3c00a3db
.long 0x3b7735c2,0x3bd032ea,0x3bfb2c51,0x3bf9ad4c,0x3b993505,0x3be5312e,0x3c001e48,0x3be9b0cb
.long 0x3bb63444,0x3bf42edc,0x3bfdab11,0x3bd0b2ea,0x3bce3303,0x3bfd2aac,0x3bf2af72,0x3badb481
.long 0x3be23179,0x3c009a48,0x3be0b1aa,0x3b82b587,0x3bf12fd6,0x3bfdab75,0x3bc6b396,0x3b4eb687
.long 0x3bfa2cb5,0x3bf3af40,0x3ba4b4bd,0x3b11b780,0x3bff2648,0x3be3b160,0x3b7bb5ab,0x3accb838
.long 0x28b63bff,0x291b3bfe,0x297f3bfe,0x29e33bfe,0x2f0e3bf4,0x2fa43bf1,0x301d3bef,0x30673bed
.long 0x31db3bdd,0x32573bd7,0x32d23bd1,0x334c3bca,0x34143bbc,0x34693bb1,0x34bd3ba4,0x35113b97
.long 0x35343b91,0x359f3b7d,0x36083b69,0x36703b53,0x364e3b5a,0x36cc3b3e,0x37483b20,0x37c23aff
.long 0x375e3b1a,0x37ee3af3,0x383d3ac9,0x38813a9c,0x38323ad0,0x38813a9c,0x38ce3a65,0x39183a2b
.long 0x38b03a7c,0x39053a3b,0x395639f6,0x39a439ad,0x39273a1f,0x398039d0,0x39d4397b,0x3a233922
.long 0x399639ba,0x39f2395b,0x3a4738f6,0x3a95388c,0x39fe394d,0x3a5a38dd,0x3aae3867,0x3af937d8
.long 0x3a5e38d8,0x3ab83858,0x3b0837a1,0x3b4e3687,0x3ab5385d,0x3b0b3796,0x3b553665,0x3b933529
.long 0x3b0237b7,0x3b533670,0x3b95351d,0x3bc7337d,0x3b4636aa,0x3b8f3540,0x3bc63396,0x3beb3099
.long 0x3b803593,0x3bbe3408,0x3be830e4,0x3bfd2aac,0x3baf3475,0x3be13191,0x3bfb2c51,0x3bfea91b
.long 0x3bd432a1,0x3bf72e14,0x3c00a4b6,0x3beeb036,0x3bed304e,0x3c0023db,0x3bf5aeaa,0x3bcdb31b
.long 0x3bfc2bd9,0x3bfcac1f,0x3bdbb20d,0x3b9bb4f9,0x3c00a248,0x3bebb099,0x3bb2b45d,0x3b58b659
.long 0x3bf8ad7e,0x3bcdb31b,0x3b7bb5ab,0x3b05b7ac,0x3be6b115,0x3ba2b4c9,0x3b36b6ee,0x3aa3b877
.long 0x3bc9b365,0x3b6bb5fd,0x3ae3b812,0x3a33b90e,0x3ba0b4d5,0x3b28b726,0x3a83b8a6,0x39b5b99b
.long 0x3b6eb5f1,0x3ad9b822,0x3a17b930,0x392bba1b,0x3b30b705,0x3a7fb8ab,0x399fb9b1,0x3896ba8e
.long 0x3ae9b807,0x3a1bb92b,0x391dba27,0x37eebaf3,0x3a99b887,0x39adb9a4,0x3891ba92,0x369ebb49
.long 0x3a3fb900,0x3935ba13,0x37f9baf0,0x3540bb8f,0x39dcb972,0x38b5ba78,0x36c1bb41,0x33aebbc4
.long 0x2a483bfe,0x2aac3bfd,0x2b113bfd,0x2b753bfd,0x30b23bea,0x30fd3be7,0x31473be4,0x31913be1
.long 0x33c63bc3,0x34203bbb,0x345d3bb2,0x34993baa,0x35643b88,0x35b63b79,0x36083b69,0x36593b58
.long 0x36d73b3b,0x373d3b22,0x37a13b08,0x38023aed,0x381d3add,0x38583ab8,0x38913a92,0x38c93a69
.long 0x38c43a6d,0x39053a3b,0x39433a07,0x398039d0,0x395f39ed,0x39a439ad,0x39e53969,0x3a233922
.long 0x39ed395f,0x3a33390e,0x3a7438ba,0x3ab13862,0x3a6d38c4,0x3ab13862,0x3af037f9,0x3b283726
.long 0x3add381d,0x3b1d3753,0x3b553665,0x3b863570,0x3b3b36d7,0x3b7435ce,0x3ba434bd,0x3bca334c
.long 0x3b883564,0x3bb73438,0x3bdb320d,0x3bf32f40,0x3bc333c6,0x3be5312e,0x3bf92d1a,0x3c009a48
.long 0x3bea30b2,0x3bfd2b75,0x3bffa7da,0x3bf1afa4,0x3bfe2a48,0x3bfea9e3,0x3becb080,0x3bc7b37d
.long 0x3bfeaa48,0x3be9b0cb,0x3bc0b3f7,0x3b82b587,0x3beab0b2,0x3bbeb408,0x3b7bb5ab,0x3b22b73d
.long 0x3bc3b3c6,0x3b7db59f,0x3b20b748,0x3aaab86d,0x3b88b564,0x3b28b726,0x3aaeb867,0x3a1bb92b
.long 0x3b3bb6d7,0x3abfb84d,0x3a27b91d,0x3976b9d8,0x3addb81d,0x3a43b8fb,0x398db9c3,0x38bfba71
.long 0x3a6db8c4,0x39b5b99b,0x38e2ba56,0x37eebaf3,0x39edb95f,0x3918ba2b,0x3828bad6,0x3642bb5d
.long 0x395fb9ed,0x386dbaaa,0x36c1bb41,0x3481bbad,0x38c4ba6d,0x376abb17,0x351dbb95,0x3160bbe3
.long 0x381dbadd,0x35e5bb70,0x32d2bbd1,0x2aacbbfd,0x36d7bb3b,0x3451bbb4,0x2eaabbf5,0xac1fbbfc
.long 0x3564bb88,0x3160bbe3,0x9e48bc00,0xb1c3bbdf,0x33c6bbc3,0x2c1fbbfc,0xaf72bbf2,0xb4b1bba6
.long 0x30b2bbea,0xa91bbbfe,0xb334bbcb,0xb670bb53,0x2a48bbfe,0xb099bbeb,0xb54cbb8c,0xb80dbae6
.long 0x2bd93bfc,0x2c1f3bfc,0x2c513bfb,0x2c833bfb,0x31db3bdd,0x32263bda,0x326f3bd6,0x32b93bd2
.long 0x34d53ba0,0x35113b97,0x354c3b8c,0x35873b82,0x36aa3b46,0x36f93b33,0x37483b20,0x37963b0b
.long 0x38323ad0,0x38623ab1,0x38913a92,0x38bf3a71,0x39003a3f,0x39353a13,0x396939e5,0x399b39b5
.long 0x39ba3996,0x39f2395b,0x3a27391d,0x3a5a38dd,0x3a5e38d8,0x3a95388c,0x3ac9383d,0x3af937d8
.long 0x3ae93807,0x3b1d3753,0x3b4b3693,0x3b7435ce,0x3b5a364e,0x3b863570,0x3bab348d,0x3bca334c
.long 0x3baf3475,0x3bd032ea,0x3be830e4,0x3bf82db0,0x3be63115,0x3bf82db0,0x3c0024b6,0x3bfdaaac
.long 0x3bff28b6,0x3bfea91b,0x3bf2af72,0x3bdab226,0x3bf8ad7e,0x3be3b160,0x3bc0b3f7,0x3b8fb540
.long 0x3bd4b2a1,0x3ba6b4b1,0x3b69b608,0x3b1db753,0x3b91b534,0x3b49b69e,0x3af0b7f9,0x3a87b8a0
.long 0x3b30b705,0x3accb838,0x3a56b8e2,0x39d0b980,0x3ab5b85d,0x3a33b90e,0x399fb9b1,0x38fbba43
.long 0x3a1fb927,0x3980b9d0,0x38ceba65,0x380dbae6,0x3972b9dc,0x38b5ba78,0x37cdbafc,0x3614bb67
.long 0x38b0ba7c,0x37acbb05,0x35dabb72,0x33dfbbc1,0x37b7bb02,0x35cebb74,0x3396bbc6,0x2edcbbf4
.long 0x35f1bb6e,0x33aebbc4,0x2eaabbf5,0xa852bbff,0x3414bbbc,0x2f40bbf3,0xa7dabbff,0xb191bbe1
.long 0x304ebbed,0xa3dbbc00,0xb147bbe4,0xb4f9bb9b,0x2248bc00,0xb099bbeb,0xb4bdbba4,0xb710bb2e
.long 0xaf0ebbf4,0xb451bbb4,0xb6c1bb41,0xb881ba9c,0xb365bbc9,0xb642bb5d,0xb852babc,0xb964b9e9
.long 0xb593bb80,0xb80dbae6,0xb930ba17,0xba2bb918,0xb75ebb1a,0xb8e7ba52,0xb9f6b956,0xbad3b82d
.long 0xb887ba99,0xb9adb9a4,0xbaa0b87c,0xbb58b659,0xb94db9fe,0xba5ab8dd,0xbb2bb71b,0xbbb7b438
.long 0x2cb53bfa,0x2ce73bfa,0x2d1a3bf9,0x2d4c3bf9,0x33033bce,0x334c3bca,0x33963bc6,0x33df3bc1
.long 0x35c23b77,0x35fd3b6b,0x36373b5f,0x36703b53,0x37e33af6,0x38173ae0,0x383d3ac9,0x38623ab1
.long 0x38ec3a4f,0x39183a2b,0x39433a07,0x396d39e1,0x39cb3984,0x39fa3951,0x3a27391d,0x3a5238e7
.long 0x3a8a389b,0x3ab83858,0x3ae33812,0x3b0b3796,0x3b253732,0x3b4e3687,0x3b7235da,0x3b933529
.long 0x3b993505,0x3bb73438,0x3bd132d2,0x3be5312e,0x3be23179,0x3bf32f40,0x3bfd2b11,0x3c009a48
.long 0x3bff2648,0x3bfea91b,0x3bf5aeaa,0x3be3b160,0x3bf1afd6,0x3bdab226,0x3bb9b42c,0x3b8fb540
.long 0x3bb6b444,0x3b86b570,0x3b4bb693,0x3b05b7ac,0x3b50b67c,0x3b05b7ac,0x3aaeb867,0x3a4bb8f1
.long 0x3ac2b848,0x3a5ab8dd,0x39e5b969,0x3964b9e9,0x3a0fb93a,0x3989b9c7,0x38f6ba47,0x3858bab8
.long 0x393aba0f,0x3896ba8e,0x37cdbafc,0x3659bb58,0x3848bac2,0x3710bb2e,0x357cbb84,0x33aebbc4
.long 0x367cbb50,0x34c9bba2,0x320dbbdb,0x2ce7bbfa,0x3444bbb6,0x30cbbbe9,0x27dabbff,0xadb0bbf8
.long 0x2fd6bbf1,0x9a48bc00,0xb01dbbef,0xb408bbbe,0xa648bbff,0xb0fdbbe7,0xb48dbbab,0xb687bb4e
.long 0xb179bbe2,0xb4e1bb9e,0xb6eebb36,0xb86dbaaa,0xb505bb99,0xb726bb28,0xb891ba92,0xb976b9d8
.long 0xb732bb25,0xb8a0ba87,0xb98db9c3,0xba5ab8dd,0xb89bba8a,0xb992b9be,0xba65b8ce,0xbb11b780
.long 0xb984b9cb,0xba62b8d3,0xbb14b775,0xbb97b511,0xba4fb8ec,0xbb0bb796,0xbb95b51d,0xbbe7b0fd
.long 0xbaf6b7e3,0xbb8ab558,0xbbe4b147,0xbc0020b6,0xbb77b5c2,0xbbdcb1f4,0xbc009e48,0xbbe13191
.long 0xbbceb303,0xbbffa852,0xbbe830e4,0xbb8a3558,0xbbfaacb5,0xbbf12fa4,0xbb9d34ed,0xbaff37c2
.long 0x2d7e3bf8,0x2db03bf8,0x2de23bf7,0x2e143bf7,0x34143bbc,0x34383bb7,0x345d3bb2,0x34813bad
.long 0x36aa3b46,0x36e33b39,0x371b3b2b,0x37533b1d,0x38873a99,0x38ab3a7f,0x38ce3a65,0x38f13a4b
.long 0x399639ba,0x39be3992,0x39e53969,0x3a0b393e,0x3a7c38b0,0x3aa33877,0x3ac9383d,0x3aed3802
.long 0x3b303705,0x3b533670,0x3b7235da,0x3b8f3540,0x3baf3475,0x3bc7337d,0x3bdb320d,0x3beb3099
.long 0x3bf42f0e,0x3bfd2b75,0x3c001e48,0x3bfea9e3,0x3bfcabd9,0x3bf1afa4,0x3be0b1aa,0x3bc7b37d
.long 0x3bc9b365,0x3ba6b4b1,0x3b7bb5ab,0x3b49b69e,0x3b5ab64e,0x3b1db753,0x3ad6b828,0x3a87b8a0
.long 0x3ab5b85d,0x3a5ab8dd,0x39f6b956,0x3989b9c7,0x39dcb972,0x3964b9e9,0x38e2ba56,0x3858bab8
.long 0x38d8ba5e,0x3842bac6,0x3748bb20,0x35fdbb6b,0x375ebb1a,0x35fdbb6b,0x348dbbab,0x3226bbda
.long 0x34d5bba0,0x3288bbd5,0x2eaabbf5,0x1a48bc00,0x304ebbed,0x2711bbff,0xad1abbf9,0xb1f4bbdc
.long 0xa8b6bbff,0xb0cbbbe9,0xb42cbbb9,0xb5e5bb70,0xb2a1bbd4,0xb529bb93,0xb6eebb36,0xb84dbabf
.long 0xb5f1bb6e,0xb7c2baff,0xb8baba74,0xb980b9d0,0xb832bad0,0xb90eba33,0xb9d4b97b,0xba7fb8ab
.long 0xb94db9fe,0xba13b935,0xbabcb852,0xbb43b6b5,0xba3fb900,0xbae6b80d,0xbb69b608,0xbbc4b3ae
.long 0xbb02b7b7,0xbb82b587,0xbbd6b26f,0xbbfdaaac,0xbb91b534,0xbbe1b191,0xbc00a4b6,0xbbed3067
.long 0xbbe6b115,0xbc001a48,0xbbe43147,0xbb933529,0xbc002248,0xbbdf31c3,0xbb84357c,0xbaf337ee
.long 0xbbdd31db,0xbb7d359f,0xbae33812,0xba133935,0xbb803593,0xbae03817,0xba073943,0xb8fb3a43
.long 0xbae93807,0xba0b393e,0xb8f63a47,0xb76a3b17,0xba1f3927,0xb9053a3b,0xb7753b14,0xb4993baa
.p2align 8
T_P3:
.long 0x35cd35cd,0x35cd35cd,0x35cd35cd,0x35cd35cd,0x35c335cd,0x357135a6,0x1ae234fd,0xb571b4fd
.long 0x35a635cd,0xb4fd34fd,0xb5cdb5a6,0xb4fdb5a6,0x357135cd,0xb5c3b4fd,0x9ba9b5a6,0x35c335a6
.long 0x34fd35cd,0xb5a6b5a6,0x35cd34fd,0xb5a634fd,0x1ae235cd,0x9ba9b5cd,0x1c0d35cd,0x9c46b5cd
.long 0xb4fd35cd,0x35a6b5a6,0xb5cd34fd,0x35a634fd,0xb57135cd,0x35c3b4fd,0x9c46b5a6,0xb5c335a6
.long 0xb5a635cd,0x34fd34fd,0x35cdb5a6,0x34fdb5a6,0xb5c335cd,0xb57135a6,0x1c7e34fd,0x3571b4fd
.long 0xb5cd35cd,0xb5cd35cd,0xb5cd35cd,0xb5cd35cd,0xb5c335cd,0xb57135a6,0x9d8d34fd,0x3571b4fd
.long 0xb5a635cd,0x34fd34fd,0x35cdb5a6,0x34fdb5a6,0xb57135cd,0x35c3b4fd,0x9ce2b5a6,0xb5c335a6
.long 0xb4fd35cd,0x35a6b5a6,0xb5cd34fd,0x35a634fd,0x9ba935cd,0x1d86b5cd,0x9d9b35cd,0x1e3fb5cd
.long 0x34fd35cd,0xb5a6b5a6,0x35cd34fd,0xb5a634fd,0x357135cd,0xb5c3b4fd,0x9caab5a6,0x35c335a6
.long 0x35a635cd,0xb4fd34fd,0xb5cdb5a6,0xb4fdb5a6,0x35c335cd,0x357135a6,0x1c8d34fd,0xb571b4fd
.long 0x0,0x0,0x0,0x0,0x0,0x0,0x0,0x0
.long 0x0,0x0,0x0,0x0,0x0,0x0,0x0,0x0
.long 0x0,0x0,0x0,0x0,0x0,0x0,0x0,0x0
.long 0x0,0x0,0x0,0x0,0x0,0x0,0x0,0x0
.long 0x0,0x0,0x0,0x0,0x0,0x0,0x0,0x0
.long 0x0,0x0,0x0,0x0,0x0,0x0,0x0,0x0
.long 0x80008000,0x80008000,0x80008000,0x80008000,0xb4fd8000,0xb5a6b571,0xb5cdb5c3,0xb5a6b5c3
.long 0xb5718000,0xb5c3b5c3,0x9b62b571,0x35c33571,0xb5a68000,0xb4fdb5c3,0x35cd3571,0xb4fd3571
.long 0xb5c38000,0x3571b571,0x1be235c3,0xb571b5c3,0xb5cd8000,0x35cd9b62,0xb5cd1be2,0x35cd9c29
.long 0xb5c38000,0x35713571,0x9c29b5c3,0xb57135c3,0xb5a68000,0xb4fd35c3,0x35cdb571,0xb4fdb571
.long 0xb5718000,0xb5c335c3,0x1c623571,0x35c3b571,0xb4fd8000,0xb5a63571,0xb5cd35c3,0xb5a635c3
.long 0x9b628000,0x9c291be2,0x9c8d1c62,0x9cc61ca9,0x34fd8000,0x35a6b571,0x35cdb5c3,0x35a6b5c3
.long 0x35718000,0x35c3b5c3,0x1ca9b571,0xb5c33571,0x35a68000,0x34fdb5c3,0xb5cd3571,0x34fd3571
.long 0x35c38000,0xb571b571,0x9cc635c3,0x3571b5c3,0x35cd8000,0xb5cd9c29,0x35cd1ca9,0xb5cd9e06
.long 0x35c38000,0xb5713571,0x1ce2b5c3,0x357135c3,0x35a68000,0x34fd35c3,0xb5cdb571,0x34fdb571
.long 0x35718000,0x35c335c3,0x9cfe3571,0xb5c3b571,0x34fd8000,0x35a63571,0x35cd35c3,0x35a635c3
.long 0x0,0x0,0x0,0x0,0x0,0x0,0x0,0x0
.long 0x0,0x0,0x0,0x0,0x0,0x0,0x0,0x0
.long 0x0,0x0,0x0,0x0,0x0,0x0,0x0,0x0
.long 0x0,0x0,0x0,0x0,0x0,0x0,0x0,0x0
.long 0x0,0x0,0x0,0x0,0x0,0x0,0x0,0x0
.long 0x0,0x0,0x0,0x0,0x0,0x0,0x0,0x0
.long 0x35cd35cd,0x35cd,0x0,0x0,0xb5c3b5a6,0xb5cd,0x0,0x0
.long 0x35a634fd,0x35cd,0x0,0x0,0xb57134fd,0xb5cd,0x0,0x0
.long 0x34fdb5a6,0x35cd,0x0,0x0,0x1c7e35cd,0xb5cd,0x0,0x0
.long 0xb4fdb5a6,0x35cd,0x0,0x0,0x357134fd,0xb5cd,0x0,0x0
.long 0xb5a634fd,0x35cd,0x0,0x0,0x35c3b5a6,0xb5cd,0x0,0x0
.long 0xb5cd35cd,0x35cd,0x0,0x0,0x35c3b5a6,0xb5cd,0x0,0x0
.long 0xb5a634fd,0x35cd,0x0,0x0,0x357134fd,0xb5cd,0x0,0x0
.long 0xb4fdb5a6,0x35cd,0x0,0x0,0x9dc635cd,0xb5cd,0x0,0x0
.long 0x34fdb5a6,0x35cd,0x0,0x0,0xb57134fd,0xb5cd,0x0,0x0
.long 0x35a634fd,0x35cd,0x0,0x0,0xb5c3b5a6,0xb5cd,0x0,0x0
.long 0x0,0x0,0x0,0x0,0x0,0x0,0x0,0x0
.long 0x0,0x0,0x0,0x0,0x0,0x0,0x0,0x0
.long 0x0,0x0,0x0,0x0,0x0,0x0,0x0,0x0
.long 0x0,0x0,0x0,0x0,0x0,0x0,0x0,0x0
.long 0x0,0x0,0x0,0x0,0x0,0x0,0x0,0x0
.long 0x0,0x0,0x0,0x0,0x0,0x0,0x0,0x0
.long 0x80008000,0x8000,0x0,0x0,0xb4fdb571,0x9b62,0x0,0x0
.long 0x357135c3,0x1be2,0x0,0x0,0xb5a6b5c3,0x9c29,0x0,0x0
.long 0x35c33571,0x1c62,0x0,0x0,0xb5cd1c62,0x9c8d,0x0,0x0
.long 0x35c3b571,0x1ca9,0x0,0x0,0xb5a635c3,0x9cc6,0x0,0x0
.long 0x3571b5c3,0x1ce2,0x0,0x0,0xb4fd3571,0x9cfe,0x0,0x0
.long 0x9cfe1ce2,0x1d0d,0x0,0x0,0x34fdb571,0x9e0d,0x0,0x0
.long 0xb57135c3,0x1d29,0x0,0x0,0x35a6b5c3,0x1d62,0x0,0x0
.long 0xb5c33571,0x1d46,0x0,0x0,0x35cd1d29,0x9e1b,0x0,0x0
.long 0xb5c3b571,0x1d62,0x0,0x0,0x35a635c3,0x1d2a,0x0,0x0
.long 0xb571b5c3,0x1d7e,0x0,0x0,0x34fd3571,0x1d0d,0x0,0x0
.long 0x0,0x0,0x0,0x0,0x0,0x0,0x0,0x0
.long 0x0,0x0,0x0,0x0,0x0,0x0,0x0,0x0
.long 0x0,0x0,0x0,0x0,0x0,0x0,0x0,0x0
.long 0x0,0x0,0x0,0x0,0x0,0x0,0x0,0x0
.long 0x0,0x0,0x0,0x0,0x0,0x0,0x0,0x0
.long 0x0,0x0,0x0,0x0,0x0,0x0,0x0,0x0
.long 0x0,0x0,0x0,0x0,0x34fd0000,0x35a63571,0x35cd35c3,0x35a635c3
.long 0x35710000,0x35c335c3,0x1b623571,0xb5c3b571,0x35a60000,0x34fd35c3,0xb5cdb571,0x34fdb571
.long 0x35c30000,0xb5713571,0x9be2b5c3,0x357135c3,0x35cd0000,0xb5cd1b62,0x35cd9be2,0xb5cd1c29
.long 0x35c30000,0xb571b571,0x1c2935c3,0x3571b5c3,0x35a60000,0x34fdb5c3,0xb5cd3571,0x34fd3571
.long 0x35710000,0x35c3b5c3,0x9c62b571,0xb5c33571,0x34fd0000,0x35a6b571,0x35cdb5c3,0x35a6b5c3
.long 0x1b620000,0x1c299be2,0x1c8d9c62,0x1cc69ca9,0xb4fd0000,0xb5a63571,0xb5cd35c3,0xb5a635c3
.long 0xb5710000,0xb5c335c3,0x9ca93571,0x35c3b571,0xb5a60000,0xb4fd35c3,0x35cdb571,0xb4fdb571
.long 0xb5c30000,0x35713571,0x1cc6b5c3,0xb57135c3,0xb5cd0000,0x35cd1c29,0xb5cd9ca9,0x35cd1e06
.long 0xb5c30000,0x3571b571,0x9ce235c3,0xb571b5c3,0xb5a60000,0xb4fdb5c3,0x35cd3571,0xb4fd3571
.long 0xb5710000,0xb5c3b5c3,0x1cfeb571,0x35c33571,0xb4fd0000,0xb5a6b571,0xb5cdb5c3,0xb5a6b5c3
.long 0x0,0x0,0x0,0x0,0x0,0x0,0x0,0x0
.long 0x0,0x0,0x0,0x0,0x0,0x0,0x0,0x0
.long 0x0,0x0,0x0,0x0,0x0,0x0,0x0,0x0
.long 0x0,0x0,0x0,0x0,0x0,0x0,0x0,0x0
.long 0x0,0x0,0x0,0x0,0x0,0x0,0x0,0x0
.long 0x0,0x0,0x0,0x0,0x0,0x0,0x0,0x0
.long 0x35cd35cd,0x35cd35cd,0x35cd35cd,0x35cd35cd,0x35c335cd,0x357135a6,0x1ae234fd,0xb571b4fd
.long 0x35a635cd,0xb4fd34fd,0xb5cdb5a6,0xb4fdb5a6,0x357135cd,0xb5c3b4fd,0x9ba9b5a6,0x35c335a6
.long 0x34fd35cd,0xb5a6b5a6,0x35cd34fd,0xb5a634fd,0x1ae235cd,0x9ba9b5cd,0x1c0d35cd,0x9c46b5cd
.long 0xb4fd35cd,0x35a6b5a6,0xb5cd34fd,0x35a634fd,0xb57135cd,0x35c3b4fd,0x9c46b5a6,0xb5c335a6
.long 0xb5a635cd,0x34fd34fd,0x35cdb5a6,0x34fdb5a6,0xb5c335cd,0xb57135a6,0x1c7e34fd,0x3571b4fd
.long 0xb5cd35cd,0xb5cd35cd,0xb5cd35cd,0xb5cd35cd,0xb5c335cd,0xb57135a6,0x9d8d34fd,0x3571b4fd
.long 0xb5a635cd,0x34fd34fd,0x35cdb5a6,0x34fdb5a6,0xb57135cd,0x35c3b4fd,0x9ce2b5a6,0xb5c335a6
.long 0xb4fd35cd,0x35a6b5a6,0xb5cd34fd,0x35a634fd,0x9ba935cd,0x1d86b5cd,0x9d9b35cd,0x1e3fb5cd
.long 0x34fd35cd,0xb5a6b5a6,0x35cd34fd,0xb5a634fd,0x357135cd,0xb5c3b4fd,0x9caab5a6,0x35c335a6
.long 0x35a635cd,0xb4fd34fd,0xb5cdb5a6,0xb4fdb5a6,0x35c335cd,0x357135a6,0x1c8d34fd,0xb571b4fd
.long 0x0,0x0,0x0,0x0,0x0,0x0,0x0,0x0
.long 0x0,0x0,0x0,0x0,0x0,0x0,0x0,0x0
.long 0x0,0x0,0x0,0x0,0x0,0x0,0x0,0x0
.long 0x0,0x0,0x0,0x0,0x0,0x0,0x0,0x0
.long 0x0,0x0,0x0,0x0,0x0,0x0,0x0,0x0
.long 0x0,0x0,0x0,0x0,0x0,0x0,0x0,0x0
.long 0x0,0x0,0x0,0x0,0x34fd3571,0x1b62,0x0,0x0
.long 0xb571b5c3,0x9be2,0x0,0x0,0x35a635c3,0x1c29,0x0,0x0
.long 0xb5c3b571,0x9c62,0x0,0x0,0x35cd9c62,0x1c8d,0x0,0x0
.long 0xb5c33571,0x9ca9,0x0,0x0,0x35a6b5c3,0x1cc6,0x0,0x0
.long 0xb57135c3,0x9ce2,0x0,0x0,0x34fdb571,0x1cfe,0x0,0x0
.long 0x1cfe9ce2,0x9d0d,0x0,0x0,0xb4fd3571,0x1e0d,0x0,0x0
.long 0x3571b5c3,0x9d29,0x0,0x0,0xb5a635c3,0x9d62,0x0,0x0
.long 0x35c3b571,0x9d46,0x0,0x0,0xb5cd9d29,0x1e1b,0x0,0x0
.long 0x35c33571,0x9d62,0x0,0x0,0xb5a6b5c3,0x9d2a,0x0,0x0
.long 0x357135c3,0x9d7e,0x0,0x0,0xb4fdb571,0x9d0d,0x0,0x0
.long 0x0,0x0,0x0,0x0,0x0,0x0,0x0,0x0
.long 0x0,0x0,0x0,0x0,0x0,0x0,0x0,0x0
.long 0x0,0x0,0x0,0x0,0x0,0x0,0x0,0x0
.long 0x0,0x0,0x0,0x0,0x0,0x0,0x0,0x0
.long 0x0,0x0,0x0,0x0,0x0,0x0,0x0,0x0
.long 0x0,0x0,0x0,0x0,0x0,0x0,0x0,0x0
.long 0x35cd35cd,0x35cd,0x0,0x0,0xb5c3b5a6,0xb5cd,0x0,0x0
.long 0x35a634fd,0x35cd,0x0,0x0,0xb57134fd,0xb5cd,0x0,0x0
.long 0x34fdb5a6,0x35cd,0x0,0x0,0x1c7e35cd,0xb5cd,0x0,0x0
.long 0xb4fdb5a6,0x35cd,0x0,0x0,0x357134fd,0xb5cd,0x0,0x0
.long 0xb5a634fd,0x35cd,0x0,0x0,0x35c3b5a6,0xb5cd,0x0,0x0
.long 0xb5cd35cd,0x35cd,0x0,0x0,0x35c3b5a6,0xb5cd,0x0,0x0
.long 0xb5a634fd,0x35cd,0x0,0x0,0x357134fd,0xb5cd,0x0,0x0
.long 0xb4fdb5a6,0x35cd,0x0,0x0,0x9dc635cd,0xb5cd,0x0,0x0
.long 0x34fdb5a6,0x35cd,0x0,0x0,0xb57134fd,0xb5cd,0x0,0x0
.long 0x35a634fd,0x35cd,0x0,0x0,0xb5c3b5a6,0xb5cd,0x0,0x0
.long 0x0,0x0,0x0,0x0,0x0,0x0,0x0,0x0
.long 0x0,0x0,0x0,0x0,0x0,0x0,0x0,0x0
.long 0x0,0x0,0x0,0x0,0x0,0x0,0x0,0x0
.long 0x0,0x0,0x0,0x0,0x0,0x0,0x0,0x0
.long 0x0,0x0,0x0,0x0,0x0,0x0,0x0,0x0
.long 0x0,0x0,0x0,0x0,0x0,0x0,0x0,0x0
.long 0x3f800000,0x3f800000,0x3f800000,0x3f800000,0x3f800000,0x3f7ffcd7,0x3f7ff35e,0x3f7fe394
.long 0x3f800000,0x3f7ff35e,0x3f7fcd79,0x3f7f8e56,0x3f800000,0x3f7fe394,0x3f7f8e56,0x3f7f0059
.long 0x3f800000,0x3f7fcd79,0x3f7f35f9,0x3f7e39bc,0x3f800000,0x3f7fb10f,0x3f7ec46d,0x3f7d3aac
.long 0x3f800000,0x3f7f8e56,0x3f7e39bc,0x3f7c0361,0x3f800000,0x3f7f654e,0x3f7d95f4,0x3f7a9421
.long 0x3f800000,0x3f7f35f9,0x3f7cd925,0x3f78ed3c,0x3f800000,0x3f7f0059,0x3f7c0361,0x3f770f11
.long 0x3f800000,0x3f7ec46d,0x3f7b14be,0x3f74fa0b,0x3f800000,0x3f7e8238,0x3f7a0d54,0x3f72ae9e
.long 0x3f800000,0x3f7e39bc,0x3f78ed3c,0x3f702d4f,0x3f800000,0x3f7deafa,0x3f77b493,0x3f6d76aa
.long 0x3f800000,0x3f7d95f4,0x3f766377,0x3f6a8b4b,0x3f800000,0x3f7d3aac,0x3f74fa0b,0x3f676bd8
.long 0x3f800000,0x3f7cd925,0x3f737871,0x3f641901,0x3f800000,0x3f7c7160,0x3f71decf,0x3f609384
.long 0x3f800000,0x3f7c0361,0x3f702d4f,0x3f5cdc29,0x3f800000,0x3f7b8f2a,0x3f6e641a,0x3f58f3c4
.long 0x3f800000,0x3f7b14be,0x3f6c835e,0x3f54db31,0x3f800000,0x3f7a9421,0x3f6a8b4b,0x3f50935b
.long 0x3f800000,0x3f7a0d54,0x3f687c12,0x3f4c1d35,0x3f800000,0x3f79805c,0x3f6655e7,0x3f4779bc
.long 0x3f800000,0x3f78ed3c,0x3f641901,0x3f42a9f7,0x3f800000,0x3f7853f8,0x3f61c598,0x3f3daef9
.long 0x3f800000,0x3f77b493,0x3f5f5be6,0x3f3889dc,0x3f800000,0x3f770f11,0x3f5cdc29,0x3f333bc6
.long 0x3f800000,0x3f766377,0x3f5a46a0,0x3f2dc5e3,0x3f800000,0x3f75b1c9,0x3f579b8c,0x3f28296a
.long 0x3f800000,0x3f74fa0b,0x3f54db31,0x3f226799,0x3f800000,0x3f743c41,0x3f5205d4,0x3f1c81b9
.long 0x3f800000,0x3f800000,0x3f800000,0x3f800000,0x3f7fcd79,0x3f7fb10f,0x3f7f8e56,0x3f7f654e
.long 0x3f7f35f9,0x3f7ec46d,0x3f7e39bc,0x3f7d95f4,0x3f7e39bc,0x3f7d3aac,0x3f7c0361,0x3f7a9421
.long 0x3f7cd925,0x3f7b14be,0x3f78ed3c,0x3f766377,0x3f7b14be,0x3f7853f8,0x3f74fa0b,0x3f710908
.long 0x3f78ed3c,0x3f74fa0b,0x3f702d4f,0x3f6a8b4b,0x3f766377,0x3f710908,0x3f6a8b4b,0x3f62f219
.long 0x3f737871,0x3f6c835e,0x3f641901,0x3f5a46a0,0x3f702d4f,0x3f676bd8,0x3f5cdc29,0x3f50935b
.long 0x3f6c835e,0x3f61c598,0x3f54db31,0x3f45e403,0x3f687c12,0x3f5b941a,0x3f4c1d35,0x3f3a4582
.long 0x3f641901,0x3f54db31,0x3f42a9f7,0x3f2dc5e3,0x3f5f5be6,0x3f4d9f02,0x3f3889dc,0x3f207440
.long 0x3f5a46a0,0x3f45e403,0x3f2dc5e3,0x3f1260b2,0x3f54db31,0x3f3daef9,0x3f226799,0x3f039c3d
.long 0x3f4f1bbd,0x3f3504f3,0x3f167918,0x3ee87171,0x3f490a88,0x3f2beb4a,0x3f0a04f8,0x3ec8917e
.long 0x3f42a9f7,0x3f226799,0x3efa2c90,0x3ea7bf25,0x3f3bfc8f,0x3f187fc0,0x3edf7108,0x3e862210
.long 0x3f3504f3,0x3f0e39da,0x3ec3ef15,0x3e47c5c2,0x3f2dc5e3,0x3f039c3d,0x3ea7bf25,0x3e0255f4
.long 0x3f26423a,0x3ef15aea,0x3e8afa3e,0x3d712283,0x3f1e7cf1,0x3edae880,0x3e5b73dc,0xbc20d8d2
.long 0x3f167918,0x3ec3ef15,0x3e20305b,0xbda0af2a,0x3f0e39da,0x3eac7cd4,0x3dc8bd36,0xbe164083
.long 0x3f05c277,0x3e94a031,0x3d20cee7,0xbe5b73dc,0x3efa2c90,0x3e78cfcc,0xbca0d6d6,0xbe8fcefe
.long 0x3ee87171,0x3e47c5c2,0xbda0af2a,0xbeb13641,0x3ed65a92,0x3e164083,0xbe0c4cf7,0xbed1c759
.long 0x3ec3ef15,0x3dc8bd36,0xbe47c5c2,0xbef15aea,0x3eb13641,0x3d48fb30,0xbe814693,0xbf07e565
.long 0x3f800000,0x3f800000,0x3f800000,0x3f800000,0x3f7f35f9,0x3f7f0059,0x3f7ec46d,0x3f7e8238
.long 0x3f7cd925,0x3f7c0361,0x3f7b14be,0x3f7a0d54,0x3f78ed3c,0x3f770f11,0x3f74fa0b,0x3f72ae9e
.long 0x3f737871,0x3f702d4f,0x3f6c835e,0x3f687c12,0x3f6c835e,0x3f676bd8,0x3f61c598,0x3f5b941a
.long 0x3f641901,0x3f5cdc29,0x3f54db31,0x3f4c1d35,0x3f5a46a0,0x3f50935b,0x3f45e403,0x3f3a4582
.long 0x3f4f1bbd,0x3f42a9f7,0x3f3504f3,0x3f26423a,0x3f42a9f7,0x3f333bc6,0x3f226799,0x3f104f0e
.long 0x3f3504f3,0x3f226799,0x3f0e39da,0x3ef15aea,0x3f26423a,0x3f104f0e,0x3ef15aea,0x3ebf47d7
.long 0x3f167918,0x3efa2c90,0x3ec3ef15,0x3e8afa3e,0x3f05c277,0x3ed1c759,0x3e94a031,0x3e2a1c3f
.long 0x3ee87171,0x3ea7bf25,0x3e47c5c2,0x3d712283,0x3ec3ef15,0x3e78cfcc,0x3dc8bd36,0xbd48fb30
.long 0x3e9e377a,0x3e20305b,0x248d3132,0xbe20305b,0x3e6f0c4d,0x3d8ca1f2,0xbdc8bd36,0xbe862210
.long 0x3e20305b,0xbca0d6d6,0xbe47c5c2,0xbeba9be1,0x3da0af2a,0xbddcbd0d,0xbe94a031,0xbeece91a
.long 0x248d3132,0xbe47c5c2,0xbec3ef15,0xbf0e39da,0xbda0af2a,0xbe8fcefe,0xbef15aea,0xbf2456f1
.long 0xbe20305b,0xbeba9be1,0xbf0e39da,0xbf3889dc,0xbe6f0c4d,0xbee3f40d,0xbf226799,0xbf4a965e
.long 0xbe9e377a,0xbf05c277,0xbf3504f3,0xbf5a46a0,0xbec3ef15,0xbf187fc0,0xbf45e403,0xbf676bd8
.long 0xbee87171,0xbf2a0c73,0xbf54db31,0xbf71decf,0xbf05c277,0xbf3a4582,0xbf61c598,0xbf79805c
.long 0xbf167918,0xbf490a88,0xbf6c835e,0xbf7e39bc,0xbf26423a,0xbf563e03,0xbf74fa0b,0xbf7ffcd7
.long 0xbf3504f3,0xbf61c598,0xbf7b14be,0xbf7ec46d,0xbf42a9f7,0xbf6b8a3d,0xbf7ec46d,0xbf7a9421
.long 0x3f800000,0x3f800000,0x3f800000,0x3f800000,0x3f7e39bc,0x3f7deafa,0x3f7d95f4,0x3f7d3aac
.long 0x3f78ed3c,0x3f77b493,0x3f766377,0x3f74fa0b,0x3f702d4f,0x3f6d76aa,0x3f6a8b4b,0x3f676bd8
.long 0x3f641901,0x3f5f5be6,0x3f5a46a0,0x3f54db31,0x3f54db31,0x3f4d9f02,0x3f45e403,0x3f3daef9
.long 0x3f42a9f7,0x3f3889dc,0x3f2dc5e3,0x3f226799,0x3f2dc5e3,0x3f207440,0x3f1260b2,0x3f039c3d
.long 0x3f167918,0x3f05c277,0x3ee87171,0x3ec3ef15,0x3efa2c90,0x3ed1c759,0x3ea7bf25,0x3e78cfcc
.long 0x3ec3ef15,0x3e94a031,0x3e47c5c2,0x3dc8bd36,0x3e8afa3e,0x3e2a1c3f,0x3d712283,0xbd48fb30
.long 0x3e20305b,0x3d20cee7,0xbda0af2a,0xbe47c5c2,0x3d20cee7,0xbdb4b86a,0xbe5b73dc,0xbeac7cd4
.long 0xbda0af2a,0xbe5b73dc,0xbeb13641,0xbef15aea,0xbe47c5c2,0xbeac7cd4,0xbef15aea,0xbf187fc0
.long 0xbe9e377a,0xbee87171,0xbf167918,0xbf3504f3,0xbed65a92,0xbf104f0e,0xbf316e2c,0xbf4d9f02
.long 0xbf05c277,0xbf2a0c73,0xbf490a88,0xbf61c598,0xbf1e7cf1,0xbf4105b8,0xbf5cdc29,0xbf710908
.long 0xbf3504f3,0xbf54db31,0xbf6c835e,0xbf7b14be,0xbf490a88,0xbf653a48,0xbf77b493,0xbf7fb10f
.long 0xbf5a46a0,0xbf71decf,0xbf7e39bc,0xbf7ec46d,0xbf687c12,0xbf7a9421,0xbf7ff35e,0xbf7853f8
.long 0xbf737871,0xbf7f35f9,0xbf7cd925,0xbf6c835e,0xbf7b14be,0xbf7fb10f,0xbf74fa0b,0xbf5b941a
.long 0xbf7f35f9,0xbf7c0361,0xbf687c12,0xbf45e403,0xbf7fcd79,0xbf743c41,0xbf579b8c,0xbf2beb4a
.long 0xbf7cd925,0xbf687c12,0xbf42a9f7,0xbf0e39da,0xbf766377,0xbf58f3c4,0xbf2a0c73,0xbedae880
.long 0xbf6c835e,0xbf45e403,0xbf0e39da,0xbe94a031,0xbf5f5be6,0xbf2f9c32,0xbedf7108,0xbe164083
.long 0x3f800000,0x3f800000,0x3f800000,0x3f800000,0x3f7cd925,0x3f7c7160,0x3f7c0361,0x3f7b8f2a
.long 0x3f737871,0x3f71decf,0x3f702d4f,0x3f6e641a,0x3f641901,0x3f609384,0x3f5cdc29,0x3f58f3c4
.long 0x3f4f1bbd,0x3f490a88,0x3f42a9f7,0x3f3bfc8f,0x3f3504f3,0x3f2beb4a,0x3f226799,0x3f187fc0
.long 0x3f167918,0x3f0a04f8,0x3efa2c90,0x3edf7108,0x3ee87171,0x3ec8917e,0x3ea7bf25,0x3e862210
.long 0x3e9e377a,0x3e6f0c4d,0x3e20305b,0x3da0af2a,0x3e20305b,0x3d8ca1f2,0xbca0d6d6,0xbddcbd0d
.long 0x248d3132,0xbdc8bd36,0xbe47c5c2,0xbe94a031,0xbe20305b,0xbe862210,0xbeba9be1,0xbeece91a
.long 0xbe9e377a,0xbed65a92,0xbf05c277,0xbf1e7cf1,0xbee87171,0xbf104f0e,0xbf2a0c73,0xbf4105b8
.long 0xbf167918,0xbf316e2c,0xbf490a88,0xbf5cdc29,0xbf3504f3,0xbf4d9f02,0xbf61c598,0xbf710908
.long 0xbf4f1bbd,0xbf641901,0xbf737871,0xbf7cd925,0xbf641901,0xbf743c41,0xbf7d95f4,0xbf7fe394
.long 0xbf737871,0xbf7d95f4,0xbf7fcd79,0xbf7a0d54,0xbf7cd925,0xbf7fe394,0xbf7a0d54,0xbf6b8a3d
.long 0xbf800000,0xbf7b14be,0xbf6c835e,0xbf54db31,0xbf7cd925,0xbf6f4ba8,0xbf579b8c,0xbf36c9a9
.long 0xbf737871,0xbf5cdc29,0xbf3bfc8f,0xbf1260b2,0xbf641901,0xbf444969,0xbf1a82a4,0xbed1c759
.long 0xbf4f1bbd,0xbf26423a,0xbee87171,0xbe6f0c4d,0xbf3504f3,0xbf039c3d,0xbe94a031,0xbd48fb30
.long 0xbf167918,0xbeba9be1,0xbdf0b772,0x3e0c4cf7,0xbee87171,0xbe519f65,0x3d712283,0x3ea2fd52
.long 0xbe9e377a,0xbd20cee7,0x3e6f0c4d,0x3efa2c90,0xbe20305b,0x3e0255f4,0x3ecd2ef3,0x3f2456f1
.long 0xa553c9ca,0x3e94a031,0x3f0e39da,0x3f45e403,0x3e20305b,0x3ee3f40d,0x3f316e2c,0x3f609384
.long 0x3f800000,0x3f800000,0x3f800000,0x3f800000,0x3f7b14be,0x3f7a9421,0x3f7a0d54,0x3f79805c
.long 0x3f6c835e,0x3f6a8b4b,0x3f687c12,0x3f6655e7,0x3f54db31,0x3f50935b,0x3f4c1d35,0x3f4779bc
.long 0x3f3504f3,0x3f2dc5e3,0x3f26423a,0x3f1e7cf1,0x3f0e39da,0x3f039c3d,0x3ef15aea,0x3edae880
.long 0x3ec3ef15,0x3ea7bf25,0x3e8afa3e,0x3e5b73dc,0x3e47c5c2,0x3e0255f4,0x3d712283,0xbc20d8d2
.long 0x248d3132,0xbda0af2a,0xbe20305b,0xbe6f0c4d,0xbe47c5c2,0xbe8fcefe,0xbeba9be1,0xbee3f40d
.long 0xbec3ef15,0xbef15aea,0xbf0e39da,0xbf226799,0xbf0e39da,0xbf2456f1,0xbf3889dc,0xbf4a965e
.long 0xbf3504f3,0xbf490a88,0xbf5a46a0,0xbf687c12,0xbf54db31,0xbf653a48,0xbf71decf,0xbf7a9421
.long 0xbf6c835e,0xbf77b493,0xbf7e39bc,0xbf7ff35e,0xbf7b14be,0xbf7fb10f,0xbf7ec46d,0xbf7853f8
.long 0xbf800000,0xbf7cd925,0xbf737871,0xbf641901,0xbf7b14be,0xbf6f4ba8,0xbf5cdc29,0xbf444969
.long 0xbf6c835e,0xbf579b8c,0xbf3bfc8f,0xbf1a82a4,0xbf54db31,0xbf36c9a9,0xbf1260b2,0xbed1c759
.long 0xbf3504f3,0xbf0e39da,0xbec3ef15,0xbe47c5c2,0xbf0e39da,0xbebf47d7,0xbe3403f1,0x3cf13d4c
.long 0xbec3ef15,0xbe3403f1,0x3d20cee7,0x3e814693,0xbe47c5c2,0x3cf13d4c,0x3e814693,0x3eece91a
.long 0xa553c9ca,0x3e6f0c4d,0x3ee87171,0x3f26423a,0x3e47c5c2,0x3edae880,0x3f226799,0x3f4d9f02
.long 0x3ec3ef15,0x3f1a82a4,0x3f490a88,0x3f6a8b4b,0x3f0e39da,0x3f4105b8,0x3f6655e7,0x3f7b8f2a
.long 0x3f3504f3,0x3f5f5be6,0x3f78ed3c,0x3f7fcd79,0x3f54db31,0x3f743c41,0x3f7ff35e,0x3f770f11
.long 0x3f6c835e,0x3f7ec46d,0x3f7b14be,0x3f61c598,0x3f7b14be,0x3f7e8238,0x3f6a8b4b,0x3f4105b8
.long 0x3f800000,0x3f800000,0x3f800000,0x3f800000,0x3f78ed3c,0x3f7853f8,0x3f77b493,0x3f770f11
.long 0x3f641901,0x3f61c598,0x3f5f5be6,0x3f5cdc29,0x3f42a9f7,0x3f3daef9,0x3f3889dc,0x3f333bc6
.long 0x3f167918,0x3f0e39da,0x3f05c277,0x3efa2c90,0x3ec3ef15,0x3eac7cd4,0x3e94a031,0x3e78cfcc
.long 0x3e20305b,0x3dc8bd36,0x3d20cee7,0xbca0d6d6,0xbda0af2a,0xbe164083,0xbe5b73dc,0xbe8fcefe
.long 0xbe9e377a,0xbec3ef15,0xbee87171,0xbf05c277,0xbf05c277,0xbf187fc0,0xbf2a0c73,0xbf3a4582
.long 0xbf3504f3,0xbf45e403,0xbf54db31,0xbf61c598,0xbf5a46a0,0xbf676bd8,0xbf71decf,0xbf79805c
.long 0xbf737871,0xbf7b14be,0xbf7f35f9,0xbf7fcd79,0xbf7f35f9,0xbf7fb10f,0xbf7c0361,0xbf743c41
.long 0xbf7cd925,0xbf74fa0b,0xbf687c12,0xbf579b8c,0xbf6c835e,0xbf5b941a,0xbf45e403,0xbf2beb4a
.long 0xbf4f1bbd,0xbf3504f3,0xbf167918,0xbee87171,0xbf26423a,0xbf039c3d,0xbeba9be1,0xbe519f65
.long 0xbee87171,0xbe94a031,0xbdf0b772,0x3d712283,0xbe6f0c4d,0xbd48fb30,0x3e0c4cf7,0x3ea2fd52
.long 0xa553c9ca,0x3e47c5c2,0x3ec3ef15,0x3f0e39da,0x3e6f0c4d,0x3edae880,0x3f1a82a4,0x3f4105b8
.long 0x3ee87171,0x3f226799,0x3f490a88,0x3f6655e7,0x3f26423a,0x3f4d9f02,0x3f6a8b4b,0x3f7b8f2a
.long 0x3f4f1bbd,0x3f6c835e,0x3f7cd925,0x3f7f35f9,0x3f6c835e,0x3f7d3aac,0x3f7ec46d,0x3f710908
.long 0x3f7cd925,0x3f7ec46d,0x3f702d4f,0x3f5205d4,0x3f7f35f9,0x3f710908,0x3f5205d4,0x3f2456f1
.long 0x3f737871,0x3f54db31,0x3f26423a,0x3ed65a92,0x3f5a46a0,0x3f2beb4a,0x3edf7108,0x3e2a1c3f
.long 0x3f3504f3,0x3ef15aea,0x3e47c5c2,0xbdc8bd36,0x3f05c277,0x3e78cfcc,0xbd712283,0xbeb5eb4f
.long 0x3f800000,0x3f800000,0x3f800000,0x3f800000,0x3f766377,0x3f75b1c9,0x3f74fa0b,0x3f743c41
.long 0x3f5a46a0,0x3f579b8c,0x3f54db31,0x3f5205d4,0x3f2dc5e3,0x3f28296a,0x3f226799,0x3f1c81b9
.long 0x3ee87171,0x3ed65a92,0x3ec3ef15,0x3eb13641,0x3e47c5c2,0x3e164083,0x3dc8bd36,0x3d48fb30
.long 0xbda0af2a,0xbe0c4cf7,0xbe47c5c2,0xbe814693,0xbeb13641,0xbed1c759,0xbef15aea,0xbf07e565
.long 0xbf167918,0xbf26423a,0xbf3504f3,0xbf42a9f7,0xbf490a88,0xbf563e03,0xbf61c598,0xbf6b8a3d
.long 0xbf6c835e,0xbf74fa0b,0xbf7b14be,0xbf7ec46d,0xbf7e39bc,0xbf7ffcd7,0xbf7ec46d,0xbf7a9421
.long 0xbf7cd925,0xbf766377,0xbf6c835e,0xbf5f5be6,0xbf687c12,0xbf58f3c4,0xbf45e403,0xbf2f9c32
.long 0xbf42a9f7,0xbf2a0c73,0xbf0e39da,0xbedf7108,0xbf0e39da,0xbedae880,0xbe94a031,0xbe164083
.long 0xbe9e377a,0xbe20305b,0xa553c9ca,0x3e20305b,0xbd20cee7,0x3e0255f4,0x3e94a031,0x3ee3f40d
.long 0x3e6f0c4d,0x3ecd2ef3,0x3f0e39da,0x3f316e2c,0x3efa2c90,0x3f2456f1,0x3f45e403,0x3f609384
.long 0x3f3504f3,0x3f54db31,0x3f6c835e,0x3f7b14be,0x3f5f5be6,0x3f743c41,0x3f7ec46d,0x3f7e8238
.long 0x3f78ed3c,0x3f7ff35e,0x3f7b14be,0x3f6a8b4b,0x3f7fcd79,0x3f770f11,0x3f61c598,0x3f4105b8
.long 0x3f737871,0x3f5a46a0,0x3f3504f3,0x3f05c277,0x3f54db31,0x3f2beb4a,0x3ef15aea,0x3e78cfcc
.long 0x3f26423a,0x3edf7108,0x3e47c5c2,0xbd712283,0x3ed65a92,0x3e2a1c3f,0xbdc8bd36,0xbeb5eb4f
.long 0x3e20305b,0xbdf0b772,0xbec3ef15,0xbf1e7cf1,0xbdf0b772,0xbec8917e,0xbf226799,0xbf53731f
.long 0xbec3ef15,0xbf226799,0xbf54db31,0xbf74fa0b,0xbf1e7cf1,0xbf53731f,0xbf74fa0b,0xbf7ffcd7
.long 0x0,0x0,0x0,0x0,0x0,0x3c20d8d2,0x3ca0d6d6,0x3cf13d4c
.long 0x0,0x3ca0d6d6,0x3d20cee7,0x3d712283,0x0,0x3cf13d4c,0x3d712283,0x3db4b86a
.long 0x0,0x3d20cee7,0x3da0af2a,0x3df0b772,0x0,0x3d48fb30,0x3dc8bd36,0x3e164083
.long 0x0,0x3d712283,0x3df0b772,0x3e3403f1,0x0,0x3d8ca1f2,0x3e0c4cf7,0x3e519f65
.long 0x0,0x3da0af2a,0x3e20305b,0x3e6f0c4d,0x0,0x3db4b86a,0x3e3403f1,0x3e862210
.long 0x0,0x3dc8bd36,0x3e47c5c2,0x3e94a031,0x0,0x3ddcbd0d,0x3e5b73dc,0x3ea2fd52
.long 0x0,0x3df0b772,0x3e6f0c4d,0x3eb13641,0x0,0x3e0255f4,0x3e814693,0x3ebf47d7
.long 0x0,0x3e0c4cf7,0x3e8afa3e,0x3ecd2ef3,0x0,0x3e164083,0x3e94a031,0x3edae880
.long 0x0,0x3e20305b,0x3e9e377a,0x3ee87171,0x0,0x3e2a1c3f,0x3ea7bf25,0x3ef5c6c5
.long 0x0,0x3e3403f1,0x3eb13641,0x3f0172c3,0x0,0x3e3de731,0x3eba9be1,0x3f07e565
.long 0x0,0x3e47c5c2,0x3ec3ef15,0x3f0e39da,0x0,0x3e519f65,0x3ecd2ef3,0x3f146eba
.long 0x0,0x3e5b73dc,0x3ed65a92,0x3f1a82a4,0x0,0x3e6542e9,0x3edf7108,0x3f207440
.long 0x0,0x3e6f0c4d,0x3ee87171,0x3f26423a,0x0,0x3e78cfcc,0x3ef15aea,0x3f2beb4a
.long 0x0,0x3e814693,0x3efa2c90,0x3f316e2c,0x0,0x3e862210,0x3f0172c3,0x3f36c9a9
.long 0x0,0x3e8afa3e,0x3f05c277,0x3f3bfc8f,0x0,0x3e8fcefe,0x3f0a04f8,0x3f4105b8
.long 0x0,0x3e94a031,0x3f0e39da,0x3f45e403,0x0,0x3e996dba,0x3f1260b2,0x3f4a965e
.long 0x0,0x0,0x0,0x0,0x3d20cee7,0x3d48fb30,0x3d712283,0x3d8ca1f2
.long 0x3da0af2a,0x3dc8bd36,0x3df0b772,0x3e0c4cf7,0x3df0b772,0x3e164083,0x3e3403f1,0x3e519f65
.long 0x3e20305b,0x3e47c5c2,0x3e6f0c4d,0x3e8afa3e,0x3e47c5c2,0x3e78cfcc,0x3e94a031,0x3eac7cd4
.long 0x3e6f0c4d,0x3e94a031,0x3eb13641,0x3ecd2ef3,0x3e8afa3e,0x3eac7cd4,0x3ecd2ef3,0x3eece91a
.long 0x3e9e377a,0x3ec3ef15,0x3ee87171,0x3f05c277,0x3eb13641,0x3edae880,0x3f0172c3,0x3f146eba
.long 0x3ec3ef15,0x3ef15aea,0x3f0e39da,0x3f226799,0x3ed65a92,0x3f039c3d,0x3f1a82a4,0x3f2f9c32
.long 0x3ee87171,0x3f0e39da,0x3f26423a,0x3f3bfc8f,0x3efa2c90,0x3f187fc0,0x3f316e2c,0x3f4779bc
.long 0x3f05c277,0x3f226799,0x3f3bfc8f,0x3f5205d4,0x3f0e39da,0x3f2beb4a,0x3f45e403,0x3f5b941a
.long 0x3f167918,0x3f3504f3,0x3f4f1bbd,0x3f641901,0x3f1e7cf1,0x3f3daef9,0x3f579b8c,0x3f6b8a3d
.long 0x3f26423a,0x3f45e403,0x3f5f5be6,0x3f71decf,0x3f2dc5e3,0x3f4d9f02,0x3f6655e7,0x3f770f11
.long 0x3f3504f3,0x3f54db31,0x3f6c835e,0x3f7b14be,0x3f3bfc8f,0x3f5b941a,0x3f71decf,0x3f7deafa
.long 0x3f42a9f7,0x3f61c598,0x3f766377,0x3f7f8e56,0x3f490a88,0x3f676bd8,0x3f7a0d54,0x3f7ffcd7
.long 0x3f4f1bbd,0x3f6c835e,0x3f7cd925,0x3f7f35f9,0x3f54db31,0x3f710908,0x3f7ec46d,0x3f7d3aac
.long 0x3f5a46a0,0x3f74fa0b,0x3f7fcd79,0x3f7a0d54,0x3f5f5be6,0x3f7853f8,0x3f7ff35e,0x3f75b1c9
.long 0x3f641901,0x3f7b14be,0x3f7f35f9,0x3f702d4f,0x3f687c12,0x3f7d3aac,0x3f7d95f4,0x3f698690
.long 0x3f6c835e,0x3f7ec46d,0x3f7b14be,0x3f61c598,0x3f702d4f,0x3f7fb10f,0x3f77b493,0x3f58f3c4
.long 0x0,0x0,0x0,0x0,0x3da0af2a,0x3db4b86a,0x3dc8bd36,0x3ddcbd0d
.long 0x3e20305b,0x3e3403f1,0x3e47c5c2,0x3e5b73dc,0x3e6f0c4d,0x3e862210,0x3e94a031,0x3ea2fd52
.long 0x3e9e377a,0x3eb13641,0x3ec3ef15,0x3ed65a92,0x3ec3ef15,0x3edae880,0x3ef15aea,0x3f039c3d
.long 0x3ee87171,0x3f0172c3,0x3f0e39da,0x3f1a82a4,0x3f05c277,0x3f146eba,0x3f226799,0x3f2f9c32
.long 0x3f167918,0x3f26423a,0x3f3504f3,0x3f42a9f7,0x3f26423a,0x3f36c9a9,0x3f45e403,0x3f53731f
.long 0x3f3504f3,0x3f45e403,0x3f54db31,0x3f61c598,0x3f42a9f7,0x3f53731f,0x3f61c598,0x3f6d76aa
.long 0x3f4f1bbd,0x3f5f5be6,0x3f6c835e,0x3f766377,0x3f5a46a0,0x3f698690,0x3f74fa0b,0x3f7c7160
.long 0x3f641901,0x3f71decf,0x3f7b14be,0x3f7f8e56,0x3f6c835e,0x3f7853f8,0x3f7ec46d,0x3f7fb10f
.long 0x3f737871,0x3f7cd925,0x3f800000,0x3f7cd925,0x3f78ed3c,0x3f7f654e,0x3f7ec46d,0x3f770f11
.long 0x3f7cd925,0x3f7ff35e,0x3f7b14be,0x3f6e641a,0x3f7f35f9,0x3f7e8238,0x3f74fa0b,0x3f62f219
.long 0x3f800000,0x3f7b14be,0x3f6c835e,0x3f54db31,0x3f7f35f9,0x3f75b1c9,0x3f61c598,0x3f444969
.long 0x3f7cd925,0x3f6e641a,0x3f54db31,0x3f316e2c,0x3f78ed3c,0x3f653a48,0x3f45e403,0x3f1c81b9
.long 0x3f737871,0x3f5a46a0,0x3f3504f3,0x3f05c277,0x3f6c835e,0x3f4d9f02,0x3f226799,0x3edae880
.long 0x3f641901,0x3f3f5cb5,0x3f0e39da,0x3ea7bf25,0x3f5a46a0,0x3f2f9c32,0x3ef15aea,0x3e6542e9
.long 0x3f4f1bbd,0x3f1e7cf1,0x3ec3ef15,0x3df0b772,0x3f42a9f7,0x3f0c2124,0x3e94a031,0x3c20d8d2
.long 0x3f3504f3,0x3ef15aea,0x3e47c5c2,0xbdc8bd36,0x3f26423a,0x3ec8917e,0x3dc8bd36,0xbe519f65
.long 0x0,0x0,0x0,0x0,0x3df0b772,0x3e0255f4,0x3e0c4cf7,0x3e164083
.long 0x3e6f0c4d,0x3e814693,0x3e8afa3e,0x3e94a031,0x3eb13641,0x3ebf47d7,0x3ecd2ef3,0x3edae880
.long 0x3ee87171,0x3efa2c90,0x3f05c277,0x3f0e39da,0x3f0e39da,0x3f187fc0,0x3f226799,0x3f2beb4a
.long 0x3f26423a,0x3f316e2c,0x3f3bfc8f,0x3f45e403,0x3f3bfc8f,0x3f4779bc,0x3f5205d4,0x3f5b941a
.long 0x3f4f1bbd,0x3f5a46a0,0x3f641901,0x3f6c835e,0x3f5f5be6,0x3f698690,0x3f71decf,0x3f7853f8
.long 0x3f6c835e,0x3f74fa0b,0x3f7b14be,0x3f7ec46d,0x3f766377,0x3f7c7160,0x3f7f8e56,0x3f7fb10f
.long 0x3f7cd925,0x3f7fcd79,0x3f7f35f9,0x3f7b14be,0x3f7fcd79,0x3f7f0059,0x3f7a0d54,0x3f710908
.long 0x3f7f35f9,0x3f7a0d54,0x3f702d4f,0x3f61c598,0x3f7b14be,0x3f710908,0x3f61c598,0x3f4d9f02
.long 0x3f737871,0x3f641901,0x3f4f1bbd,0x3f3504f3,0x3f687c12,0x3f53731f,0x3f3889dc,0x3f187fc0
.long 0x3f5a46a0,0x3f3f5cb5,0x3f1e7cf1,0x3ef15aea,0x3f490a88,0x3f28296a,0x3f0172c3,0x3eac7cd4
.long 0x3f3504f3,0x3f0e39da,0x3ec3ef15,0x3e47c5c2,0x3f1e7cf1,0x3ee3f40d,0x3e814693,0x3d48fb30
.long 0x3f05c277,0x3ea7bf25,0x3df0b772,0xbdc8bd36,0x3ed65a92,0x3e519f65,0xbca0d6d6,0xbe78cfcc
.long 0x3e9e377a,0x3da0af2a,0xbe20305b,0xbec3ef15,0x3e47c5c2,0xbd48fb30,0xbe94a031,0xbf039c3d
.long 0x3da0af2a,0xbe3403f1,0xbed65a92,0xbf226799,0xbd20cee7,0xbe996dba,0xbf0a04f8,0xbf3daef9
.long 0xbe20305b,0xbed65a92,0xbf26423a,0xbf54db31,0xbe8afa3e,0xbf07e565,0xbf3f5cb5,0xbf676bd8
.long 0xbec3ef15,0xbf226799,0xbf54db31,0xbf74fa0b,0xbefa2c90,0xbf3a4582,0xbf6655e7,0xbf7d3aac
.long 0x0,0x0,0x0,0x0,0x3e20305b,0x3e2a1c3f,0x3e3403f1,0x3e3de731
.long 0x3e9e377a,0x3ea7bf25,0x3eb13641,0x3eba9be1,0x3ee87171,0x3ef5c6c5,0x3f0172c3,0x3f07e565
.long 0x3f167918,0x3f1e7cf1,0x3f26423a,0x3f2dc5e3,0x3f3504f3,0x3f3daef9,0x3f45e403,0x3f4d9f02
.long 0x3f4f1bbd,0x3f579b8c,0x3f5f5be6,0x3f6655e7,0x3f641901,0x3f6b8a3d,0x3f71decf,0x3f770f11
.long 0x3f737871,0x3f78ed3c,0x3f7cd925,0x3f7f35f9,0x3f7cd925,0x3f7f654e,0x3f7ff35e,0x3f7e8238
.long 0x3f800000,0x3f7ec46d,0x3f7b14be,0x3f74fa0b,0x3f7cd925,0x3f770f11,0x3f6e641a,0x3f62f219
.long 0x3f737871,0x3f687c12,0x3f5a46a0,0x3f490a88,0x3f641901,0x3f53731f,0x3f3f5cb5,0x3f28296a
.long 0x3f4f1bbd,0x3f3889dc,0x3f1e7cf1,0x3f0172c3,0x3f3504f3,0x3f187fc0,0x3ef15aea,0x3eac7cd4
.long 0x3f167918,0x3ee87171,0x3e9e377a,0x3e20305b,0x3ee87171,0x3e996dba,0x3e0c4cf7,0xbcf13d4c
.long 0x3e9e377a,0x3e0c4cf7,0xbd20cee7,0xbe5b73dc,0x3e20305b,0xbcf13d4c,0xbe5b73dc,0xbec8917e
.long 0x250d3132,0xbe47c5c2,0xbec3ef15,0xbf0e39da,0xbe20305b,0xbeb5eb4f,0xbf0a04f8,0xbf333bc6
.long 0xbe9e377a,0xbf0172c3,0xbf2dc5e3,0xbf5205d4,0xbee87171,0xbf2456f1,0xbf4c1d35,0xbf698690
.long 0xbf167918,0xbf42a9f7,0xbf641901,0xbf78ed3c,0xbf3504f3,0xbf5b941a,0xbf74fa0b,0xbf7fb10f
.long 0xbf4f1bbd,0xbf6e641a,0xbf7e39bc,0xbf7d95f4,0xbf641901,0xbf7a9421,0xbf7f8e56,0xbf72ae9e
.long 0xbf737871,0xbf7fcd79,0xbf78ed3c,0xbf5f5be6,0xbf7cd925,0xbf7deafa,0xbf6a8b4b,0xbf444969
.long 0xbf800000,0xbf74fa0b,0xbf54db31,0xbf226799,0xbf7cd925,0xbf653a48,0xbf3889dc,0xbef5c6c5
.long 0x0,0x0,0x0,0x0,0x3e47c5c2,0x3e519f65,0x3e5b73dc,0x3e6542e9
.long 0x3ec3ef15,0x3ecd2ef3,0x3ed65a92,0x3edf7108,0x3f0e39da,0x3f146eba,0x3f1a82a4,0x3f207440
.long 0x3f3504f3,0x3f3bfc8f,0x3f42a9f7,0x3f490a88,0x3f54db31,0x3f5b941a,0x3f61c598,0x3f676bd8
.long 0x3f6c835e,0x3f71decf,0x3f766377,0x3f7a0d54,0x3f7b14be,0x3f7deafa,0x3f7f8e56,0x3f7ffcd7
.long 0x3f800000,0x3f7f35f9,0x3f7cd925,0x3f78ed3c,0x3f7b14be,0x3f75b1c9,0x3f6e641a,0x3f653a48
.long 0x3f6c835e,0x3f61c598,0x3f54db31,0x3f45e403,0x3f54db31,0x3f444969,0x3f316e2c,0x3f1c81b9
.long 0x3f3504f3,0x3f1e7cf1,0x3f05c277,0x3ed65a92,0x3f0e39da,0x3ee3f40d,0x3ea7bf25,0x3e519f65
.long 0x3ec3ef15,0x3e814693,0x3df0b772,0xbca0d6d6,0x3e47c5c2,0x3d48fb30,0xbdc8bd36,0xbe78cfcc
.long 0x250d3132,0xbe20305b,0xbe9e377a,0xbee87171,0xbe47c5c2,0xbeb5eb4f,0xbf0172c3,0xbf2456f1
.long 0xbec3ef15,0xbf0a04f8,0xbf2dc5e3,0xbf4c1d35,0xbf0e39da,0xbf333bc6,0xbf5205d4,0xbf698690
.long 0xbf3504f3,0xbf54db31,0xbf6c835e,0xbf7b14be,0xbf54db31,0xbf6d76aa,0xbf7c0361,0xbf7fe394
.long 0xbf6c835e,0xbf7c0361,0xbf7fcd79,0xbf77b493,0xbf7b14be,0xbf7fe394,0xbf77b493,0xbf62f219
.long 0xbf800000,0xbf78ed3c,0xbf641901,0xbf42a9f7,0xbf7b14be,0xbf676bd8,0xbf45e403,0xbf187fc0
.long 0xbf6c835e,0xbf4c1d35,0xbf1e7cf1,0xbecd2ef3,0xbf54db31,0xbf28296a,0xbedf7108,0xbe3de731
.long 0xbf3504f3,0xbefa2c90,0xbe6f0c4d,0x3d20cee7,0xbf0e39da,0xbe996dba,0xbca0d6d6,0x3e862210
.long 0xbec3ef15,0xbdc8bd36,0x3e47c5c2,0x3ef15aea,0xbe47c5c2,0x3ddcbd0d,0x3ecd2ef3,0x3f28296a
.long 0x0,0x0,0x0,0x0,0x3e6f0c4d,0x3e78cfcc,0x3e814693,0x3e862210
.long 0x3ee87171,0x3ef15aea,0x3efa2c90,0x3f0172c3,0x3f26423a,0x3f2beb4a,0x3f316e2c,0x3f36c9a9
.long 0x3f4f1bbd,0x3f54db31,0x3f5a46a0,0x3f5f5be6,0x3f6c835e,0x3f710908,0x3f74fa0b,0x3f7853f8
.long 0x3f7cd925,0x3f7ec46d,0x3f7fcd79,0x3f7ff35e,0x3f7f35f9,0x3f7d3aac,0x3f7a0d54,0x3f75b1c9
.long 0x3f737871,0x3f6c835e,0x3f641901,0x3f5a46a0,0x3f5a46a0,0x3f4d9f02,0x3f3f5cb5,0x3f2f9c32
.long 0x3f3504f3,0x3f226799,0x3f0e39da,0x3ef15aea,0x3f05c277,0x3edae880,0x3ea7bf25,0x3e6542e9
.long 0x3e9e377a,0x3e47c5c2,0x3da0af2a,0xbd20cee7,0x3da0af2a,0xbd48fb30,0xbe3403f1,0xbe996dba
.long 0xbe20305b,0xbe94a031,0xbed65a92,0xbf0a04f8,0xbec3ef15,0xbf039c3d,0xbf226799,0xbf3daef9
.long 0xbf167918,0xbf3504f3,0xbf4f1bbd,0xbf641901,0xbf42a9f7,0xbf5b941a,0xbf6e641a,0xbf7a9421
.long 0xbf641901,0xbf74fa0b,0xbf7e39bc,0xbf7f8e56,0xbf78ed3c,0xbf7fb10f,0xbf7d95f4,0xbf72ae9e
.long 0xbf800000,0xbf7b14be,0xbf6c835e,0xbf54db31,0xbf78ed3c,0xbf676bd8,0xbf4c1d35,0xbf28296a
.long 0xbf641901,0xbf45e403,0xbf1e7cf1,0xbedf7108,0xbf42a9f7,0xbf187fc0,0xbecd2ef3,0xbe3de731
.long 0xbf167918,0xbec3ef15,0xbe20305b,0x3da0af2a,0xbec3ef15,0xbe164083,0x3dc8bd36,0x3eac7cd4
.long 0xbe20305b,0x3dc8bd36,0x3eb13641,0x3f1260b2,0x3da0af2a,0x3eac7cd4,0x3f1260b2,0x3f444969
.long 0x3e9e377a,0x3f0e39da,0x3f42a9f7,0x3f687c12,0x3f05c277,0x3f3daef9,0x3f6655e7,0x3f7c7160
.long 0x3f3504f3,0x3f61c598,0x3f7b14be,0x3f7ec46d,0x3f5a46a0,0x3f7853f8,0x3f7f8e56,0x3f6f4ba8
.long 0x0,0x0,0x0,0x0,0x3e8afa3e,0x3e8fcefe,0x3e94a031,0x3e996dba
.long 0x3f05c277,0x3f0a04f8,0x3f0e39da,0x3f1260b2,0x3f3bfc8f,0x3f4105b8,0x3f45e403,0x3f4a965e
.long 0x3f641901,0x3f687c12,0x3f6c835e,0x3f702d4f,0x3f7b14be,0x3f7d3aac,0x3f7ec46d,0x3f7fb10f
.long 0x3f7f35f9,0x3f7d95f4,0x3f7b14be,0x3f77b493,0x3f702d4f,0x3f698690,0x3f61c598,0x3f58f3c4
.long 0x3f4f1bbd,0x3f42a9f7,0x3f3504f3,0x3f26423a,0x3f1e7cf1,0x3f0c2124,0x3ef15aea,0x3ec8917e
.long 0x3ec3ef15,0x3e94a031,0x3e47c5c2,0x3dc8bd36,0x3df0b772,0x3c20d8d2,0xbdc8bd36,0xbe519f65
.long 0xbe20305b,0xbe8afa3e,0xbec3ef15,0xbefa2c90,0xbed65a92,0xbf07e565,0xbf226799,0xbf3a4582
.long 0xbf26423a,0xbf3f5cb5,0xbf54db31,0xbf6655e7,0xbf54db31,0xbf676bd8,0xbf74fa0b,0xbf7d3aac
.long 0xbf737871,0xbf7cd925,0xbf800000,0xbf7cd925,0xbf7fcd79,0xbf7deafa,0xbf74fa0b,0xbf653a48
.long 0xbf78ed3c,0xbf6a8b4b,0xbf54db31,0xbf3889dc,0xbf5f5be6,0xbf444969,0xbf226799,0xbef5c6c5
.long 0xbf3504f3,0xbf0e39da,0xbec3ef15,0xbe47c5c2,0xbefa2c90,0xbe996dba,0xbdc8bd36,0x3ddcbd0d
.long 0xbe6f0c4d,0xbca0d6d6,0x3e47c5c2,0x3ecd2ef3,0x3d20cee7,0x3e862210,0x3ef15aea,0x3f28296a
.long 0x3e9e377a,0x3f05c277,0x3f3504f3,0x3f5a46a0,0x3f0e39da,0x3f3daef9,0x3f61c598,0x3f7853f8
.long 0x3f42a9f7,0x3f6655e7,0x3f7b14be,0x3f7f8e56,0x3f687c12,0x3f7c7160,0x3f7ec46d,0x3f6f4ba8
.long 0x3f7cd925,0x3f7e39bc,0x3f6c835e,0x3f490a88,0x3f7e39bc,0x3f6b8a3d,0x3f45e403,0x3f104f0e
.long 0x3f6c835e,0x3f45e403,0x3f0e39da,0x3e94a031,0x3f490a88,0x3f104f0e,0x3e94a031,0xbc20d8d2
.long 0x80003f80,0x80003f80,0x80003f80,0x80003f80,0x80003f80,0xbe483f7b,0xbec43f6d,0xbf0e3f55
.long 0x80003f80,0xbec43f6d,0xbf353f35,0xbf6d3ec4,0x80003f80,0xbf0e3f55,0xbf6d3ec4,0xbf7bbe48
.long 0x80003f80,0xbf353f35,0xbf80248d,0xbf35bf35,0x80003f80,0xbf553f0e,0xbf6dbec4,0xbe48bf7b
.long 0x80003f80,0xbf6d3ec4,0xbf35bf35,0x3ec4bf6d,0x80003f80,0xbf7b3e48,0xbec4bf6d,0x3f55bf0e
.long 0x80003f80,0xbf80248d,0xa50dbf80,0x3f80a554,0x80003f80,0xbf7bbe48,0x3ec4bf6d,0x3f553f0e
.long 0x80003f80,0xbf6dbec4,0x3f35bf35,0x3ec43f6d,0x80003f80,0xbf55bf0e,0x3f6dbec4,0xbe483f7b
.long 0x80003f80,0xbf35bf35,0x3f80a554,0xbf353f35,0x80003f80,0xbf0ebf55,0x3f6d3ec4,0xbf7b3e48
.long 0x80003f80,0xbec4bf6d,0x3f353f35,0xbf6dbec4,0x80003f80,0xbe48bf7b,0x3ec43f6d,0xbf0ebf55
.long 0x80003f80,0xa50dbf80,0x258d3f80,0xa5d4bf80,0x80003f80,0x3e48bf7b,0xbec43f6d,0x3f0ebf55
.long 0x80003f80,0x3ec4bf6d,0xbf353f35,0x3f6dbec4,0x80003f80,0x3f0ebf55,0xbf6d3ec4,0x3f7b3e48
.long 0x80003f80,0x3f35bf35,0xbf8025b0,0x3f353f35,0x80003f80,0x3f55bf0e,0xbf6dbec4,0x3e483f7b
.long 0x80003f80,0x3f6dbec4,0xbf35bf35,0xbec43f6d,0x80003f80,0x3f7bbe48,0xbec4bf6d,0xbf553f0e
.long 0x80003f80,0x3f80a554,0xa5d4bf80,0xbf80261f,0x80003f80,0x3f7b3e48,0x3ec4bf6d,0xbf55bf0e
.long 0x80003f80,0x3f6d3ec4,0x3f35bf35,0xbec4bf6d,0x80003f80,0x3f553f0e,0x3f6dbec4,0x3e48bf7b
.long 0x80003f80,0x3f353f35,0x3f80a5f7,0x3f35bf35,0x80003f80,0x3f0e3f55,0x3f6d3ec4,0x3f7bbe48
.long 0x80003f80,0x3ec43f6d,0x3f353f35,0x3f6d3ec4,0x80003f80,0x3e483f7b,0x3ec43f6d,0x3f0e3f55
.long 0x80003f80,0x80003f80,0x80003f80,0x80003f80,0xbf353f35,0xbf553f0e,0xbf6d3ec4,0xbf7b3e48
.long 0xbf80248d,0xbf6dbec4,0xbf35bf35,0xbec4bf6d,0xbf35bf35,0xbe48bf7b,0x3ec4bf6d,0x3f55bf0e
.long 0xa50dbf80,0x3f35bf35,0x3f80a554,0x3f353f35,0x3f35bf35,0x3f7b3e48,0x3ec43f6d,0xbf0e3f55
.long 0x3f80a554,0x3ec43f6d,0xbf353f35,0xbf6dbec4,0x3f353f35,0xbf0e3f55,0xbf6dbec4,0x3e48bf7b
.long 0x258d3f80,0xbf8025b0,0xa5d4bf80,0x3f80a5f7,0xbf353f35,0xbf0ebf55,0x3f6dbec4,0x3e483f7b
.long 0xbf8025b0,0x3ec4bf6d,0x3f353f35,0xbf6d3ec4,0xbf35bf35,0x3f7bbe48,0xbec43f6d,0xbf0ebf55
.long 0xa5d4bf80,0x3f353f35,0xbf80261f,0x3f35bf35,0x3f35bf35,0xbe483f7b,0xbec4bf6d,0x3f553f0e
.long 0x3f80a5f7,0xbf6d3ec4,0x3f35bf35,0xbec43f6d,0x3f353f35,0xbf55bf0e,0x3f6d3ec4,0xbf7bbe48
.long 0x260d3f80,0xa630bf80,0x26543f80,0xa677bf80,0xbf353f35,0x3f55bf0e,0xbf6d3ec4,0x3f7bbe48
.long 0xbf80261f,0x3f6d3ec4,0xbf35bf35,0x3ec43f6d,0xbf35bf35,0x3e483f7b,0x3ec4bf6d,0xbf553f0e
.long 0xa630bf80,0xbf353f35,0x3f80a742,0xbf35bf35,0x3f35bf35,0xbf7bbe48,0x3ec43f6d,0x3f0ebf55
.long 0x3f80a731,0xbec4bf6d,0xbf353f35,0x3f6d3ec4,0x3f353f35,0x3f0ebf55,0xbf6dbec4,0xbe483f7b
.long 0x26543f80,0x3f80a742,0xa69fbf80,0xbf80a60d,0xbf353f35,0x3f0e3f55,0x3f6dbec4,0xbe48bf7b
.long 0xbf80a68d,0xbec43f6d,0x3f353f35,0x3f6dbec4,0xbf35bf35,0xbf7b3e48,0xbec43f6d,0x3f0e3f55
.long 0xa677bf80,0xbf35bf35,0xbf80a60d,0xbf353f35,0x3f35bf35,0x3e48bf7b,0xbec4bf6d,0xbf55bf0e
.long 0x3f80a742,0x3f6dbec4,0x3f35bf35,0x3ec4bf6d,0x3f353f35,0x3f553f0e,0x3f6d3ec4,0x3f7b3e48
.long 0x80003f80,0x80003f80,0x80003f80,0x80003f80,0xbf80248d,0xbf7bbe48,0xbf6dbec4,0xbf55bf0e
.long 0xa50dbf80,0x3ec4bf6d,0x3f35bf35,0x3f6dbec4,0x3f80a554,0x3f553f0e,0x3ec43f6d,0xbe483f7b
.long 0x258d3f80,0xbf353f35,0xbf8025b0,0xbf35bf35,0xbf8025b0,0xbf0ebf55,0x3ec4bf6d,0x3f7bbe48
.long 0xa5d4bf80,0x3f6dbec4,0x3f353f35,0xbec43f6d,0x3f80a5f7,0x3e483f7b,0xbf6d3ec4,0xbf0ebf55
.long 0x260d3f80,0xbf80261f,0xa630bf80,0x3f80a731,0xbf80261f,0x3e48bf7b,0x3f6d3ec4,0xbf0e3f55
.long 0xa630bf80,0x3f6d3ec4,0xbf353f35,0xbec4bf6d,0x3f80a731,0xbf0e3f55,0xbec4bf6d,0x3f7b3e48
.long 0x26543f80,0xbf35bf35,0x3f80a742,0xbf353f35,0xbf80a68d,0x3f55bf0e,0xbec43f6d,0xbe48bf7b
.long 0xa677bf80,0x3ec43f6d,0xbf35bf35,0x3f6d3ec4,0x3f80a742,0xbf7b3e48,0x3f6dbec4,0xbf553f0e
.long 0x268d3f80,0xa69fbf80,0x26b03f80,0xa7b1bf80,0xbf80a654,0x3f7b3e48,0xbf6dbec4,0x3f553f0e
.long 0xa69fbf80,0xbec43f6d,0x3f35bf35,0xbf6d3ec4,0x3f80a754,0xbf55bf0e,0x3ec43f6d,0x3e48bf7b
.long 0x26b03f80,0x3f35bf35,0xbf80a58e,0x3f353f35,0xbf80a60d,0x3f0e3f55,0x3ec4bf6d,0xbf7b3e48
.long 0xa7b1bf80,0xbf6d3ec4,0x3f353f35,0x3ec4bf6d,0x3f80a765,0xbe48bf7b,0xbf6d3ec4,0x3f0e3f55
.long 0x26d43f80,0x3f80a777,0xa7c2bf80,0xbf80258d,0xbf80a58e,0xbe483f7b,0x3f6d3ec4,0x3f0ebf55
.long 0x270dbf80,0xbf6dbec4,0xbf353f35,0x3ec43f6d,0x3f80a777,0x3f0ebf55,0xbec4bf6d,0xbf7bbe48
.long 0x26f73f80,0x3f353f35,0x3f80a78d,0x3f35bf35,0xbf80a137,0xbf553f0e,0xbec43f6d,0x3e483f7b
.long 0xa7c2bf80,0xbec4bf6d,0xbf35bf35,0xbf6dbec4,0x3f80a784,0x3f7bbe48,0x3f6dbec4,0x3f55bf0e
.long 0x80003f80,0x80003f80,0x80003f80,0x80003f80,0xbf35bf35,0xbf0ebf55,0xbec4bf6d,0xbe48bf7b
.long 0x3f80a554,0x3f6d3ec4,0x3f353f35,0x3ec43f6d,0xbf353f35,0xbf7b3e48,0xbf6dbec4,0xbf0ebf55
.long 0xa5d4bf80,0x3f35bf35,0x3f80a5f7,0x3f353f35,0x3f353f35,0xbe483f7b,0xbf6d3ec4,0xbf55bf0e
.long 0xbf80261f,0xbec4bf6d,0x3f35bf35,0x3f6d3ec4,0x3f35bf35,0x3f553f0e,0xbec43f6d,0xbf7bbe48
.long 0x26543f80,0xbf80a68d,0xa677bf80,0x3f80a742,0xbf35bf35,0x3f55bf0e,0x3ec43f6d,0xbf7b3e48
.long 0x3f80a742,0xbec43f6d,0xbf35bf35,0x3f6dbec4,0xbf353f35,0xbe48bf7b,0x3f6d3ec4,0xbf553f0e
.long 0xa69fbf80,0x3f353f35,0xbf80a60d,0x3f35bf35,0x3f353f35,0xbf7bbe48,0x3f6dbec4,0xbf0e3f55
.long 0xbf80a60d,0x3f6dbec4,0xbf353f35,0x3ec4bf6d,0x3f35bf35,0xbf0e3f55,0x3ec4bf6d,0xbe483f7b
.long 0x26d43f80,0x270dbf80,0x26f73f80,0xa7c2bf80,0xbf35bf35,0x3f0e3f55,0xbec4bf6d,0x3e483f7b
.long 0x3f80a777,0xbf6dbec4,0x3f353f35,0xbec4bf6d,0xbf353f35,0x3f7bbe48,0xbf6dbec4,0x3f0e3f55
.long 0xa7c2bf80,0xbf353f35,0x3f80a78d,0xbf35bf35,0x3f353f35,0x3e48bf7b,0xbf6d3ec4,0x3f553f0e
.long 0xbf802804,0x3ec43f6d,0x3f35bf35,0xbf6dbec4,0x3f35bf35,0xbf55bf0e,0xbec43f6d,0x3f7b3e48
.long 0x271f3f80,0x3f80a796,0x268dbf80,0xbf80268d,0xbf35bf35,0xbf553f0e,0x3ec43f6d,0x3f7bbe48
.long 0x3f802754,0x3ec4bf6d,0xbf35bf35,0xbf6d3ec4,0xbf353f35,0x3e483f7b,0x3f6d3ec4,0x3f55bf0e
.long 0x268dbf80,0xbf35bf35,0xbf802816,0xbf353f35,0x3f353f35,0x3f7b3e48,0x3f6dbec4,0x3f0ebf55
.long 0xbf802889,0xbf6d3ec4,0xbf353f35,0xbec43f6d,0x3f35bf35,0x3f0ebf55,0x3ec4bf6d,0x3e48bf7b
.long 0x80003f80,0x80003f80,0x80003f80,0x80003f80,0xa50dbf80,0x3e48bf7b,0x3ec4bf6d,0x3f0ebf55
.long 0x258d3f80,0xbec43f6d,0xbf353f35,0xbf6d3ec4,0xa5d4bf80,0x3f0ebf55,0x3f6dbec4,0x3f7b3e48
.long 0x260d3f80,0xbf353f35,0xbf80261f,0xbf35bf35,0xa630bf80,0x3f55bf0e,0x3f6d3ec4,0x3e483f7b
.long 0x26543f80,0xbf6d3ec4,0xbf35bf35,0x3ec4bf6d,0xa677bf80,0x3f7bbe48,0x3ec43f6d,0xbf553f0e
.long 0x268d3f80,0xbf80a654,0xa69fbf80,0x3f80a754,0xa69fbf80,0x3f7b3e48,0xbec43f6d,0xbf55bf0e
.long 0x26b03f80,0xbf6dbec4,0x3f35bf35,0x3ec43f6d,0xa7b1bf80,0x3f553f0e,0xbf6d3ec4,0x3e48bf7b
.long 0x26d43f80,0xbf35bf35,0x3f80a777,0xbf353f35,0x270dbf80,0x3f0e3f55,0xbf6dbec4,0x3f7bbe48
.long 0x26f73f80,0xbec4bf6d,0x3f353f35,0xbf6dbec4,0xa7c2bf80,0x3e483f7b,0xbec4bf6d,0x3f0e3f55
.long 0x270d3f80,0x26d4bf80,0x271f3f80,0xa7d4bf80,0x26d4bf80,0xbe483f7b,0x3ec4bf6d,0xbf0e3f55
.long 0x271f3f80,0x3ec4bf6d,0xbf353f35,0x3f6dbec4,0xa7d4bf80,0xbf0e3f55,0x3f6dbec4,0xbf7bbe48
.long 0x27303f80,0x3f35bf35,0xbf80268d,0x3f353f35,0x268dbf80,0xbf553f0e,0x3f6d3ec4,0xbe48bf7b
.long 0x28313f80,0x3f6dbec4,0xbf35bf35,0xbec43f6d,0xa7e5bf80,0xbf7b3e48,0x3ec43f6d,0x3f55bf0e
.long 0x27543f80,0x3f80a7b1,0xa7f7bf80,0xbf80281f,0x260ebf80,0xbf7bbe48,0xbec43f6d,0x3f553f0e
.long 0xa78d3f80,0x3f6d3ec4,0x3f35bf35,0xbec4bf6d,0xa7f7bf80,0xbf55bf0e,0xbf6d3ec4,0xbe483f7b
.long 0x27773f80,0x3f353f35,0x3f8026d4,0x3f35bf35,0x21b7bf80,0xbf0ebf55,0xbf6dbec4,0xbf7b3e48
.long 0x28423f80,0x3ec43f6d,0x3f353f35,0x3f6d3ec4,0xa804bf80,0xbe48bf7b,0xbec4bf6d,0xbf0ebf55
.long 0x80003f80,0x80003f80,0x80003f80,0x80003f80,0x3f35bf35,0x3f55bf0e,0x3f6dbec4,0x3f7bbe48
.long 0xbf8025b0,0xbf6dbec4,0xbf35bf35,0xbec4bf6d,0x3f353f35,0x3e483f7b,0xbec43f6d,0xbf553f0e
.long 0xa630bf80,0x3f35bf35,0x3f80a731,0x3f353f35,0xbf353f35,0xbf7bbe48,0xbec4bf6d,0x3f0ebf55
.long 0x3f80a742,0x3ec43f6d,0xbf353f35,0xbf6dbec4,0xbf35bf35,0x3f0ebf55,0x3f6d3ec4,0xbe483f7b
.long 0x26b03f80,0xbf80a60d,0xa7b1bf80,0x3f80a765,0x3f35bf35,0x3f0e3f55,0xbf6d3ec4,0xbe48bf7b
.long 0xbf80a58e,0x3ec4bf6d,0x3f353f35,0xbf6d3ec4,0x3f353f35,0xbf7b3e48,0x3ec4bf6d,0x3f0e3f55
.long 0xa7c2bf80,0x3f353f35,0xbf80258d,0x3f35bf35,0xbf353f35,0x3e48bf7b,0x3ec43f6d,0xbf55bf0e
.long 0x3f80a78d,0xbf6d3ec4,0x3f35bf35,0xbec43f6d,0xbf35bf35,0x3f553f0e,0xbf6dbec4,0x3f7b3e48
.long 0x27303f80,0x268dbf80,0x28313f80,0xa7e5bf80,0x3f35bf35,0xbf553f0e,0x3f6dbec4,0xbf7b3e48
.long 0xbf80268d,0x3f6d3ec4,0xbf35bf35,0x3ec43f6d,0x3f353f35,0xbe48bf7b,0xbec43f6d,0x3f55bf0e
.long 0x260ebf80,0xbf353f35,0x3f80270d,0xbf35bf35,0xbf353f35,0x3f7b3e48,0xbec4bf6d,0xbf0e3f55
.long 0x3f80a85d,0xbec4bf6d,0xbf353f35,0x3f6d3ec4,0xbf35bf35,0xbf0e3f55,0x3f6d3ec4,0x3e48bf7b
.long 0x28423f80,0x3f8026d4,0xa60dbf80,0xbf802730,0x3f35bf35,0xbf0ebf55,0xbf6d3ec4,0x3e483f7b
.long 0xbf80a7b1,0xbec43f6d,0x3f353f35,0x3f6dbec4,0x3f353f35,0x3f7bbe48,0x3ec4bf6d,0xbf0ebf55
.long 0xa80dbf80,0xbf35bf35,0xbf802754,0xbf353f35,0xbf353f35,0xbe483f7b,0x3ec43f6d,0x3f553f0e
.long 0x3f80a7e5,0x3f6dbec4,0x3f35bf35,0x3ec4bf6d,0xbf35bf35,0xbf55bf0e,0xbf6dbec4,0xbf7bbe48
.long 0x80003f80,0x80003f80,0x80003f80,0x80003f80,0x3f80a554,0x3f7b3e48,0x3f6d3ec4,0x3f553f0e
.long 0xa5d4bf80,0x3ec4bf6d,0x3f35bf35,0x3f6dbec4,0xbf80261f,0xbf55bf0e,0xbec4bf6d,0x3e48bf7b
.long 0x26543f80,0xbf353f35,0xbf80a68d,0xbf35bf35,0x3f80a742,0x3f0e3f55,0xbec43f6d,0xbf7b3e48
.long 0xa69fbf80,0x3f6dbec4,0x3f353f35,0xbec43f6d,0xbf80a60d,0xbe48bf7b,0x3f6dbec4,0x3f0e3f55
.long 0x26d43f80,0xbf80a58e,0x270dbf80,0x3f80a777,0x3f80a777,0xbe483f7b,0xbf6dbec4,0x3f0ebf55
.long 0xa7c2bf80,0x3f6d3ec4,0xbf353f35,0xbec4bf6d,0xbf802804,0x3f0ebf55,0x3ec43f6d,0xbf7bbe48
.long 0x271f3f80,0xbf35bf35,0x3f80a796,0xbf353f35,0x3f802754,0xbf553f0e,0x3ec4bf6d,0x3e483f7b
.long 0x268dbf80,0x3ec43f6d,0xbf35bf35,0x3f6d3ec4,0xbf802889,0x3f7bbe48,0xbf6d3ec4,0x3f55bf0e
.long 0x27543f80,0x260ebf80,0xa78d3f80,0xa7f7bf80,0x3f802828,0xbf7bbe48,0x3f6d3ec4,0xbf55bf0e
.long 0xa7f7bf80,0xbec43f6d,0x3f35bf35,0xbf6d3ec4,0xbf80281f,0x3f553f0e,0xbec4bf6d,0xbe483f7b
.long 0x28423f80,0x3f35bf35,0xbf802828,0x3f353f35,0x3f8026d4,0xbf0ebf55,0xbec43f6d,0x3f7bbe48
.long 0xa884bf80,0xbf6d3ec4,0x3f353f35,0x3ec4bf6d,0xbf802730,0x3e483f7b,0x3f6dbec4,0xbf0ebf55
.long 0x279f3f80,0x3f80a7e5,0xa816bf80,0xbf802839,0x3f80a7e5,0x3e48bf7b,0xbf6dbec4,0xbf0e3f55
.long 0x27d4bf80,0xbf6dbec4,0xbf353f35,0x3ec43f6d,0xbf802839,0xbf0e3f55,0x3ec43f6d,0x3f7b3e48
.long 0xa70d3f80,0x3f353f35,0x3f80a804,0x3f35bf35,0x3f80a880,0x3f55bf0e,0x3ec4bf6d,0xbe48bf7b
.long 0xa909bf80,0xbec4bf6d,0xbf35bf35,0xbf6dbec4,0xbf8028a3,0xbf7b3e48,0xbf6d3ec4,0xbf553f0e
.long 0x80003f80,0x80003f80,0x80003f80,0x80003f80,0x3f353f35,0x3f0e3f55,0x3ec43f6d,0x3e483f7b
.long 0x3f80a5f7,0x3f6d3ec4,0x3f353f35,0x3ec43f6d,0x3f35bf35,0x3f7bbe48,0x3f6d3ec4,0x3f0e3f55
.long 0xa677bf80,0x3f35bf35,0x3f80a742,0x3f353f35,0xbf35bf35,0x3e48bf7b,0x3f6dbec4,0x3f553f0e
.long 0xbf80a60d,0xbec4bf6d,0x3f35bf35,0x3f6d3ec4,0xbf353f35,0xbf55bf0e,0x3ec4bf6d,0x3f7b3e48
.long 0x26f73f80,0xbf80a137,0xa7c2bf80,0x3f80a784,0x3f353f35,0xbf553f0e,0xbec4bf6d,0x3f7bbe48
.long 0x3f80a78d,0xbec43f6d,0xbf35bf35,0x3f6dbec4,0x3f35bf35,0x3e483f7b,0xbf6dbec4,0x3f55bf0e
.long 0x268dbf80,0x3f353f35,0xbf80268d,0x3f35bf35,0xbf35bf35,0x3f7b3e48,0xbf6d3ec4,0x3f0ebf55
.long 0xbf802816,0x3f6dbec4,0xbf353f35,0x3ec4bf6d,0xbf353f35,0x3f0ebf55,0xbec43f6d,0x3e48bf7b
.long 0x27773f80,0x21b7bf80,0x28423f80,0xa804bf80,0x3f353f35,0xbf0ebf55,0x3ec43f6d,0xbe48bf7b
.long 0x3f8026d4,0xbf6dbec4,0x3f353f35,0xbec4bf6d,0x3f35bf35,0xbf7b3e48,0x3f6d3ec4,0xbf0ebf55
.long 0xa80dbf80,0xbf353f35,0x3f80a7e5,0xbf35bf35,0xbf35bf35,0xbe483f7b,0x3f6dbec4,0xbf55bf0e
.long 0xbf80289a,0x3ec43f6d,0x3f35bf35,0xbf6dbec4,0xbf353f35,0x3f553f0e,0x3ec4bf6d,0xbf7bbe48
.long 0xa70d3f80,0x3f80a880,0xa70dbf80,0xbf8028a3,0x3f353f35,0x3f55bf0e,0xbec4bf6d,0xbf7b3e48
.long 0x3f8028be,0x3ec4bf6d,0xbf35bf35,0xbf6d3ec4,0x3f35bf35,0xbe48bf7b,0xbf6dbec4,0xbf553f0e
.long 0xa896bf80,0xbf35bf35,0xbf80a731,0xbf353f35,0xbf35bf35,0xbf7bbe48,0xbf6d3ec4,0xbf0e3f55
.long 0xbf8028ea,0xbf6d3ec4,0xbf353f35,0xbec43f6d,0xbf353f35,0xbf0e3f55,0xbec43f6d,0xbe483f7b
PF_END:
.p2align 8
T_P1:
.long 0x3f803f80,0x3f803f80,0x3f803f80,0x3f803f80,0x3f7b3f80,0x3f553f6d,0x3f0e3f35,0x3e483ec4
.long 0x3f6d3f80,0x3ec43f35,0xbec4248d,0xbf6dbf35,0x3f553f80,0xbe483ec4,0xbf7bbf35,0xbf0ebf6d
.long 0x3f353f80,0xbf35248d,0xbf35bf80,0x3f35a554,0x3f0e3f80,0xbf7bbec4,0x3e48bf35,0x3f553f6d
.long 0x3ec43f80,0xbf6dbf35,0x3f6da554,0xbec43f35,0x3e483f80,0xbf0ebf6d,0x3f553f35,0xbf7bbec4
.long 0x248d3f80,0xa554bf80,0x25b03f80,0xa5f7bf80,0xbe483f80,0x3f0ebf6d,0xbf553f35,0x3f7bbec4
.long 0xbec43f80,0x3f6dbf35,0xbf6d25b0,0x3ec43f35,0xbf0e3f80,0x3f7bbec4,0xbe48bf35,0xbf553f6d
.long 0xbf353f80,0x3f35a554,0x3f35bf80,0xbf35261f,0xbf553f80,0x3e483ec4,0x3f7bbf35,0x3f0ebf6d
.long 0xbf6d3f80,0xbec43f35,0x3ec4a5f7,0x3f6dbf35,0xbf7b3f80,0xbf553f6d,0xbf0e3f35,0xbe483ec4
.long 0xbf803f80,0xbf803f80,0xbf803f80,0xbf803f80,0xbf7b3f80,0xbf553f6d,0xbf0e3f35,0xbe483ec4
.long 0xbf6d3f80,0xbec43f35,0x3ec4261f,0x3f6dbf35,0xbf553f80,0x3e483ec4,0x3f7bbf35,0x3f0ebf6d
.long 0xbf353f80,0x3f3525b0,0x3f35bf80,0xbf35a742,0xbf0e3f80,0x3f7bbec4,0xbe48bf35,0xbf553f6d
.long 0xbec43f80,0x3f6dbf35,0xbf6da731,0x3ec43f35,0xbe483f80,0x3f0ebf6d,0xbf553f35,0x3f7bbec4
.long 0xa5543f80,0x261fbf80,0xa7423f80,0xa60dbf80,0x3e483f80,0xbf0ebf6d,0x3f553f35,0xbf7bbec4
.long 0x3ec43f80,0xbf6dbf35,0x3f6da68d,0xbec43f35,0x3f0e3f80,0xbf7bbec4,0x3e48bf35,0x3f553f6d
.long 0x3f353f80,0xbf35a5f7,0xbf35bf80,0x3f35a60d,0x3f553f80,0xbe483ec4,0xbf7bbf35,0xbf0ebf6d
.long 0x3f6d3f80,0x3ec43f35,0xbec4a742,0xbf6dbf35,0x3f7b3f80,0x3f553f6d,0x3f0e3f35,0x3e483ec4
.long 0x3f803f80,0x3f803f80,0x3f803f80,0x3f803f80,0xbe48248d,0xbf0ebec4,0xbf55bf35,0xbf7bbf6d
.long 0xbf6dbf80,0xbec4bf35,0x3ec4a554,0x3f6d3f35,0x3f0ea554,0x3f7b3f6d,0x3e483f35,0xbf55bec4
.long 0x3f353f80,0xbf3525b0,0xbf35bf80,0x3f35a5f7,0xbf5525b0,0xbe48bf6d,0x3f7b3f35,0xbf0e3ec4
.long 0xbec4bf80,0x3f6d3f35,0xbf6d261f,0x3ec4bf35,0x3f7ba5f7,0xbf553ec4,0x3f0ebf35,0xbe483f6d
.long 0x261f3f80,0xa731bf80,0xa68d3f80,0xa742bf80,0xbf7b261f,0x3f553ec4,0xbf0ebf35,0x3e483f6d
.long 0x3ec4bf80,0xbf6d3f35,0x3f6da742,0xbec4bf35,0x3f55a731,0x3e48bf6d,0xbf7b3f35,0x3f0e3ec4
.long 0xbf353f80,0x3f35a742,0x3f35bf80,0xbf35a60d,0xbf0ea68d,0xbf7b3f6d,0xbe483f35,0x3f55bec4
.long 0x3f6dbf80,0x3ec4bf35,0xbec4a60d,0xbf6d3f35,0x3e48a742,0x3f0ebec4,0x3f55bf35,0x3f7bbf6d
.long 0xbf803f80,0xbf803f80,0xbf803f80,0xbf803f80,0x3e48a654,0x3f0ebec4,0x3f55bf35,0x3f7bbf6d
.long 0x3f6dbf80,0x3ec4bf35,0xbec4a777,0xbf6d3f35,0xbf0ea754,0xbf7b3f6d,0xbe483f35,0x3f55bec4
.long 0xbf353f80,0x3f35a58e,0x3f35bf80,0xbf35a78d,0x3f55a60d,0x3e48bf6d,0xbf7b3f35,0x3f0e3ec4
.long 0x3ec4bf80,0xbf6d3f35,0x3f6d258d,0xbec4bf35,0xbf7ba765,0x3f553ec4,0xbf0ebf35,0x3e483f6d
.long 0xa7773f80,0x2804bf80,0x27543f80,0x2889bf80,0x3f7ba58e,0xbf553ec4,0x3f0ebf35,0xbe483f6d
.long 0xbec4bf80,0x3f6d3f35,0xbf6da796,0x3ec4bf35,0xbf55a777,0xbe48bf6d,0x3f7b3f35,0xbf0e3ec4
.long 0x3f353f80,0xbf35a78d,0xbf35bf80,0x3f352816,0x3f0ea137,0x3f7b3f6d,0x3e483f35,0xbf55bec4
.long 0xbf6dbf80,0xbec4bf35,0x3ec4268d,0x3f6d3f35,0xbe48a784,0xbf0ebec4,0xbf55bf35,0xbf7bbf6d
.long 0x3f803f80,0x3f803f80,0x3f803f80,0x3f803f80,0xbf7bbf80,0xbf55bf6d,0xbf0ebf35,0xbe48bec4
.long 0x3f6d3f80,0x3ec43f35,0xbec425b0,0xbf6dbf35,0xbf55bf80,0x3e48bec4,0x3f7b3f35,0x3f0e3f6d
.long 0x3f353f80,0xbf35261f,0xbf35bf80,0x3f35a731,0xbf0ebf80,0x3f7b3ec4,0xbe483f35,0xbf55bf6d
.long 0x3ec43f80,0xbf6dbf35,0x3f6da742,0xbec43f35,0xbe48bf80,0x3f0e3f6d,0xbf55bf35,0x3f7b3ec4
.long 0xa6543f80,0xa754bf80,0xa60d3f80,0xa765bf80,0x3e48bf80,0xbf0e3f6d,0x3f55bf35,0xbf7b3ec4
.long 0xbec43f80,0x3f6dbf35,0xbf6da58e,0x3ec43f35,0x3f0ebf80,0xbf7b3ec4,0x3e483f35,0x3f55bf6d
.long 0xbf353f80,0x3f35a777,0x3f35bf80,0xbf352804,0x3f55bf80,0xbe48bec4,0xbf7b3f35,0xbf0e3f6d
.long 0xbf6d3f80,0xbec43f35,0x3ec4a78d,0x3f6dbf35,0x3f7bbf80,0x3f55bf6d,0x3f0ebf35,0x3e48bec4
.long 0xbf803f80,0xbf803f80,0xbf803f80,0xbf803f80,0x3f7bbf80,0x3f55bf6d,0x3f0ebf35,0x3e48bec4
.long 0xbf6d3f80,0xbec43f35,0x3ec4268d,0x3f6dbf35,0x3f55bf80,0xbe48bec4,0xbf7b3f35,0xbf0e3f6d
.long 0xbf353f80,0x3f35268d,0x3f35bf80,0xbf35a85d,0x3f0ebf80,0xbf7b3ec4,0x3e483f35,0x3f55bf6d
.long 0xbec43f80,0x3f6dbf35,0xbf6d270d,0x3ec43f35,0x3e48bf80,0xbf0e3f6d,0x3f55bf35,0xbf7b3ec4
.long 0x28283f80,0x281fbf80,0x26d43f80,0x2730bf80,0xbe48bf80,0x3f0e3f6d,0xbf55bf35,0x3f7b3ec4
.long 0x3ec43f80,0xbf6dbf35,0x3f6d2828,0xbec43f35,0xbf0ebf80,0x3f7b3ec4,0xbe483f35,0xbf55bf6d
.long 0x3f353f80,0xbf3526d4,0xbf35bf80,0x3f35289a,0xbf55bf80,0x3e48bec4,0x3f7b3f35,0x3f0e3f6d
.long 0x3f6d3f80,0x3ec43f35,0xbec4a7e5,0xbf6dbf35,0xbf7bbf80,0xbf55bf6d,0xbf0ebf35,0xbe48bec4
.long 0x3f803f80,0x3f803f80,0x3f803f80,0x3f803f80,0x3e48a554,0x3f0e3ec4,0x3f553f35,0x3f7b3f6d
.long 0xbf6dbf80,0xbec4bf35,0x3ec4a5f7,0x3f6d3f35,0xbf0e261f,0xbf7bbf6d,0xbe48bf35,0x3f553ec4
.long 0x3f353f80,0xbf35a68d,0xbf35bf80,0x3f35a742,0x3f55a742,0x3e483f6d,0xbf7bbf35,0x3f0ebec4
.long 0xbec4bf80,0x3f6d3f35,0xbf6da60d,0x3ec4bf35,0xbf7ba60d,0x3f55bec4,0xbf0e3f35,0x3e48bf6d
.long 0xa58e3f80,0xa777bf80,0xa1373f80,0xa784bf80,0x3f7ba777,0xbf55bec4,0x3f0e3f35,0xbe48bf6d
.long 0x3ec4bf80,0xbf6d3f35,0x3f6da78d,0xbec4bf35,0xbf55258d,0xbe483f6d,0x3f7bbf35,0xbf0ebec4
.long 0xbf353f80,0x3f352754,0x3f35bf80,0xbf352889,0x3f0ea796,0x3f7bbf6d,0x3e48bf35,0xbf553ec4
.long 0x3f6dbf80,0x3ec4bf35,0xbec42816,0xbf6d3f35,0xbe48268d,0xbf0e3ec4,0xbf553f35,0xbf7b3f6d
.long 0xbf803f80,0xbf803f80,0xbf803f80,0xbf803f80,0xbe48a7b1,0xbf0e3ec4,0xbf553f35,0xbf7b3f6d
.long 0x3f6dbf80,0x3ec4bf35,0xbec426d4,0xbf6d3f35,0x3f0e281f,0x3f7bbf6d,0x3e48bf35,0xbf553ec4
.long 0xbf353f80,0x3f35a7b1,0x3f35bf80,0xbf35a7e5,0xbf5526d4,0xbe483f6d,0x3f7bbf35,0xbf0ebec4
.long 0x3ec4bf80,0xbf6d3f35,0x3f6d2754,0xbec4bf35,0x3f7b2730,0xbf55bec4,0x3f0e3f35,0xbe48bf6d
.long 0xa7e53f80,0x2839bf80,0xa8803f80,0x28a3bf80,0xbf7ba7e5,0x3f55bec4,0xbf0e3f35,0x3e48bf6d
.long 0xbec4bf80,0x3f6d3f35,0xbf6da804,0x3ec4bf35,0x3f552839,0x3e483f6d,0xbf7bbf35,0x3f0ebec4
.long 0x3f353f80,0xbf3528be,0xbf35bf80,0x3f3528ea,0xbf0ea880,0xbf7bbf6d,0xbe48bf35,0x3f553ec4
.long 0xbf6dbf80,0xbec4bf35,0x3ec4a731,0x3f6d3f35,0x3e4828a3,0x3f0e3ec4,0x3f553f35,0x3f7b3f6d
.long 0x80008000,0x80008000,0x80008000,0x80008000,0xbe488000,0xbf0ebec4,0xbf55bf35,0xbf7bbf6d
.long 0xbec48000,0xbf6dbf35,0xbf6dbf80,0xbec4bf35,0xbf0e8000,0xbf7bbf6d,0xbe48bf35,0x3f553ec4
.long 0xbf358000,0xbf35bf80,0x3f35a50d,0x3f353f80,0xbf558000,0xbe48bf6d,0x3f7b3f35,0xbf0e3ec4
.long 0xbf6d8000,0x3ec4bf35,0x3ec43f80,0xbf6dbf35,0xbf7b8000,0x3f55bec4,0xbf0e3f35,0x3e48bf6d
.long 0xbf808000,0x3f80a50d,0xbf80258d,0x3f80a5d4,0xbf7b8000,0x3f553ec4,0xbf0ebf35,0x3e483f6d
.long 0xbf6d8000,0x3ec43f35,0x3ec4bf80,0xbf6d3f35,0xbf558000,0xbe483f6d,0x3f7bbf35,0xbf0ebec4
.long 0xbf358000,0xbf353f80,0x3f35a5d4,0x3f35bf80,0xbf0e8000,0xbf7b3f6d,0xbe483f35,0x3f55bec4
.long 0xbec48000,0xbf6d3f35,0xbf6d3f80,0xbec43f35,0xbe488000,0xbf0e3ec4,0xbf553f35,0xbf7b3f6d
.long 0xa50d8000,0xa5d4258d,0xa630260d,0xa6772654,0x3e488000,0x3f0ebec4,0x3f55bf35,0x3f7bbf6d
.long 0x3ec48000,0x3f6dbf35,0x3f6dbf80,0x3ec4bf35,0x3f0e8000,0x3f7bbf6d,0x3e48bf35,0xbf553ec4
.long 0x3f358000,0x3f35bf80,0xbf35a630,0xbf353f80,0x3f558000,0x3e48bf6d,0xbf7b3f35,0x3f0e3ec4
.long 0x3f6d8000,0xbec4bf35,0xbec43f80,0x3f6dbf35,0x3f7b8000,0xbf55bec4,0x3f0e3f35,0xbe48bf6d
.long 0x3f808000,0xbf80a5d4,0x3f802654,0xbf80a69f,0x3f7b8000,0xbf553ec4,0x3f0ebf35,0xbe483f6d
.long 0x3f6d8000,0xbec43f35,0xbec4bf80,0x3f6d3f35,0x3f558000,0x3e483f6d,0xbf7bbf35,0x3f0ebec4
.long 0x3f358000,0x3f353f80,0xbf35a677,0xbf35bf80,0x3f0e8000,0x3f7b3f6d,0x3e483f35,0xbf55bec4
.long 0x3ec48000,0x3f6d3f35,0x3f6d3f80,0x3ec43f35,0x3e488000,0x3f0e3ec4,0x3f553f35,0x3f7b3f6d
.long 0x80008000,0x80008000,0x80008000,0x80008000,0xbf7bbf80,0xbf55bf6d,0xbf0ebf35,0xbe48bec4
.long 0x3ec4a50d,0x3f6d3f35,0x3f6d3f80,0x3ec43f35,0x3f553f80,0xbe483ec4,0xbf7bbf35,0xbf0ebf6d
.long 0xbf35258d,0xbf35bf80,0x3f35a5d4,0x3f353f80,0xbf0ebf80,0x3f7b3ec4,0xbe483f35,0xbf55bf6d
.long 0x3f6da5d4,0xbec43f35,0xbec4bf80,0x3f6d3f35,0x3e483f80,0xbf0ebf6d,0x3f553f35,0xbf7bbec4
.long 0xbf80260d,0x3f80a630,0xbf802654,0x3f80a677,0x3e48bf80,0xbf0e3f6d,0x3f55bf35,0xbf7b3ec4
.long 0x3f6da630,0xbec4bf35,0xbec43f80,0x3f6dbf35,0xbf0e3f80,0x3f7bbec4,0xbe48bf35,0xbf553f6d
.long 0xbf352654,0xbf353f80,0x3f35a69f,0x3f35bf80,0x3f55bf80,0xbe48bec4,0xbf7b3f35,0xbf0e3f6d
.long 0x3ec4a677,0x3f6dbf35,0x3f6dbf80,0x3ec4bf35,0xbf7b3f80,0xbf553f6d,0xbf0e3f35,0xbe483ec4
.long 0xa69f268d,0xa7b126b0,0x270d26d4,0xa7c226f7,0x3f7bbf80,0x3f55bf6d,0x3f0ebf35,0x3e48bec4
.long 0xbec4a69f,0xbf6d3f35,0xbf6d3f80,0xbec43f35,0xbf553f80,0x3e483ec4,0x3f7bbf35,0x3f0ebf6d
.long 0x3f3526b0,0x3f35bf80,0xbf35a7c2,0xbf353f80,0x3f0ebf80,0xbf7b3ec4,0x3e483f35,0x3f55bf6d
.long 0xbf6da7b1,0x3ec43f35,0x3ec4bf80,0xbf6d3f35,0xbe483f80,0x3f0ebf6d,0xbf553f35,0x3f7bbec4
.long 0x3f8026d4,0xbf80a7c2,0x3f80271f,0xbf80268d,0xbe48bf80,0x3f0e3f6d,0xbf55bf35,0x3f7b3ec4
.long 0xbf6d270d,0x3ec4bf35,0x3ec43f80,0xbf6dbf35,0x3f0e3f80,0xbf7bbec4,0x3e48bf35,0x3f553f6d
.long 0x3f3526f7,0x3f353f80,0xbf35268d,0xbf35bf80,0xbf55bf80,0x3e48bec4,0x3f7b3f35,0x3f0e3f6d
.long 0xbec4a7c2,0xbf6dbf35,0xbf6dbf80,0xbec4bf35,0x3f7b3f80,0x3f553f6d,0x3f0e3f35,0x3e483ec4
.long 0x80008000,0x80008000,0x80008000,0x80008000,0x3e48a50d,0x3f0e3ec4,0x3f553f35,0x3f7b3f6d
.long 0xbec4258d,0xbf6dbf35,0xbf6dbf80,0xbec4bf35,0x3f0ea5d4,0x3f7b3f6d,0x3e483f35,0xbf55bec4
.long 0xbf35260d,0xbf35bf80,0x3f35a630,0x3f353f80,0x3f55a630,0x3e483f6d,0xbf7bbf35,0x3f0ebec4
.long 0xbf6d2654,0x3ec4bf35,0x3ec43f80,0xbf6dbf35,0x3f7ba677,0xbf553ec4,0x3f0ebf35,0xbe483f6d
.long 0xbf80268d,0x3f80a69f,0xbf8026b0,0x3f80a7b1,0x3f7ba69f,0xbf55bec4,0x3f0e3f35,0xbe48bf6d
.long 0xbf6d26b0,0x3ec43f35,0x3ec4bf80,0xbf6d3f35,0x3f55a7b1,0x3e48bf6d,0xbf7b3f35,0x3f0e3ec4
.long 0xbf3526d4,0xbf353f80,0x3f35a7c2,0x3f35bf80,0x3f0e270d,0x3f7bbf6d,0x3e48bf35,0xbf553ec4
.long 0xbec426f7,0xbf6d3f35,0xbf6d3f80,0xbec43f35,0x3e48a7c2,0x3f0ebec4,0x3f55bf35,0x3f7bbf6d
.long 0x26d4270d,0xa7d4271f,0x268d2730,0xa7e52831,0xbe4826d4,0xbf0e3ec4,0xbf553f35,0xbf7b3f6d
.long 0x3ec4271f,0x3f6dbf35,0x3f6dbf80,0x3ec4bf35,0xbf0ea7d4,0xbf7b3f6d,0xbe483f35,0x3f55bec4
.long 0x3f352730,0x3f35bf80,0xbf35260e,0xbf353f80,0xbf55268d,0xbe483f6d,0x3f7bbf35,0xbf0ebec4
.long 0x3f6d2831,0xbec4bf35,0xbec43f80,0x3f6dbf35,0xbf7ba7e5,0x3f553ec4,0xbf0ebf35,0x3e483f6d
.long 0x3f802754,0xbf80a7f7,0x3f802842,0xbf80a884,0xbf7b260e,0x3f55bec4,0xbf0e3f35,0x3e48bf6d
.long 0x3f6da78d,0xbec43f35,0xbec4bf80,0x3f6d3f35,0xbf55a7f7,0xbe48bf6d,0x3f7b3f35,0xbf0e3ec4
.long 0x3f352777,0x3f353f80,0xbf35a80d,0xbf35bf80,0xbf0e21b7,0xbf7bbf6d,0xbe48bf35,0x3f553ec4
.long 0x3ec42842,0x3f6d3f35,0x3f6d3f80,0x3ec43f35,0xbe48a804,0xbf0ebec4,0xbf55bf35,0xbf7bbf6d
.long 0x80008000,0x80008000,0x80008000,0x80008000,0x3f7b3f80,0x3f553f6d,0x3f0e3f35,0x3e483ec4
.long 0x3ec4a5d4,0x3f6d3f35,0x3f6d3f80,0x3ec43f35,0xbf55bf80,0x3e48bec4,0x3f7b3f35,0x3f0e3f6d
.long 0xbf352654,0xbf35bf80,0x3f35a677,0x3f353f80,0x3f0e3f80,0xbf7bbec4,0x3e48bf35,0x3f553f6d
.long 0x3f6da69f,0xbec43f35,0xbec4bf80,0x3f6d3f35,0xbe48bf80,0x3f0e3f6d,0xbf55bf35,0x3f7b3ec4
.long 0xbf8026d4,0x3f80270d,0xbf8026f7,0x3f80a7c2,0xbe483f80,0x3f0ebf6d,0xbf553f35,0x3f7bbec4
.long 0x3f6da7c2,0xbec4bf35,0xbec43f80,0x3f6dbf35,0x3f0ebf80,0xbf7b3ec4,0x3e483f35,0x3f55bf6d
.long 0xbf35271f,0xbf353f80,0x3f35268d,0x3f35bf80,0xbf553f80,0x3e483ec4,0x3f7bbf35,0x3f0ebf6d
.long 0x3ec4268d,0x3f6dbf35,0x3f6dbf80,0x3ec4bf35,0x3f7bbf80,0x3f55bf6d,0x3f0ebf35,0x3e48bec4
.long 0x260e2754,0xa7f7a78d,0x21b72777,0xa8042842,0xbf7b3f80,0xbf553f6d,0xbf0e3f35,0xbe483ec4
.long 0xbec4a7f7,0xbf6d3f35,0xbf6d3f80,0xbec43f35,0x3f55bf80,0xbe48bec4,0xbf7b3f35,0xbf0e3f6d
.long 0x3f352842,0x3f35bf80,0xbf35a80d,0xbf353f80,0xbf0e3f80,0x3f7bbec4,0xbe48bf35,0xbf553f6d
.long 0xbf6da60d,0x3ec43f35,0x3ec4bf80,0xbf6d3f35,0x3e48bf80,0xbf0e3f6d,0x3f55bf35,0xbf7b3ec4
.long 0x3f80279f,0xbf8027d4,0x3f80a70d,0xbf80a909,0x3e483f80,0xbf0ebf6d,0x3f553f35,0xbf7bbec4
.long 0xbf6da816,0x3ec4bf35,0x3ec43f80,0xbf6dbf35,0xbf0ebf80,0x3f7b3ec4,0xbe483f35,0xbf55bf6d
.long 0x3f35a70d,0x3f353f80,0xbf35a896,0xbf35bf80,0x3f553f80,0xbe483ec4,0xbf7bbf35,0xbf0ebf6d
.long 0xbec4a70d,0xbf6dbf35,0xbf6dbf80,0xbec4bf35,0xbf7bbf80,0xbf55bf6d,0xbf0ebf35,0xbe48bec4
.long 0x3f800000,0x3f800000,0x3f800000,0x3f800000,0x3f800000,0x3f7ffcd7,0x3f7ff35e,0x3f7fe394
.long 0x3f800000,0x3f7ff35e,0x3f7fcd79,0x3f7f8e56,0x3f800000,0x3f7fe394,0x3f7f8e56,0x3f7f0059
.long 0x3f800000,0x3f7fcd79,0x3f7f35f9,0x3f7e39bc,0x3f800000,0x3f7fb10f,0x3f7ec46d,0x3f7d3aac
.long 0x3f800000,0x3f7f8e56,0x3f7e39bc,0x3f7c0361,0x3f800000,0x3f7f654e,0x3f7d95f4,0x3f7a9421
.long 0x3f800000,0x3f7f35f9,0x3f7cd925,0x3f78ed3c,0x3f800000,0x3f7f0059,0x3f7c0361,0x3f770f11
.long 0x3f800000,0x3f7ec46d,0x3f7b14be,0x3f74fa0b,0x3f800000,0x3f7e8238,0x3f7a0d54,0x3f72ae9e
.long 0x3f800000,0x3f7e39bc,0x3f78ed3c,0x3f702d4f,0x3f800000,0x3f7deafa,0x3f77b493,0x3f6d76aa
.long 0x3f800000,0x3f7d95f4,0x3f766377,0x3f6a8b4b,0x3f800000,0x3f7d3aac,0x3f74fa0b,0x3f676bd8
.long 0x3f800000,0x3f7cd925,0x3f737871,0x3f641901,0x3f800000,0x3f7c7160,0x3f71decf,0x3f609384
.long 0x3f800000,0x3f7c0361,0x3f702d4f,0x3f5cdc29,0x3f800000,0x3f7b8f2a,0x3f6e641a,0x3f58f3c4
.long 0x3f800000,0x3f7b14be,0x3f6c835e,0x3f54db31,0x3f800000,0x3f7a9421,0x3f6a8b4b,0x3f50935b
.long 0x3f800000,0x3f7a0d54,0x3f687c12,0x3f4c1d35,0x3f800000,0x3f79805c,0x3f6655e7,0x3f4779bc
.long 0x3f800000,0x3f78ed3c,0x3f641901,0x3f42a9f7,0x3f800000,0x3f7853f8,0x3f61c598,0x3f3daef9
.long 0x3f800000,0x3f77b493,0x3f5f5be6,0x3f3889dc,0x3f800000,0x3f770f11,0x3f5cdc29,0x3f333bc6
.long 0x3f800000,0x3f766377,0x3f5a46a0,0x3f2dc5e3,0x3f800000,0x3f75b1c9,0x3f579b8c,0x3f28296a
.long 0x3f800000,0x3f74fa0b,0x3f54db31,0x3f226799,0x3f800000,0x3f743c41,0x3f5205d4,0x3f1c81b9
.long 0x3f800000,0x3f800000,0x3f800000,0x3f800000,0x3f7fcd79,0x3f7fb10f,0x3f7f8e56,0x3f7f654e
.long 0x3f7f35f9,0x3f7ec46d,0x3f7e39bc,0x3f7d95f4,0x3f7e39bc,0x3f7d3aac,0x3f7c0361,0x3f7a9421
.long 0x3f7cd925,0x3f7b14be,0x3f78ed3c,0x3f766377,0x3f7b14be,0x3f7853f8,0x3f74fa0b,0x3f710908
.long 0x3f78ed3c,0x3f74fa0b,0x3f702d4f,0x3f6a8b4b,0x3f766377,0x3f710908,0x3f6a8b4b,0x3f62f219
.long 0x3f737871,0x3f6c835e,0x3f641901,0x3f5a46a0,0x3f702d4f,0x3f676bd8,0x3f5cdc29,0x3f50935b
.long 0x3f6c835e,0x3f61c598,0x3f54db31,0x3f45e403,0x3f687c12,0x3f5b941a,0x3f4c1d35,0x3f3a4582
.long 0x3f641901,0x3f54db31,0x3f42a9f7,0x3f2dc5e3,0x3f5f5be6,0x3f4d9f02,0x3f3889dc,0x3f207440
.long 0x3f5a46a0,0x3f45e403,0x3f2dc5e3,0x3f1260b2,0x3f54db31,0x3f3daef9,0x3f226799,0x3f039c3d
.long 0x3f4f1bbd,0x3f3504f3,0x3f167918,0x3ee87171,0x3f490a88,0x3f2beb4a,0x3f0a04f8,0x3ec8917e
.long 0x3f42a9f7,0x3f226799,0x3efa2c90,0x3ea7bf25,0x3f3bfc8f,0x3f187fc0,0x3edf7108,0x3e862210
.long 0x3f3504f3,0x3f0e39da,0x3ec3ef15,0x3e47c5c2,0x3f2dc5e3,0x3f039c3d,0x3ea7bf25,0x3e0255f4
.long 0x3f26423a,0x3ef15aea,0x3e8afa3e,0x3d712283,0x3f1e7cf1,0x3edae880,0x3e5b73dc,0xbc20d8d2
.long 0x3f167918,0x3ec3ef15,0x3e20305b,0xbda0af2a,0x3f0e39da,0x3eac7cd4,0x3dc8bd36,0xbe164083
.long 0x3f05c277,0x3e94a031,0x3d20cee7,0xbe5b73dc,0x3efa2c90,0x3e78cfcc,0xbca0d6d6,0xbe8fcefe
.long 0x3ee87171,0x3e47c5c2,0xbda0af2a,0xbeb13641,0x3ed65a92,0x3e164083,0xbe0c4cf7,0xbed1c759
.long 0x3ec3ef15,0x3dc8bd36,0xbe47c5c2,0xbef15aea,0x3eb13641,0x3d48fb30,0xbe814693,0xbf07e565
.long 0x3f800000,0x3f800000,0x3f800000,0x3f800000,0x3f7f35f9,0x3f7f0059,0x3f7ec46d,0x3f7e8238
.long 0x3f7cd925,0x3f7c0361,0x3f7b14be,0x3f7a0d54,0x3f78ed3c,0x3f770f11,0x3f74fa0b,0x3f72ae9e
.long 0x3f737871,0x3f702d4f,0x3f6c835e,0x3f687c12,0x3f6c835e,0x3f676bd8,0x3f61c598,0x3f5b941a
.long 0x3f641901,0x3f5cdc29,0x3f54db31,0x3f4c1d35,0x3f5a46a0,0x3f50935b,0x3f45e403,0x3f3a4582
.long 0x3f4f1bbd,0x3f42a9f7,0x3f3504f3,0x3f26423a,0x3f42a9f7,0x3f333bc6,0x3f226799,0x3f104f0e
.long 0x3f3504f3,0x3f226799,0x3f0e39da,0x3ef15aea,0x3f26423a,0x3f104f0e,0x3ef15aea,0x3ebf47d7
.long 0x3f167918,0x3efa2c90,0x3ec3ef15,0x3e8afa3e,0x3f05c277,0x3ed1c759,0x3e94a031,0x3e2a1c3f
.long 0x3ee87171,0x3ea7bf25,0x3e47c5c2,0x3d712283,0x3ec3ef15,0x3e78cfcc,0x3dc8bd36,0xbd48fb30
.long 0x3e9e377a,0x3e20305b,0x248d3132,0xbe20305b,0x3e6f0c4d,0x3d8ca1f2,0xbdc8bd36,0xbe862210
.long 0x3e20305b,0xbca0d6d6,0xbe47c5c2,0xbeba9be1,0x3da0af2a,0xbddcbd0d,0xbe94a031,0xbeece91a
.long 0x248d3132,0xbe47c5c2,0xbec3ef15,0xbf0e39da,0xbda0af2a,0xbe8fcefe,0xbef15aea,0xbf2456f1
.long 0xbe20305b,0xbeba9be1,0xbf0e39da,0xbf3889dc,0xbe6f0c4d,0xbee3f40d,0xbf226799,0xbf4a965e
.long 0xbe9e377a,0xbf05c277,0xbf3504f3,0xbf5a46a0,0xbec3ef15,0xbf187fc0,0xbf45e403,0xbf676bd8
.long 0xbee87171,0xbf2a0c73,0xbf54db31,0xbf71decf,0xbf05c277,0xbf3a4582,0xbf61c598,0xbf79805c
.long 0xbf167918,0xbf490a88,0xbf6c835e,0xbf7e39bc,0xbf26423a,0xbf563e03,0xbf74fa0b,0xbf7ffcd7
.long 0xbf3504f3,0xbf61c598,0xbf7b14be,0xbf7ec46d,0xbf42a9f7,0xbf6b8a3d,0xbf7ec46d,0xbf7a9421
.long 0x3f800000,0x3f800000,0x3f800000,0x3f800000,0x3f7e39bc,0x3f7deafa,0x3f7d95f4,0x3f7d3aac
.long 0x3f78ed3c,0x3f77b493,0x3f766377,0x3f74fa0b,0x3f702d4f,0x3f6d76aa,0x3f6a8b4b,0x3f676bd8
.long 0x3f641901,0x3f5f5be6,0x3f5a46a0,0x3f54db31,0x3f54db31,0x3f4d9f02,0x3f45e403,0x3f3daef9
.long 0x3f42a9f7,0x3f3889dc,0x3f2dc5e3,0x3f226799,0x3f2dc5e3,0x3f207440,0x3f1260b2,0x3f039c3d
.long 0x3f167918,0x3f05c277,0x3ee87171,0x3ec3ef15,0x3efa2c90,0x3ed1c759,0x3ea7bf25,0x3e78cfcc
.long 0x3ec3ef15,0x3e94a031,0x3e47c5c2,0x3dc8bd36,0x3e8afa3e,0x3e2a1c3f,0x3d712283,0xbd48fb30
.long 0x3e20305b,0x3d20cee7,0xbda0af2a,0xbe47c5c2,0x3d20cee7,0xbdb4b86a,0xbe5b73dc,0xbeac7cd4
.long 0xbda0af2a,0xbe5b73dc,0xbeb13641,0xbef15aea,0xbe47c5c2,0xbeac7cd4,0xbef15aea,0xbf187fc0
.long 0xbe9e377a,0xbee87171,0xbf167918,0xbf3504f3,0xbed65a92,0xbf104f0e,0xbf316e2c,0xbf4d9f02
.long 0xbf05c277,0xbf2a0c73,0xbf490a88,0xbf61c598,0xbf1e7cf1,0xbf4105b8,0xbf5cdc29,0xbf710908
.long 0xbf3504f3,0xbf54db31,0xbf6c835e,0xbf7b14be,0xbf490a88,0xbf653a48,0xbf77b493,0xbf7fb10f
.long 0xbf5a46a0,0xbf71decf,0xbf7e39bc,0xbf7ec46d,0xbf687c12,0xbf7a9421,0xbf7ff35e,0xbf7853f8
.long 0xbf737871,0xbf7f35f9,0xbf7cd925,0xbf6c835e,0xbf7b14be,0xbf7fb10f,0xbf74fa0b,0xbf5b941a
.long 0xbf7f35f9,0xbf7c0361,0xbf687c12,0xbf45e403,0xbf7fcd79,0xbf743c41,0xbf579b8c,0xbf2beb4a
.long 0xbf7cd925,0xbf687c12,0xbf42a9f7,0xbf0e39da,0xbf766377,0xbf58f3c4,0xbf2a0c73,0xbedae880
.long 0xbf6c835e,0xbf45e403,0xbf0e39da,0xbe94a031,0xbf5f5be6,0xbf2f9c32,0xbedf7108,0xbe164083
.long 0x3f800000,0x3f800000,0x3f800000,0x3f800000,0x3f7cd925,0x3f7c7160,0x3f7c0361,0x3f7b8f2a
.long 0x3f737871,0x3f71decf,0x3f702d4f,0x3f6e641a,0x3f641901,0x3f609384,0x3f5cdc29,0x3f58f3c4
.long 0x3f4f1bbd,0x3f490a88,0x3f42a9f7,0x3f3bfc8f,0x3f3504f3,0x3f2beb4a,0x3f226799,0x3f187fc0
.long 0x3f167918,0x3f0a04f8,0x3efa2c90,0x3edf7108,0x3ee87171,0x3ec8917e,0x3ea7bf25,0x3e862210
.long 0x3e9e377a,0x3e6f0c4d,0x3e20305b,0x3da0af2a,0x3e20305b,0x3d8ca1f2,0xbca0d6d6,0xbddcbd0d
.long 0x248d3132,0xbdc8bd36,0xbe47c5c2,0xbe94a031,0xbe20305b,0xbe862210,0xbeba9be1,0xbeece91a
.long 0xbe9e377a,0xbed65a92,0xbf05c277,0xbf1e7cf1,0xbee87171,0xbf104f0e,0xbf2a0c73,0xbf4105b8
.long 0xbf167918,0xbf316e2c,0xbf490a88,0xbf5cdc29,0xbf3504f3,0xbf4d9f02,0xbf61c598,0xbf710908
.long 0xbf4f1bbd,0xbf641901,0xbf737871,0xbf7cd925,0xbf641901,0xbf743c41,0xbf7d95f4,0xbf7fe394
.long 0xbf737871,0xbf7d95f4,0xbf7fcd79,0xbf7a0d54,0xbf7cd925,0xbf7fe394,0xbf7a0d54,0xbf6b8a3d
.long 0xbf800000,0xbf7b14be,0xbf6c835e,0xbf54db31,0xbf7cd925,0xbf6f4ba8,0xbf579b8c,0xbf36c9a9
.long 0xbf737871,0xbf5cdc29,0xbf3bfc8f,0xbf1260b2,0xbf641901,0xbf444969,0xbf1a82a4,0xbed1c759
.long 0xbf4f1bbd,0xbf26423a,0xbee87171,0xbe6f0c4d,0xbf3504f3,0xbf039c3d,0xbe94a031,0xbd48fb30
.long 0xbf167918,0xbeba9be1,0xbdf0b772,0x3e0c4cf7,0xbee87171,0xbe519f65,0x3d712283,0x3ea2fd52
.long 0xbe9e377a,0xbd20cee7,0x3e6f0c4d,0x3efa2c90,0xbe20305b,0x3e0255f4,0x3ecd2ef3,0x3f2456f1
.long 0xa553c9ca,0x3e94a031,0x3f0e39da,0x3f45e403,0x3e20305b,0x3ee3f40d,0x3f316e2c,0x3f609384
.long 0x0,0x0,0x0,0x0,0x0,0x0,0x0,0x0
.long 0x0,0x0,0x0,0x0,0x0,0x0,0x0,0x0
.long 0x0,0x0,0x0,0x0,0x0,0x0,0x0,0x0
.long 0x0,0x0,0x0,0x0,0x0,0x0,0x0,0x0
.long 0x0,0x0,0x0,0x0,0x0,0x0,0x0,0x0
.long 0x0,0x0,0x0,0x0,0x0,0x0,0x0,0x0
.long 0x0,0x0,0x0,0x0,0x0,0x0,0x0,0x0
.long 0x0,0x0,0x0,0x0,0x0,0x0,0x0,0x0
.long 0x0,0x0,0x0,0x0,0x0,0x0,0x0,0x0
.long 0x0,0x0,0x0,0x0,0x0,0x0,0x0,0x0
.long 0x0,0x0,0x0,0x0,0x0,0x0,0x0,0x0
.long 0x0,0x0,0x0,0x0,0x0,0x0,0x0,0x0
.long 0x0,0x0,0x0,0x0,0x0,0x0,0x0,0x0
.long 0x0,0x0,0x0,0x0,0x0,0x0,0x0,0x0
.long 0x0,0x0,0x0,0x0,0x0,0x0,0x0,0x0
.long 0x0,0x0,0x0,0x0,0x0,0x0,0x0,0x0
.long 0x0,0x0,0x0,0x0,0x0,0x3c20d8d2,0x3ca0d6d6,0x3cf13d4c
.long 0x0,0x3ca0d6d6,0x3d20cee7,0x3d712283,0x0,0x3cf13d4c,0x3d712283,0x3db4b86a
.long 0x0,0x3d20cee7,0x3da0af2a,0x3df0b772,0x0,0x3d48fb30,0x3dc8bd36,0x3e164083
.long 0x0,0x3d712283,0x3df0b772,0x3e3403f1,0x0,0x3d8ca1f2,0x3e0c4cf7,0x3e519f65
.long 0x0,0x3da0af2a,0x3e20305b,0x3e6f0c4d,0x0,0x3db4b86a,0x3e3403f1,0x3e862210
.long 0x0,0x3dc8bd36,0x3e47c5c2,0x3e94a031,0x0,0x3ddcbd0d,0x3e5b73dc,0x3ea2fd52
.long 0x0,0x3df0b772,0x3e6f0c4d,0x3eb13641,0x0,0x3e0255f4,0x3e814693,0x3ebf47d7
.long 0x0,0x3e0c4cf7,0x3e8afa3e,0x3ecd2ef3,0x0,0x3e164083,0x3e94a031,0x3edae880
.long 0x0,0x3e20305b,0x3e9e377a,0x3ee87171,0x0,0x3e2a1c3f,0x3ea7bf25,0x3ef5c6c5
.long 0x0,0x3e3403f1,0x3eb13641,0x3f0172c3,0x0,0x3e3de731,0x3eba9be1,0x3f07e565
.long 0x0,0x3e47c5c2,0x3ec3ef15,0x3f0e39da,0x0,0x3e519f65,0x3ecd2ef3,0x3f146eba
.long 0x0,0x3e5b73dc,0x3ed65a92,0x3f1a82a4,0x0,0x3e6542e9,0x3edf7108,0x3f207440
.long 0x0,0x3e6f0c4d,0x3ee87171,0x3f26423a,0x0,0x3e78cfcc,0x3ef15aea,0x3f2beb4a
.long 0x0,0x3e814693,0x3efa2c90,0x3f316e2c,0x0,0x3e862210,0x3f0172c3,0x3f36c9a9
.long 0x0,0x3e8afa3e,0x3f05c277,0x3f3bfc8f,0x0,0x3e8fcefe,0x3f0a04f8,0x3f4105b8
.long 0x0,0x3e94a031,0x3f0e39da,0x3f45e403,0x0,0x3e996dba,0x3f1260b2,0x3f4a965e
.long 0x0,0x0,0x0,0x0,0x3d20cee7,0x3d48fb30,0x3d712283,0x3d8ca1f2
.long 0x3da0af2a,0x3dc8bd36,0x3df0b772,0x3e0c4cf7,0x3df0b772,0x3e164083,0x3e3403f1,0x3e519f65
.long 0x3e20305b,0x3e47c5c2,0x3e6f0c4d,0x3e8afa3e,0x3e47c5c2,0x3e78cfcc,0x3e94a031,0x3eac7cd4
.long 0x3e6f0c4d,0x3e94a031,0x3eb13641,0x3ecd2ef3,0x3e8afa3e,0x3eac7cd4,0x3ecd2ef3,0x3eece91a
.long 0x3e9e377a,0x3ec3ef15,0x3ee87171,0x3f05c277,0x3eb13641,0x3edae880,0x3f0172c3,0x3f146eba
.long 0x3ec3ef15,0x3ef15aea,0x3f0e39da,0x3f226799,0x3ed65a92,0x3f039c3d,0x3f1a82a4,0x3f2f9c32
.long 0x3ee87171,0x3f0e39da,0x3f26423a,0x3f3bfc8f,0x3efa2c90,0x3f187fc0,0x3f316e2c,0x3f4779bc
.long 0x3f05c277,0x3f226799,0x3f3bfc8f,0x3f5205d4,0x3f0e39da,0x3f2beb4a,0x3f45e403,0x3f5b941a
.long 0x3f167918,0x3f3504f3,0x3f4f1bbd,0x3f641901,0x3f1e7cf1,0x3f3daef9,0x3f579b8c,0x3f6b8a3d
.long 0x3f26423a,0x3f45e403,0x3f5f5be6,0x3f71decf,0x3f2dc5e3,0x3f4d9f02,0x3f6655e7,0x3f770f11
.long 0x3f3504f3,0x3f54db31,0x3f6c835e,0x3f7b14be,0x3f3bfc8f,0x3f5b941a,0x3f71decf,0x3f7deafa
.long 0x3f42a9f7,0x3f61c598,0x3f766377,0x3f7f8e56,0x3f490a88,0x3f676bd8,0x3f7a0d54,0x3f7ffcd7
.long 0x3f4f1bbd,0x3f6c835e,0x3f7cd925,0x3f7f35f9,0x3f54db31,0x3f710908,0x3f7ec46d,0x3f7d3aac
.long 0x3f5a46a0,0x3f74fa0b,0x3f7fcd79,0x3f7a0d54,0x3f5f5be6,0x3f7853f8,0x3f7ff35e,0x3f75b1c9
.long 0x3f641901,0x3f7b14be,0x3f7f35f9,0x3f702d4f,0x3f687c12,0x3f7d3aac,0x3f7d95f4,0x3f698690
.long 0x3f6c835e,0x3f7ec46d,0x3f7b14be,0x3f61c598,0x3f702d4f,0x3f7fb10f,0x3f77b493,0x3f58f3c4
.long 0x0,0x0,0x0,0x0,0x3da0af2a,0x3db4b86a,0x3dc8bd36,0x3ddcbd0d
.long 0x3e20305b,0x3e3403f1,0x3e47c5c2,0x3e5b73dc,0x3e6f0c4d,0x3e862210,0x3e94a031,0x3ea2fd52
.long 0x3e9e377a,0x3eb13641,0x3ec3ef15,0x3ed65a92,0x3ec3ef15,0x3edae880,0x3ef15aea,0x3f039c3d
.long 0x3ee87171,0x3f0172c3,0x3f0e39da,0x3f1a82a4,0x3f05c277,0x3f146eba,0x3f226799,0x3f2f9c32
.long 0x3f167918,0x3f26423a,0x3f3504f3,0x3f42a9f7,0x3f26423a,0x3f36c9a9,0x3f45e403,0x3f53731f
.long 0x3f3504f3,0x3f45e403,0x3f54db31,0x3f61c598,0x3f42a9f7,0x3f53731f,0x3f61c598,0x3f6d76aa
.long 0x3f4f1bbd,0x3f5f5be6,0x3f6c835e,0x3f766377,0x3f5a46a0,0x3f698690,0x3f74fa0b,0x3f7c7160
.long 0x3f641901,0x3f71decf,0x3f7b14be,0x3f7f8e56,0x3f6c835e,0x3f7853f8,0x3f7ec46d,0x3f7fb10f
.long 0x3f737871,0x3f7cd925,0x3f800000,0x3f7cd925,0x3f78ed3c,0x3f7f654e,0x3f7ec46d,0x3f770f11
.long 0x3f7cd925,0x3f7ff35e,0x3f7b14be,0x3f6e641a,0x3f7f35f9,0x3f7e8238,0x3f74fa0b,0x3f62f219
.long 0x3f800000,0x3f7b14be,0x3f6c835e,0x3f54db31,0x3f7f35f9,0x3f75b1c9,0x3f61c598,0x3f444969
.long 0x3f7cd925,0x3f6e641a,0x3f54db31,0x3f316e2c,0x3f78ed3c,0x3f653a48,0x3f45e403,0x3f1c81b9
.long 0x3f737871,0x3f5a46a0,0x3f3504f3,0x3f05c277,0x3f6c835e,0x3f4d9f02,0x3f226799,0x3edae880
.long 0x3f641901,0x3f3f5cb5,0x3f0e39da,0x3ea7bf25,0x3f5a46a0,0x3f2f9c32,0x3ef15aea,0x3e6542e9
.long 0x3f4f1bbd,0x3f1e7cf1,0x3ec3ef15,0x3df0b772,0x3f42a9f7,0x3f0c2124,0x3e94a031,0x3c20d8d2
.long 0x3f3504f3,0x3ef15aea,0x3e47c5c2,0xbdc8bd36,0x3f26423a,0x3ec8917e,0x3dc8bd36,0xbe519f65
.long 0x0,0x0,0x0,0x0,0x3df0b772,0x3e0255f4,0x3e0c4cf7,0x3e164083
.long 0x3e6f0c4d,0x3e814693,0x3e8afa3e,0x3e94a031,0x3eb13641,0x3ebf47d7,0x3ecd2ef3,0x3edae880
.long 0x3ee87171,0x3efa2c90,0x3f05c277,0x3f0e39da,0x3f0e39da,0x3f187fc0,0x3f226799,0x3f2beb4a
.long 0x3f26423a,0x3f316e2c,0x3f3bfc8f,0x3f45e403,0x3f3bfc8f,0x3f4779bc,0x3f5205d4,0x3f5b941a
.long 0x3f4f1bbd,0x3f5a46a0,0x3f641901,0x3f6c835e,0x3f5f5be6,0x3f698690,0x3f71decf,0x3f7853f8
.long 0x3f6c835e,0x3f74fa0b,0x3f7b14be,0x3f7ec46d,0x3f766377,0x3f7c7160,0x3f7f8e56,0x3f7fb10f
.long 0x3f7cd925,0x3f7fcd79,0x3f7f35f9,0x3f7b14be,0x3f7fcd79,0x3f7f0059,0x3f7a0d54,0x3f710908
.long 0x3f7f35f9,0x3f7a0d54,0x3f702d4f,0x3f61c598,0x3f7b14be,0x3f710908,0x3f61c598,0x3f4d9f02
.long 0x3f737871,0x3f641901,0x3f4f1bbd,0x3f3504f3,0x3f687c12,0x3f53731f,0x3f3889dc,0x3f187fc0
.long 0x3f5a46a0,0x3f3f5cb5,0x3f1e7cf1,0x3ef15aea,0x3f490a88,0x3f28296a,0x3f0172c3,0x3eac7cd4
.long 0x3f3504f3,0x3f0e39da,0x3ec3ef15,0x3e47c5c2,0x3f1e7cf1,0x3ee3f40d,0x3e814693,0x3d48fb30
.long 0x3f05c277,0x3ea7bf25,0x3df0b772,0xbdc8bd36,0x3ed65a92,0x3e519f65,0xbca0d6d6,0xbe78cfcc
.long 0x3e9e377a,0x3da0af2a,0xbe20305b,0xbec3ef15,0x3e47c5c2,0xbd48fb30,0xbe94a031,0xbf039c3d
.long 0x3da0af2a,0xbe3403f1,0xbed65a92,0xbf226799,0xbd20cee7,0xbe996dba,0xbf0a04f8,0xbf3daef9
.long 0xbe20305b,0xbed65a92,0xbf26423a,0xbf54db31,0xbe8afa3e,0xbf07e565,0xbf3f5cb5,0xbf676bd8
.long 0xbec3ef15,0xbf226799,0xbf54db31,0xbf74fa0b,0xbefa2c90,0xbf3a4582,0xbf6655e7,0xbf7d3aac
.long 0x0,0x0,0x0,0x0,0x3e20305b,0x3e2a1c3f,0x3e3403f1,0x3e3de731
.long 0x3e9e377a,0x3ea7bf25,0x3eb13641,0x3eba9be1,0x3ee87171,0x3ef5c6c5,0x3f0172c3,0x3f07e565
.long 0x3f167918,0x3f1e7cf1,0x3f26423a,0x3f2dc5e3,0x3f3504f3,0x3f3daef9,0x3f45e403,0x3f4d9f02
.long 0x3f4f1bbd,0x3f579b8c,0x3f5f5be6,0x3f6655e7,0x3f641901,0x3f6b8a3d,0x3f71decf,0x3f770f11
.long 0x3f737871,0x3f78ed3c,0x3f7cd925,0x3f7f35f9,0x3f7cd925,0x3f7f654e,0x3f7ff35e,0x3f7e8238
.long 0x3f800000,0x3f7ec46d,0x3f7b14be,0x3f74fa0b,0x3f7cd925,0x3f770f11,0x3f6e641a,0x3f62f219
.long 0x3f737871,0x3f687c12,0x3f5a46a0,0x3f490a88,0x3f641901,0x3f53731f,0x3f3f5cb5,0x3f28296a
.long 0x3f4f1bbd,0x3f3889dc,0x3f1e7cf1,0x3f0172c3,0x3f3504f3,0x3f187fc0,0x3ef15aea,0x3eac7cd4
.long 0x3f167918,0x3ee87171,0x3e9e377a,0x3e20305b,0x3ee87171,0x3e996dba,0x3e0c4cf7,0xbcf13d4c
.long 0x3e9e377a,0x3e0c4cf7,0xbd20cee7,0xbe5b73dc,0x3e20305b,0xbcf13d4c,0xbe5b73dc,0xbec8917e
.long 0x250d3132,0xbe47c5c2,0xbec3ef15,0xbf0e39da,0xbe20305b,0xbeb5eb4f,0xbf0a04f8,0xbf333bc6
.long 0xbe9e377a,0xbf0172c3,0xbf2dc5e3,0xbf5205d4,0xbee87171,0xbf2456f1,0xbf4c1d35,0xbf698690
.long 0xbf167918,0xbf42a9f7,0xbf641901,0xbf78ed3c,0xbf3504f3,0xbf5b941a,0xbf74fa0b,0xbf7fb10f
.long 0xbf4f1bbd,0xbf6e641a,0xbf7e39bc,0xbf7d95f4,0xbf641901,0xbf7a9421,0xbf7f8e56,0xbf72ae9e
.long 0xbf737871,0xbf7fcd79,0xbf78ed3c,0xbf5f5be6,0xbf7cd925,0xbf7deafa,0xbf6a8b4b,0xbf444969
.long 0xbf800000,0xbf74fa0b,0xbf54db31,0xbf226799,0xbf7cd925,0xbf653a48,0xbf3889dc,0xbef5c6c5
.long 0x0,0x0,0x0,0x0,0x0,0x0,0x0,0x0
.long 0x0,0x0,0x0,0x0,0x0,0x0,0x0,0x0
.long 0x0,0x0,0x0,0x0,0x0,0x0,0x0,0x0
.long 0x0,0x0,0x0,0x0,0x0,0x0,0x0,0x0
.long 0x0,0x0,0x0,0x0,0x0,0x0,0x0,0x0
.long 0x0,0x0,0x0,0x0,0x0,0x0,0x0,0x0
.long 0x0,0x0,0x0,0x0,0x0,0x0,0x0,0x0
.long 0x0,0x0,0x0,0x0,0x0,0x0,0x0,0x0
.long 0x0,0x0,0x0,0x0,0x0,0x0,0x0,0x0
.long 0x0,0x0,0x0,0x0,0x0,0x0,0x0,0x0
.long 0x0,0x0,0x0,0x0,0x0,0x0,0x0,0x0
.long 0x0,0x0,0x0,0x0,0x0,0x0,0x0,0x0
.long 0x0,0x0,0x0,0x0,0x0,0x0,0x0,0x0
.long 0x0,0x0,0x0,0x0,0x0,0x0,0x0,0x0
.long 0x0,0x0,0x0,0x0,0x0,0x0,0x0,0x0
.long 0x0,0x0,0x0,0x0,0x0,0x0,0x0,0x0
.long 0x3f80,0x3f80,0x3f80,0x3f80,0x3f808000,0x3f808000,0x3f808000,0x3f808000
.long 0x3f80,0x3e9e3f73,0x3f163f4f,0x3f4f3f16,0x3f808000,0x3f73be9e,0x3f4fbf16,0x3f16bf4f
.long 0x3f80,0x3f163f4f,0x3f733e9e,0x3f73be9e,0x3f808000,0x3f4fbf16,0x3e9ebf73,0xbe9ebf73
.long 0x3f80,0x3f4f3f16,0x3f73be9e,0x3e9ebf73,0x3f808000,0x3f16bf4f,0xbe9ebf73,0xbf73be9e
.long 0x3f80,0x3f733e9e,0x3f16bf4f,0xbf16bf4f,0x3f808000,0x3e9ebf73,0xbf4fbf16,0xbf4f3f16
.long 0x3f80,0x3f80248d,0x250dbf80,0xbf80a554,0x3f808000,0x248dbf80,0xbf80a50d,0xa5543f80
.long 0x3f80,0x3f73be9e,0xbf16bf4f,0xbf163f4f,0x3f808000,0xbe9ebf73,0xbf4f3f16,0x3f4f3f16
.long 0x3f80,0x3f4fbf16,0xbf73be9e,0x3e9e3f73,0x3f808000,0xbf16bf4f,0xbe9e3f73,0x3f73be9e
.long 0x3f80,0x3f16bf4f,0xbf733e9e,0x3f733e9e,0x3f808000,0xbf4fbf16,0x3e9e3f73,0x3e9ebf73
.long 0x3f80,0x3e9ebf73,0xbf163f4f,0x3f4fbf16,0x3f808000,0xbf73be9e,0x3f4f3f16,0xbf16bf4f
.long 0x3f80,0x250dbf80,0xa58d3f80,0x25d4bf80,0x3f808000,0xbf80a50d,0x3f80258d,0xbf80a5d4
.long 0x0,0x0,0x0,0x0,0x0,0x0,0x0,0x0
.long 0x0,0x0,0x0,0x0,0x0,0x0,0x0,0x0
.long 0x0,0x0,0x0,0x0,0x0,0x0,0x0,0x0
.long 0x0,0x0,0x0,0x0,0x0,0x0,0x0,0x0
.long 0x0,0x0,0x0,0x0,0x0,0x0,0x0,0x0
.long 0x3f80,0x3f80,0x3f80,0x3f80,0x3f808000,0x3f808000,0x3f808000,0x3f808000
.long 0x3f733e9e,0x3f80248d,0x3f73be9e,0x3f4fbf16,0x3e9ebf73,0x248dbf80,0xbe9ebf73,0xbf16bf4f
.long 0x3f16bf4f,0x250dbf80,0xbf16bf4f,0xbf73be9e,0xbf4fbf16,0xbf80a50d,0xbf4f3f16,0xbe9e3f73
.long 0xbf16bf4f,0xbf80a554,0xbf163f4f,0x3e9e3f73,0xbf4f3f16,0xa5543f80,0x3f4f3f16,0x3f73be9e
.long 0xbf733e9e,0xa58d3f80,0x3f733e9e,0x3f16bf4f,0x3e9e3f73,0x3f80258d,0x3e9ebf73,0xbf4fbf16
.long 0xa58d3f80,0x3f8025b0,0x25d4bf80,0xbf80a5f7,0x3f80258d,0x25b0bf80,0xbf80a5d4,0xa5f73f80
.long 0x3f733e9e,0x25d4bf80,0xbf733e9e,0x3f163f4f,0x3e9ebf73,0xbf80a5d4,0x3e9e3f73,0x3f4fbf16
.long 0x3f16bf4f,0xbf80a5f7,0x3f163f4f,0x3e9ebf73,0xbf4fbf16,0xa5f73f80,0x3f4fbf16,0xbf73be9e
.long 0xbf16bf4f,0xa60d3f80,0x3f16bf4f,0xbf733e9e,0xbf4f3f16,0x3f80260d,0xbf4fbf16,0x3e9e3f73
.long 0xbf733e9e,0x3f80261f,0xbf73be9e,0x3f4f3f16,0x3e9e3f73,0x261fbf80,0xbe9e3f73,0x3f16bf4f
.long 0xa60d3f80,0x2630bf80,0xa6543f80,0x2677bf80,0x3f80260d,0xbf80a630,0x3f802654,0xbf80a677
.long 0x0,0x0,0x0,0x0,0x0,0x0,0x0,0x0
.long 0x0,0x0,0x0,0x0,0x0,0x0,0x0,0x0
.long 0x0,0x0,0x0,0x0,0x0,0x0,0x0,0x0
.long 0x0,0x0,0x0,0x0,0x0,0x0,0x0,0x0
.long 0x0,0x0,0x0,0x0,0x0,0x0,0x0,0x0
.long 0x3f80,0x3f80,0x3f80,0x3f80,0x3f808000,0x3f808000,0x3f808000,0x3f808000
.long 0x3f16bf4f,0x3e9ebf73,0x250dbf80,0xbe9ebf73,0xbf4fbf16,0xbf73be9e,0xbf80a50d,0xbf733e9e
.long 0xbf733e9e,0xbf163f4f,0xa58d3f80,0x3f163f4f,0x3e9e3f73,0x3f4f3f16,0x3f80258d,0x3f4fbf16
.long 0x3f733e9e,0x3f4fbf16,0x25d4bf80,0xbf4fbf16,0x3e9ebf73,0xbf16bf4f,0xbf80a5d4,0xbf163f4f
.long 0xbf16bf4f,0xbf733e9e,0xa60d3f80,0x3f733e9e,0xbf4f3f16,0x3e9e3f73,0x3f80260d,0x3e9ebf73
.long 0xa60d3f80,0x3f80261f,0x2630bf80,0xbf80a731,0x3f80260d,0x261fbf80,0xbf80a630,0xa7313f80
.long 0x3f16bf4f,0xbf73be9e,0xa6543f80,0x3f73be9e,0xbf4fbf16,0xbe9e3f73,0x3f802654,0xbe9ebf73
.long 0xbf733e9e,0x3f4f3f16,0x2677bf80,0xbf4f3f16,0x3e9e3f73,0x3f16bf4f,0xbf80a677,0x3f163f4f
.long 0x3f733e9e,0xbf16bf4f,0xa68d3f80,0x3f16bf4f,0x3e9ebf73,0xbf4f3f16,0x3f80268d,0xbf4fbf16
.long 0xbf16bf4f,0x3e9e3f73,0x269fbf80,0xbe9e3f73,0xbf4f3f16,0x3f73be9e,0xbf80a69f,0x3f733e9e
.long 0xa68d3f80,0x269fbf80,0xa6b03f80,0x27b1bf80,0x3f80268d,0xbf80a69f,0x3f8026b0,0xbf80a7b1
.long 0x0,0x0,0x0,0x0,0x0,0x0,0x0,0x0
.long 0x0,0x0,0x0,0x0,0x0,0x0,0x0,0x0
.long 0x0,0x0,0x0,0x0,0x0,0x0,0x0,0x0
.long 0x0,0x0,0x0,0x0,0x0,0x0,0x0,0x0
.long 0x0,0x0,0x0,0x0,0x0,0x0,0x0,0x0
.long 0x3f80,0x3f80,0x3f80,0x3f80,0x3f808000,0x3f808000,0x3f808000,0x3f808000
.long 0xbf16bf4f,0xbf4fbf16,0xbf73be9e,0xbf80a554,0xbf4f3f16,0xbf163f4f,0xbe9e3f73,0xa5543f80
.long 0x3f733e9e,0x3f73be9e,0x3f16bf4f,0x25d4bf80,0x3e9ebf73,0xbe9ebf73,0xbf4fbf16,0xbf80a5d4
.long 0xbf733e9e,0xbe9e3f73,0x3f163f4f,0x3f802728,0x3e9e3f73,0x3f733e9e,0x3f4fbf16,0x2728bf80
.long 0x3f16bf4f,0xbf16bf4f,0xbf733e9e,0xa6543f80,0xbf4fbf16,0xbf4f3f16,0x3e9e3f73,0x3f802654
.long 0xa6543f80,0x3f80a68d,0x2677bf80,0xbf80a742,0x3f802654,0xa68dbf80,0xbf80a677,0xa7423f80
.long 0xbf16bf4f,0xbf163f4f,0x3f733e9e,0x27a8bf80,0xbf4f3f16,0x3f4f3f16,0x3e9ebf73,0xbf80a7a8
.long 0x3f733e9e,0xbe9ebf73,0xbf163f4f,0x3f8027ee,0x3e9ebf73,0xbf733e9e,0x3f4f3f16,0x27eebf80
.long 0xbf733e9e,0x3f733e9e,0xbf16bf4f,0xa6d43f80,0x3e9e3f73,0x3e9ebf73,0xbf4f3f16,0x3f8026d4
.long 0x3f16bf4f,0xbf4f3f16,0x3f73be9e,0xbf80a777,0xbf4fbf16,0x3f163f4f,0xbe9ebf73,0xa7773f80
.long 0xa6d43f80,0xa70dbf80,0xa6f73f80,0x27c2bf80,0x3f8026d4,0xbf80270d,0x3f8026f7,0xbf80a7c2
.long 0x0,0x0,0x0,0x0,0x0,0x0,0x0,0x0
.long 0x0,0x0,0x0,0x0,0x0,0x0,0x0,0x0
.long 0x0,0x0,0x0,0x0,0x0,0x0,0x0,0x0
.long 0x0,0x0,0x0,0x0,0x0,0x0,0x0,0x0
.long 0x0,0x0,0x0,0x0,0x0,0x0,0x0,0x0
.long 0x3f80,0x3f80,0x3f80,0x3f80,0x3f808000,0x3f808000,0x3f808000,0x3f808000
.long 0xbf733e9e,0xbf4f3f16,0xbf163f4f,0xbe9e3f73,0x3e9e3f73,0x3f163f4f,0x3f4f3f16,0x3f733e9e
.long 0xbf16bf4f,0xbf73be9e,0xbf733e9e,0xbf163f4f,0xbf4f3f16,0xbe9e3f73,0x3e9e3f73,0x3f4f3f16
.long 0x3f16bf4f,0xbe9ebf73,0xbf73be9e,0xbf4f3f16,0xbf4fbf16,0xbf733e9e,0xbe9e3f73,0x3f163f4f
.long 0x3f733e9e,0x3f16bf4f,0xbf16bf4f,0xbf733e9e,0x3e9ebf73,0xbf4fbf16,0xbf4f3f16,0x3e9e3f73
.long 0xa68d3f80,0x3f80a654,0x269fbf80,0xbf802631,0x3f80268d,0xa654bf80,0xbf80a69f,0x26313f80
.long 0xbf733e9e,0x3f163f4f,0x3f16bf4f,0xbf73be9e,0x3e9e3f73,0x3f4fbf16,0xbf4fbf16,0xbe9e3f73
.long 0xbf16bf4f,0xbe9e3f73,0x3f73be9e,0xbf4fbf16,0xbf4f3f16,0x3f733e9e,0xbe9ebf73,0xbf163f4f
.long 0x3f16bf4f,0xbf733e9e,0x3f733e9e,0xbf16bf4f,0xbf4fbf16,0x3e9e3f73,0x3e9ebf73,0xbf4f3f16
.long 0x3f733e9e,0xbf4fbf16,0x3f163f4f,0xbe9ebf73,0x3e9ebf73,0xbf163f4f,0x3f4fbf16,0xbf733e9e
.long 0xa70d3f80,0xa6d4bf80,0xa71f3f80,0xa6b1bf80,0x3f80270d,0xbf8026d4,0x3f80271f,0xbf8026b1
.long 0x0,0x0,0x0,0x0,0x0,0x0,0x0,0x0
.long 0x0,0x0,0x0,0x0,0x0,0x0,0x0,0x0
.long 0x0,0x0,0x0,0x0,0x0,0x0,0x0,0x0
.long 0x0,0x0,0x0,0x0,0x0,0x0,0x0,0x0
.long 0x0,0x0,0x0,0x0,0x0,0x0,0x0,0x0
.long 0x0,0x0,0x0,0x0,0x0,0x0,0x0,0x0
.long 0x0,0x0,0x0,0x0,0x0,0x0,0x0,0x0
.long 0x0,0x0,0x0,0x0,0x0,0x0,0x0,0x0
.long 0x0,0x0,0x0,0x0,0x0,0x0,0x0,0x0
.long 0x0,0x0,0x0,0x0,0x0,0x0,0x0,0x0
.long 0x0,0x0,0x0,0x0,0x0,0x0,0x0,0x0
.long 0x0,0x0,0x0,0x0,0x0,0x0,0x0,0x0
.long 0x0,0x0,0x0,0x0,0x0,0x0,0x0,0x0
.long 0x0,0x0,0x0,0x0,0x0,0x0,0x0,0x0
.long 0x0,0x0,0x0,0x0,0x0,0x0,0x0,0x0
.long 0x0,0x0,0x0,0x0,0x0,0x0,0x0,0x0
.long 0x0,0x0,0x0,0x0,0x0,0x0,0x0,0x0
.long 0x0,0x0,0x0,0x0,0x0,0x0,0x0,0x0
.long 0x0,0x0,0x0,0x0,0x0,0x0,0x0,0x0
.long 0x0,0x0,0x0,0x0,0x0,0x0,0x0,0x0
.long 0x0,0x0,0x0,0x0,0x0,0x0,0x0,0x0
.section .rodata,"a"
.p2align 6
.amdhsa_kernel k1_kernel
  .amdhsa_next_free_vgpr 160
  .amdhsa_next_free_sgpr 102
  .amdhsa_accum_offset 160
  .amdhsa_group_segment_fixed_size 0
  .amdhsa_kernarg_size 104
  .amdhsa_user_sgpr_count 2
  .amdhsa_user_sgpr_kernarg_segment_ptr 1
  .amdhsa_system_sgpr_workgroup_id_x 1
.end_amdhsa_kernel

.p2align 6
.amdhsa_kernel k2_kernel
  .amdhsa_next_free_vgpr 256
  .amdhsa_next_free_sgpr 102
  .amdhsa_accum_offset 256
  .amdhsa_group_segment_fixed_size 0
  .amdhsa_kernarg_size 104
  .amdhsa_user_sgpr_count 2
  .amdhsa_user_sgpr_kernarg_segment_ptr 1
  .amdhsa_system_sgpr_workgroup_id_x 1
.end_amdhsa_kernel

.p2align 6
.amdhsa_kernel k3_kernel
  .amdhsa_next_free_vgpr 168
  .amdhsa_next_free_sgpr 102
  .amdhsa_accum_offset 168
  .amdhsa_group_segment_fixed_size 0
  .amdhsa_kernarg_size 104
  .amdhsa_user_sgpr_count 2
  .amdhsa_user_sgpr_kernarg_segment_ptr 1
  .amdhsa_system_sgpr_workgroup_id_x 1
.end_amdhsa_kernel
```
